```python
import torch

def _softmax(x, axis=-1):
    return torch.softmax(x, dim=axis)
def _gelu(x):
    return torch.nn.functional.gelu(x, approximate="tanh")
def _silu(x):
    return torch.nn.functional.silu(x)
def _sigmoid(x):
    return torch.sigmoid(x)
def _layernorm(x, axis=-1, eps=1e-5):
    m = x.mean(dim=axis, keepdim=True)
    v = x.var(dim=axis, keepdim=True, unbiased=False)
    return (x - m) / torch.sqrt(v + eps)
def _scatter_add(tgt, idx, src, axis=0):
    return tgt.clone().index_add_(axis, idx, src)
def _segment_sum(src, seg, n):
    out = torch.zeros((n,) + src.shape[1:], dtype=src.dtype)
    return out.index_add_(0, seg, src)
def _pad(x, pw):
    flat = tuple(v for pair in reversed(pw) for v in pair)
    return torch.nn.functional.pad(x, flat)

kernel_name = 'gated_mix__linear_attn_block__glu_gated_bilinear__prompt'

def setup_inputs():

    _w = (lambda a: (lambda t: t.to(torch.bfloat16) if t.is_floating_point() else t)(torch.as_tensor(a)))
    def _A_setup():
        B, S, D = 1, 2048, 1024
        return {
            "x": _w((lambda *s: torch.randn(*s, dtype=torch.bfloat16) * 0.05)(B, S, D)),
            "wqkv": _w((lambda *s: torch.randn(*s, dtype=torch.bfloat16) * 0.8)(D, 3 * D)),
            "wo": _w((lambda *s: torch.randn(*s, dtype=torch.bfloat16) * 0.05)(D, D)),
        }
    _A_in = _A_setup()

    def _B_setup():
        B, S, D, F = 1, 2048, 1024, 3584
        return {
            "x": _w((lambda *s: torch.randn(*s, dtype=torch.bfloat16) * 0.05)(B, S, D)),
            "w_gate": _w((lambda *s: torch.randn(*s, dtype=torch.bfloat16) * 1.6)(D, F) * (D ** -0.5)),
            "w_up": _w((lambda *s: torch.randn(*s, dtype=torch.bfloat16) * 1.6)(D, F) * (D ** -0.5)),
            "w_down": _w((lambda *s: torch.randn(*s, dtype=torch.bfloat16) * 1.6)(F, D) * (F ** -0.5)),
        }
    _B_in = _B_setup()

    return {
        "A_x": _A_in["x"],
        "A_wqkv": _A_in["wqkv"],
        "A_wo": _A_in["wo"],
        "B_x": _B_in["x"],
        "B_w_gate": _B_in["w_gate"],
        "B_w_up": _B_in["w_up"],
        "B_w_down": _B_in["w_down"],
        "gate_w": _w((lambda *s: torch.randn(*s, dtype=torch.bfloat16) * 0.05)(1024) * 16.0),
    }

def reference(A_x, A_wqkv, A_wo, B_x, B_w_gate, B_w_up, B_w_down, gate_w):
    def _A_ref(x, wqkv, wo):
        B, S, D = x.shape
        H = 32; Dh = D // H
        qkv = (lambda x, *d: x.permute(*d))((x @ wqkv).reshape(B, S, 3, H, Dh), 2, 0, 3, 1, 4)
        q, k, v = qkv[0], qkv[1], qkv[2]
        phi = lambda t: torch.where(t > 0, t + 1, torch.exp(t)) + 1e-6
        pq, pk = phi(q), phi(k)
        kv = torch.einsum("bhsd,bhse->bhde", pk, v)
        z = torch.einsum("bhsd->bhd", pk)
        num = torch.einsum("bhqd,bhde->bhqe", pq, kv)
        den = torch.einsum("bhqd,bhd->bhq", pq, z)[..., None] + 1e-6
        o = num / den
        return (lambda x, *d: x.permute(*d))(o, 0, 2, 1, 3).reshape(B, S, D) @ wo

    def _B_ref(x, w_gate, w_up, w_down):
        g = torch.einsum("bsd,df->bsf", x, w_gate)
        u = torch.einsum("bsd,df->bsf", x, w_up)
        h = g * u
        return torch.einsum("bsf,fd->bsd", h, w_down)

    x = A_x
    g = _sigmoid((x * gate_w).sum(-1, keepdims=True))
    a = _A_ref(x, A_wqkv, A_wo)
    b = _B_ref(x, B_w_gate, B_w_up, B_w_down)
    return g * a + (1 - g) * b
```

```asm
; @launch kernel=k1_gemm1_kernel grid=(256,1,1) block=(256,1,1) lds=147456
; @launch kernel=k3_gemm2_kernel grid=(256,1,1) block=(256,1,1) lds=135168
.amdgcn_target "amdgcn-amd-amdhsa--gfx950"
.text
.globl k1_gemm1_kernel
.p2align 8
.type k1_gemm1_kernel,@function
k1_gemm1_kernel:
    s_cmp_ge_u32 s2, 256
    s_cbranch_scc1 K1_END
    s_load_dwordx4 s[64:67], s[0:1], 0
    s_load_dwordx4 s[68:71], s[0:1], 32
    s_load_dwordx2 s[72:73], s[0:1], 80
    s_load_dwordx2 s[96:97], s[0:1], 16
    s_load_dwordx2 s[98:99], s[0:1], 48
    s_and_b32 s3, s2, 7
    s_lshr_b32 s32, s2, 3
    s_and_b32 s33, s32, 7
    s_lshr_b32 s32, s32, 3
    s_lshl_b32 s3, s3, 2
    s_add_u32 s34, s3, s32
    v_lshrrev_b32 v1, 6, v0
    v_and_b32 v2, 63, v0
    v_readfirstlane_b32 s35, v1
    s_and_b32 s37, s34, 1
    s_lshr_b32 s38, s34, 1
    s_mul_i32 s39, s38, 7
    s_lshl_b32 s40, s37, 2
    s_add_u32 s40, s39, s40
    s_add_u32 s41, s39, 3
    s_lshl_b32 s42, s34, 6
    s_add_u32 s48, s42, 2048
    s_add_u32 s49, s42, 4096
    s_lshl_b32 s43, s38, 7
    s_add_u32 s47, s43, 64
    s_lshl_b32 s44, s41, 6
    s_cmp_eq_u32 s37, 0
    s_cselect_b32 s50, s43, s44
    s_cselect_b32 s51, s47, s44
    s_mov_b32 s58, 229376
    s_cselect_b32 s58, 196608, s58
    s_lshl_b32 s44, s40, 6
    s_add_u32 s52, s44, 0
    s_add_u32 s53, s44, 0
    s_add_u32 s54, s44, 64
    s_add_u32 s55, s44, 64
    s_add_u32 s56, s44, 128
    s_add_u32 s57, s44, 128
    s_lshr_b32 s36, s35, 1
    s_cmp_eq_u32 s36, 0
    s_cselect_b32 s74, s48, s49
    s_cselect_b32 s75, s50, s51
    s_cselect_b32 s76, s52, s53
    s_cselect_b32 s77, s54, s55
    s_cselect_b32 s78, s56, s57
    s_waitcnt lgkmcnt(0)
    s_lshl_b32 s3, s33, 19
    s_add_u32 s64, s64, s3
    s_addc_u32 s65, s65, 0
    s_mov_b32 s4, s64
    s_and_b32 s5, s65, 0xffff
    s_mov_b32 s6, 0x80000
    s_mov_b32 s7, 0x00020000
    s_mov_b32 s8, s66
    s_and_b32 s9, s67, 0xffff
    s_mov_b32 s10, 0x600000
    s_mov_b32 s11, 0x00020000
    s_mov_b32 s12, s68
    s_and_b32 s13, s69, 0xffff
    s_mov_b32 s14, 0x700000
    s_mov_b32 s15, 0x00020000
    s_mov_b32 s16, s70
    s_and_b32 s17, s71, 0xffff
    s_mov_b32 s18, 0x700000
    s_mov_b32 s19, 0x00020000
    s_mov_b32 s28, s72
    s_and_b32 s29, s73, 0xffff
    s_mov_b32 s30, 0x10000000
    s_mov_b32 s31, 0x00020000
    s_cmp_eq_u32 s36, 0
    s_cselect_b32 s20, s12, s16
    s_cselect_b32 s21, s13, s17
    s_cselect_b32 s22, s14, s18
    s_cselect_b32 s23, s15, s19
    s_cmp_eq_u32 s37, 0
    s_cselect_b32 s24, s8, s20
    s_cselect_b32 s25, s9, s21
    s_cselect_b32 s26, s10, s22
    s_cselect_b32 s27, s11, s23
    s_lshl_b32 s79, s33, 2
    s_and_b32 s3, s34, 3
    s_add_u32 s79, s79, s3
    s_lshl_b32 s59, s79, 6
    s_mul_i32 s60, s79, 196608
    s_mul_i32 s61, s79, 229376
    s_mul_i32 s62, s79, s58
    s_lshl_b32 s45, s35, 12
    s_lshl_b32 s46, s35, 10
    s_add_u32 s46, s46, 16384
    v_lshrrev_b32 v3, 2, v2
    v_lshlrev_b32 v4, 6, v1
    v_add_u32 v4, v3, v4
    v_lshlrev_b32 v4, 11, v4
    v_lshrrev_b32 v5, 4, v2
    v_lshlrev_b32 v7, 1, v5
    v_and_b32 v7, 3, v7
    v_lshrrev_b32 v5, 1, v5
    v_mul_u32_u24 v5, 3, v5
    v_xor_b32 v5, v5, v7
    v_and_b32 v6, 3, v2
    v_xor_b32 v7, v6, v5
    v_lshl_add_u32 v10, v7, 4, v4
    v_and_b32 v4, 1, v1
    v_lshlrev_b32 v4, 4, v4
    v_add_u32 v3, v3, v4
    v_lshrrev_b32 v4, 5, v2
    v_lshlrev_b32 v4, 1, v4
    v_xor_b32 v4, v4, v6
    v_lshlrev_b32 v4, 4, v4
    s_movk_i32 s3, 6144
    v_mul_lo_u32 v11, v3, s3
    v_add_u32 v11, v11, v4
    s_movk_i32 s3, 7168
    v_mul_lo_u32 v12, v3, s3
    v_add_u32 v12, v12, v4
    s_cmp_eq_u32 s37, 0
    s_cselect_b64 vcc, -1, 0
    s_nop 1
    v_cndmask_b32 v13, v12, v11, vcc
    s_add_u32 m0, s45, 0
    s_add_u32 s3, s59, 0
    buffer_load_dwordx4 v10, s[4:7], s3 offen lds
    s_add_u32 m0, s46, 0
    s_add_u32 s3, s60, s74
    buffer_load_dwordx4 v11, s[8:11], s3 offen lds
    s_add_u32 m0, s45, 1024
    s_add_u32 s3, s59, 32768
    buffer_load_dwordx4 v10, s[4:7], s3 offen lds
    s_add_u32 m0, s46, 4096
    s_add_u32 s3, s62, s75
    buffer_load_dwordx4 v13, s[24:27], s3 offen lds
    s_add_u32 m0, s45, 2048
    s_add_u32 s3, s59, 65536
    buffer_load_dwordx4 v10, s[4:7], s3 offen lds
    s_add_u32 m0, s46, 8192
    s_add_u32 s3, s61, s76
    buffer_load_dwordx4 v12, s[20:23], s3 offen lds
    s_add_u32 m0, s45, 3072
    s_add_u32 s3, s59, 98304
    buffer_load_dwordx4 v10, s[4:7], s3 offen lds
    s_add_u32 m0, s46, 12288
    s_add_u32 s3, s61, s77
    buffer_load_dwordx4 v12, s[20:23], s3 offen lds
    s_add_u32 m0, s46, 16384
    s_add_u32 s3, s61, s78
    buffer_load_dwordx4 v12, s[20:23], s3 offen lds
    s_add_u32 s79, s79, 1
    s_and_b32 s79, s79, 31
    s_lshl_b32 s59, s79, 6
    s_mul_i32 s60, s79, 196608
    s_mul_i32 s61, s79, 229376
    s_mul_i32 s62, s79, s58
    v_and_b32 v3, 15, v2
    v_lshlrev_b32 v4, 6, v1
    v_add_u32 v4, v4, v3
    v_lshlrev_b32 v4, 6, v4
    v_lshrrev_b32 v5, 2, v3
    v_lshlrev_b32 v7, 1, v5
    v_and_b32 v7, 3, v7
    v_lshrrev_b32 v5, 1, v5
    v_mul_u32_u24 v5, 3, v5
    v_xor_b32 v5, v5, v7
    v_lshrrev_b32 v6, 4, v2
    v_xor_b32 v7, v6, v5
    v_lshl_add_u32 v14, v7, 4, v4
    v_add_u32 v15, 36864, v14
    v_add_u32 v16, 73728, v14
    v_add_u32 v17, 110592, v14
    v_lshrrev_b32 v3, 5, v2
    v_lshlrev_b32 v3, 10, v3
    v_bfe_u32 v4, v2, 4, 1
    v_lshl_add_u32 v3, v4, 9, v3
    v_bfe_u32 v5, v2, 2, 2
    v_lshl_add_u32 v3, v5, 6, v3
    v_lshl_add_u32 v3, v4, 5, v3
    v_and_b32 v5, 3, v2
    v_lshl_add_u32 v3, v5, 3, v3
    v_xor_b32 v4, 32, v3
    v_add_u32 v18, 16384, v3
    v_add_u32 v19, 16384, v4
    v_add_u32 v20, 53248, v3
    v_add_u32 v21, 53248, v4
    v_add_u32 v22, 90112, v3
    v_add_u32 v23, 90112, v4
    v_add_u32 v24, 126976, v3
    v_add_u32 v25, 126976, v4
    v_accvgpr_write_b32 a0, 0
    v_accvgpr_write_b32 a1, 0
    v_accvgpr_write_b32 a2, 0
    v_accvgpr_write_b32 a3, 0
    v_accvgpr_write_b32 a4, 0
    v_accvgpr_write_b32 a5, 0
    v_accvgpr_write_b32 a6, 0
    v_accvgpr_write_b32 a7, 0
    v_accvgpr_write_b32 a8, 0
    v_accvgpr_write_b32 a9, 0
    v_accvgpr_write_b32 a10, 0
    v_accvgpr_write_b32 a11, 0
    v_accvgpr_write_b32 a12, 0
    v_accvgpr_write_b32 a13, 0
    v_accvgpr_write_b32 a14, 0
    v_accvgpr_write_b32 a15, 0
    v_accvgpr_write_b32 a16, 0
    v_accvgpr_write_b32 a17, 0
    v_accvgpr_write_b32 a18, 0
    v_accvgpr_write_b32 a19, 0
    v_accvgpr_write_b32 a20, 0
    v_accvgpr_write_b32 a21, 0
    v_accvgpr_write_b32 a22, 0
    v_accvgpr_write_b32 a23, 0
    v_accvgpr_write_b32 a24, 0
    v_accvgpr_write_b32 a25, 0
    v_accvgpr_write_b32 a26, 0
    v_accvgpr_write_b32 a27, 0
    v_accvgpr_write_b32 a28, 0
    v_accvgpr_write_b32 a29, 0
    v_accvgpr_write_b32 a30, 0
    v_accvgpr_write_b32 a31, 0
    v_accvgpr_write_b32 a32, 0
    v_accvgpr_write_b32 a33, 0
    v_accvgpr_write_b32 a34, 0
    v_accvgpr_write_b32 a35, 0
    v_accvgpr_write_b32 a36, 0
    v_accvgpr_write_b32 a37, 0
    v_accvgpr_write_b32 a38, 0
    v_accvgpr_write_b32 a39, 0
    v_accvgpr_write_b32 a40, 0
    v_accvgpr_write_b32 a41, 0
    v_accvgpr_write_b32 a42, 0
    v_accvgpr_write_b32 a43, 0
    v_accvgpr_write_b32 a44, 0
    v_accvgpr_write_b32 a45, 0
    v_accvgpr_write_b32 a46, 0
    v_accvgpr_write_b32 a47, 0
    v_accvgpr_write_b32 a48, 0
    v_accvgpr_write_b32 a49, 0
    v_accvgpr_write_b32 a50, 0
    v_accvgpr_write_b32 a51, 0
    v_accvgpr_write_b32 a52, 0
    v_accvgpr_write_b32 a53, 0
    v_accvgpr_write_b32 a54, 0
    v_accvgpr_write_b32 a55, 0
    v_accvgpr_write_b32 a56, 0
    v_accvgpr_write_b32 a57, 0
    v_accvgpr_write_b32 a58, 0
    v_accvgpr_write_b32 a59, 0
    v_accvgpr_write_b32 a60, 0
    v_accvgpr_write_b32 a61, 0
    v_accvgpr_write_b32 a62, 0
    v_accvgpr_write_b32 a63, 0
    v_accvgpr_write_b32 a64, 0
    v_accvgpr_write_b32 a65, 0
    v_accvgpr_write_b32 a66, 0
    v_accvgpr_write_b32 a67, 0
    v_accvgpr_write_b32 a68, 0
    v_accvgpr_write_b32 a69, 0
    v_accvgpr_write_b32 a70, 0
    v_accvgpr_write_b32 a71, 0
    v_accvgpr_write_b32 a72, 0
    v_accvgpr_write_b32 a73, 0
    v_accvgpr_write_b32 a74, 0
    v_accvgpr_write_b32 a75, 0
    v_accvgpr_write_b32 a76, 0
    v_accvgpr_write_b32 a77, 0
    v_accvgpr_write_b32 a78, 0
    v_accvgpr_write_b32 a79, 0
    v_accvgpr_write_b32 a80, 0
    v_accvgpr_write_b32 a81, 0
    v_accvgpr_write_b32 a82, 0
    v_accvgpr_write_b32 a83, 0
    v_accvgpr_write_b32 a84, 0
    v_accvgpr_write_b32 a85, 0
    v_accvgpr_write_b32 a86, 0
    v_accvgpr_write_b32 a87, 0
    v_accvgpr_write_b32 a88, 0
    v_accvgpr_write_b32 a89, 0
    v_accvgpr_write_b32 a90, 0
    v_accvgpr_write_b32 a91, 0
    v_accvgpr_write_b32 a92, 0
    v_accvgpr_write_b32 a93, 0
    v_accvgpr_write_b32 a94, 0
    v_accvgpr_write_b32 a95, 0
    v_mov_b32 v32, 0
    v_mov_b32 v33, 0
    v_mov_b32 v34, 0
    v_mov_b32 v35, 0
    v_mov_b32 v36, 0
    v_mov_b32 v37, 0
    v_mov_b32 v38, 0
    v_mov_b32 v39, 0
    v_mov_b32 v40, 0
    v_mov_b32 v41, 0
    v_mov_b32 v42, 0
    v_mov_b32 v43, 0
    v_mov_b32 v44, 0
    v_mov_b32 v45, 0
    v_mov_b32 v46, 0
    v_mov_b32 v47, 0
    v_mov_b32 v48, 0
    v_mov_b32 v49, 0
    v_mov_b32 v50, 0
    v_mov_b32 v51, 0
    v_mov_b32 v52, 0
    v_mov_b32 v53, 0
    v_mov_b32 v54, 0
    v_mov_b32 v55, 0
    v_mov_b32 v56, 0
    v_mov_b32 v57, 0
    v_mov_b32 v58, 0
    v_mov_b32 v59, 0
    v_mov_b32 v60, 0
    v_mov_b32 v61, 0
    v_mov_b32 v62, 0
    v_mov_b32 v63, 0
    v_mov_b32 v64, 0
    v_mov_b32 v65, 0
    v_mov_b32 v66, 0
    v_mov_b32 v67, 0
    v_mov_b32 v68, 0
    v_mov_b32 v69, 0
    v_mov_b32 v70, 0
    v_mov_b32 v71, 0
    v_mov_b32 v72, 0
    v_mov_b32 v73, 0
    v_mov_b32 v74, 0
    v_mov_b32 v75, 0
    v_mov_b32 v76, 0
    v_mov_b32 v77, 0
    v_mov_b32 v78, 0
    v_mov_b32 v79, 0
    v_mov_b32 v80, 0
    v_mov_b32 v81, 0
    v_mov_b32 v82, 0
    v_mov_b32 v83, 0
    v_mov_b32 v84, 0
    v_mov_b32 v85, 0
    v_mov_b32 v86, 0
    v_mov_b32 v87, 0
    v_mov_b32 v88, 0
    v_mov_b32 v89, 0
    v_mov_b32 v90, 0
    v_mov_b32 v91, 0
    v_mov_b32 v92, 0
    v_mov_b32 v93, 0
    v_mov_b32 v94, 0
    v_mov_b32 v95, 0
    v_mov_b32 v96, 0
    v_mov_b32 v97, 0
    v_mov_b32 v98, 0
    v_mov_b32 v99, 0
    v_mov_b32 v100, 0
    v_mov_b32 v101, 0
    v_mov_b32 v102, 0
    v_mov_b32 v103, 0
    v_mov_b32 v104, 0
    v_mov_b32 v105, 0
    v_mov_b32 v106, 0
    v_mov_b32 v107, 0
    v_mov_b32 v108, 0
    v_mov_b32 v109, 0
    v_mov_b32 v110, 0
    v_mov_b32 v111, 0
    v_mov_b32 v112, 0
    v_mov_b32 v113, 0
    v_mov_b32 v114, 0
    v_mov_b32 v115, 0
    v_mov_b32 v116, 0
    v_mov_b32 v117, 0
    v_mov_b32 v118, 0
    v_mov_b32 v119, 0
    v_mov_b32 v120, 0
    v_mov_b32 v121, 0
    v_mov_b32 v122, 0
    v_mov_b32 v123, 0
    v_mov_b32 v124, 0
    v_mov_b32 v125, 0
    v_mov_b32 v126, 0
    v_mov_b32 v127, 0
    v_mov_b32 v128, 0
    v_mov_b32 v129, 0
    v_mov_b32 v130, 0
    v_mov_b32 v131, 0
    v_mov_b32 v132, 0
    v_mov_b32 v133, 0
    v_mov_b32 v134, 0
    v_mov_b32 v135, 0
    v_mov_b32 v136, 0
    v_mov_b32 v137, 0
    v_mov_b32 v138, 0
    v_mov_b32 v139, 0
    v_mov_b32 v140, 0
    v_mov_b32 v141, 0
    v_mov_b32 v142, 0
    v_mov_b32 v143, 0
    v_mov_b32 v144, 0
    v_mov_b32 v145, 0
    v_mov_b32 v146, 0
    v_mov_b32 v147, 0
    v_mov_b32 v148, 0
    v_mov_b32 v149, 0
    v_mov_b32 v150, 0
    v_mov_b32 v151, 0
    v_mov_b32 v152, 0
    v_mov_b32 v153, 0
    v_mov_b32 v154, 0
    v_mov_b32 v155, 0
    v_mov_b32 v156, 0
    v_mov_b32 v157, 0
    v_mov_b32 v158, 0
    v_mov_b32 v159, 0
    v_mov_b32 v160, 0
    v_mov_b32 v161, 0
    v_mov_b32 v162, 0
    v_mov_b32 v163, 0
    v_mov_b32 v164, 0
    v_mov_b32 v165, 0
    v_mov_b32 v166, 0
    v_mov_b32 v167, 0
    v_mov_b32 v168, 0
    v_mov_b32 v169, 0
    v_mov_b32 v170, 0
    v_mov_b32 v171, 0
    v_mov_b32 v172, 0
    v_mov_b32 v173, 0
    v_mov_b32 v174, 0
    v_mov_b32 v175, 0
    v_mov_b32 v176, 0
    v_mov_b32 v177, 0
    v_mov_b32 v178, 0
    v_mov_b32 v179, 0
    v_mov_b32 v180, 0
    v_mov_b32 v181, 0
    v_mov_b32 v182, 0
    v_mov_b32 v183, 0
    v_mov_b32 v184, 0
    v_mov_b32 v185, 0
    v_mov_b32 v186, 0
    v_mov_b32 v187, 0
    v_mov_b32 v188, 0
    v_mov_b32 v189, 0
    v_mov_b32 v190, 0
    v_mov_b32 v191, 0
    v_mov_b32 v192, 0
    v_mov_b32 v193, 0
    v_mov_b32 v194, 0
    v_mov_b32 v195, 0
    v_mov_b32 v196, 0
    v_mov_b32 v197, 0
    v_mov_b32 v198, 0
    v_mov_b32 v199, 0
    v_mov_b32 v200, 0
    v_mov_b32 v201, 0
    v_mov_b32 v202, 0
    v_mov_b32 v203, 0
    v_mov_b32 v204, 0
    v_mov_b32 v205, 0
    v_mov_b32 v206, 0
    v_mov_b32 v207, 0
    v_mov_b32 v208, 0
    v_mov_b32 v209, 0
    v_mov_b32 v210, 0
    v_mov_b32 v211, 0
    v_mov_b32 v212, 0
    v_mov_b32 v213, 0
    v_mov_b32 v214, 0
    v_mov_b32 v215, 0
    v_mov_b32 v216, 0
    v_mov_b32 v217, 0
    v_mov_b32 v218, 0
    v_mov_b32 v219, 0
    v_mov_b32 v220, 0
    v_mov_b32 v221, 0
    v_mov_b32 v222, 0
    v_mov_b32 v223, 0
    v_mov_b32 v224, 0
    v_mov_b32 v225, 0
    v_mov_b32 v226, 0
    v_mov_b32 v227, 0
    v_mov_b32 v228, 0
    v_mov_b32 v229, 0
    v_mov_b32 v230, 0
    v_mov_b32 v231, 0
    v_mov_b32 v232, 0
    v_mov_b32 v233, 0
    v_mov_b32 v234, 0
    v_mov_b32 v235, 0
    v_mov_b32 v236, 0
    v_mov_b32 v237, 0
    v_mov_b32 v238, 0
    v_mov_b32 v239, 0
    v_mov_b32 v240, 0
    v_mov_b32 v241, 0
    v_mov_b32 v242, 0
    v_mov_b32 v243, 0
    v_mov_b32 v244, 0
    v_mov_b32 v245, 0
    v_mov_b32 v246, 0
    v_mov_b32 v247, 0
    v_mov_b32 v248, 0
    v_mov_b32 v249, 0
    v_mov_b32 v250, 0
    v_mov_b32 v251, 0
    v_mov_b32 v252, 0
    v_mov_b32 v253, 0
    v_mov_b32 v254, 0
    v_mov_b32 v255, 0
    s_waitcnt vmcnt(0)
    s_barrier
    ds_read_b128 a[96:99], v14 offset:0
    ds_read_b128 a[100:103], v14 offset:1024
    ds_read_b128 a[104:107], v14 offset:2048
    ds_read_b128 a[108:111], v14 offset:3072
    ds_read_b64_tr_b16 a[128:129], v18 offset:0
    ds_read_b64_tr_b16 a[130:131], v18 offset:256
    ds_read_b64_tr_b16 a[132:133], v19 offset:0
    ds_read_b64_tr_b16 a[134:135], v19 offset:256
    ds_read_b64_tr_b16 a[136:137], v18 offset:2048
    ds_read_b64_tr_b16 a[138:139], v18 offset:2304
    ds_read_b64_tr_b16 a[140:141], v19 offset:2048
    ds_read_b64_tr_b16 a[142:143], v19 offset:2304
    ds_read_b64_tr_b16 a[144:145], v18 offset:4096
    ds_read_b64_tr_b16 a[146:147], v18 offset:4352
    ds_read_b64_tr_b16 a[148:149], v19 offset:4096
    ds_read_b64_tr_b16 a[150:151], v19 offset:4352
    ds_read_b64_tr_b16 a[152:153], v18 offset:6144
    ds_read_b64_tr_b16 a[154:155], v18 offset:6400
    ds_read_b64_tr_b16 a[156:157], v19 offset:6144
    ds_read_b64_tr_b16 a[158:159], v19 offset:6400
    ds_read_b64_tr_b16 a[160:161], v18 offset:8192
    ds_read_b64_tr_b16 a[162:163], v18 offset:8448
    ds_read_b64_tr_b16 a[164:165], v19 offset:8192
    ds_read_b64_tr_b16 a[166:167], v19 offset:8448
    s_add_u32 m0, s45, 36864
    s_add_u32 s3, s59, 0
    buffer_load_dwordx4 v10, s[4:7], s3 offen lds
    s_add_u32 m0, s46, 36864
    s_add_u32 s3, s60, s74
    buffer_load_dwordx4 v11, s[8:11], s3 offen lds
    s_add_u32 m0, s45, 37888
    s_add_u32 s3, s59, 32768
    buffer_load_dwordx4 v10, s[4:7], s3 offen lds
    s_add_u32 m0, s46, 40960
    s_add_u32 s3, s62, s75
    buffer_load_dwordx4 v13, s[24:27], s3 offen lds
    s_add_u32 m0, s45, 38912
    s_add_u32 s3, s59, 65536
    buffer_load_dwordx4 v10, s[4:7], s3 offen lds
    s_add_u32 m0, s46, 45056
    s_add_u32 s3, s61, s76
    buffer_load_dwordx4 v12, s[20:23], s3 offen lds
    s_add_u32 m0, s45, 39936
    s_add_u32 s3, s59, 98304
    buffer_load_dwordx4 v10, s[4:7], s3 offen lds
    s_add_u32 m0, s46, 49152
    s_add_u32 s3, s61, s77
    buffer_load_dwordx4 v12, s[20:23], s3 offen lds
    s_add_u32 m0, s46, 53248
    s_add_u32 s3, s61, s78
    buffer_load_dwordx4 v12, s[20:23], s3 offen lds
    s_add_u32 s79, s79, 1
    s_and_b32 s79, s79, 31
    s_lshl_b32 s59, s79, 6
    s_mul_i32 s60, s79, 196608
    s_mul_i32 s61, s79, 229376
    s_mul_i32 s62, s79, s58
    s_add_u32 m0, s45, 73728
    s_add_u32 s3, s59, 0
    buffer_load_dwordx4 v10, s[4:7], s3 offen lds
    s_add_u32 m0, s46, 73728
    s_add_u32 s3, s60, s74
    buffer_load_dwordx4 v11, s[8:11], s3 offen lds
    s_add_u32 m0, s45, 74752
    s_add_u32 s3, s59, 32768
    buffer_load_dwordx4 v10, s[4:7], s3 offen lds
    s_add_u32 m0, s46, 77824
    s_add_u32 s3, s62, s75
    buffer_load_dwordx4 v13, s[24:27], s3 offen lds
    s_add_u32 m0, s45, 75776
    s_add_u32 s3, s59, 65536
    buffer_load_dwordx4 v10, s[4:7], s3 offen lds
    s_add_u32 m0, s46, 81920
    s_add_u32 s3, s61, s76
    buffer_load_dwordx4 v12, s[20:23], s3 offen lds
    s_add_u32 m0, s45, 76800
    s_add_u32 s3, s59, 98304
    buffer_load_dwordx4 v10, s[4:7], s3 offen lds
    s_add_u32 m0, s46, 86016
    s_add_u32 s3, s61, s77
    buffer_load_dwordx4 v12, s[20:23], s3 offen lds
    s_add_u32 m0, s46, 90112
    s_add_u32 s3, s61, s78
    buffer_load_dwordx4 v12, s[20:23], s3 offen lds
    s_add_u32 s79, s79, 1
    s_and_b32 s79, s79, 31
    s_lshl_b32 s59, s79, 6
    s_mul_i32 s60, s79, 196608
    s_mul_i32 s61, s79, 229376
    s_mul_i32 s62, s79, s58
    s_add_u32 m0, s45, 110592
    s_add_u32 s3, s59, 0
    buffer_load_dwordx4 v10, s[4:7], s3 offen lds
    s_add_u32 m0, s46, 110592
    s_add_u32 s3, s60, s74
    buffer_load_dwordx4 v11, s[8:11], s3 offen lds
    s_add_u32 m0, s45, 111616
    s_add_u32 s3, s59, 32768
    buffer_load_dwordx4 v10, s[4:7], s3 offen lds
    s_add_u32 m0, s46, 114688
    s_add_u32 s3, s62, s75
    buffer_load_dwordx4 v13, s[24:27], s3 offen lds
    s_add_u32 m0, s45, 112640
    s_add_u32 s3, s59, 65536
    buffer_load_dwordx4 v10, s[4:7], s3 offen lds
    s_add_u32 m0, s46, 118784
    s_add_u32 s3, s61, s76
    buffer_load_dwordx4 v12, s[20:23], s3 offen lds
    s_add_u32 m0, s45, 113664
    s_add_u32 s3, s59, 98304
    buffer_load_dwordx4 v10, s[4:7], s3 offen lds
    s_add_u32 m0, s46, 122880
    s_add_u32 s3, s61, s77
    buffer_load_dwordx4 v12, s[20:23], s3 offen lds
    s_add_u32 m0, s46, 126976
    s_add_u32 s3, s61, s78
    buffer_load_dwordx4 v12, s[20:23], s3 offen lds
    s_add_u32 s79, s79, 1
    s_and_b32 s79, s79, 31
    s_lshl_b32 s59, s79, 6
    s_mul_i32 s60, s79, 196608
    s_mul_i32 s61, s79, 229376
    s_mul_i32 s62, s79, s58
    s_mov_b32 s63, 0
    s_waitcnt lgkmcnt(0)
    v_mfma_f32_16x16x32_bf16 a[0:3], a[96:99], a[128:131], a[0:3]
    ds_read_b64_tr_b16 a[168:169], v18 offset:10240
    v_mfma_f32_16x16x32_bf16 a[8:11], a[100:103], a[128:131], a[8:11]
    ds_read_b64_tr_b16 a[170:171], v18 offset:10496
    v_mfma_f32_16x16x32_bf16 a[16:19], a[104:107], a[128:131], a[16:19]
    v_mfma_f32_16x16x32_bf16 a[24:27], a[108:111], a[128:131], a[24:27]
    ds_read_b64_tr_b16 a[172:173], v19 offset:10240
    v_mfma_f32_16x16x32_bf16 a[4:7], a[96:99], a[132:135], a[4:7]
    ds_read_b64_tr_b16 a[174:175], v19 offset:10496
    v_mfma_f32_16x16x32_bf16 a[12:15], a[100:103], a[132:135], a[12:15]
    v_mfma_f32_16x16x32_bf16 a[20:23], a[104:107], a[132:135], a[20:23]
    ds_read_b64_tr_b16 a[176:177], v18 offset:12288
    v_mfma_f32_16x16x32_bf16 a[28:31], a[108:111], a[132:135], a[28:31]
    ds_read_b64_tr_b16 a[178:179], v18 offset:12544
    v_mfma_f32_16x16x32_bf16 a[32:35], a[96:99], a[136:139], a[32:35]
    v_mfma_f32_16x16x32_bf16 a[40:43], a[100:103], a[136:139], a[40:43]
    ds_read_b64_tr_b16 a[180:181], v19 offset:12288
    v_mfma_f32_16x16x32_bf16 a[48:51], a[104:107], a[136:139], a[48:51]
    ds_read_b64_tr_b16 a[182:183], v19 offset:12544
    v_mfma_f32_16x16x32_bf16 a[56:59], a[108:111], a[136:139], a[56:59]
    v_mfma_f32_16x16x32_bf16 a[36:39], a[96:99], a[140:143], a[36:39]
    ds_read_b64_tr_b16 a[184:185], v18 offset:14336
    v_mfma_f32_16x16x32_bf16 a[44:47], a[100:103], a[140:143], a[44:47]
    ds_read_b64_tr_b16 a[186:187], v18 offset:14592
    v_mfma_f32_16x16x32_bf16 a[52:55], a[104:107], a[140:143], a[52:55]
    v_mfma_f32_16x16x32_bf16 a[60:63], a[108:111], a[140:143], a[60:63]
    ds_read_b64_tr_b16 a[188:189], v19 offset:14336
    v_mfma_f32_16x16x32_bf16 a[64:67], a[144:147], a[96:99], a[64:67]
    ds_read_b64_tr_b16 a[190:191], v19 offset:14592
    v_mfma_f32_16x16x32_bf16 a[72:75], a[144:147], a[100:103], a[72:75]
    v_mfma_f32_16x16x32_bf16 a[80:83], a[144:147], a[104:107], a[80:83]
    ds_read_b64_tr_b16 a[192:193], v18 offset:16384
    v_mfma_f32_16x16x32_bf16 a[88:91], a[144:147], a[108:111], a[88:91]
    ds_read_b64_tr_b16 a[194:195], v18 offset:16640
    v_mfma_f32_16x16x32_bf16 a[68:71], a[148:151], a[96:99], a[68:71]
    v_mfma_f32_16x16x32_bf16 a[76:79], a[148:151], a[100:103], a[76:79]
    ds_read_b64_tr_b16 a[196:197], v19 offset:16384
    v_mfma_f32_16x16x32_bf16 a[84:87], a[148:151], a[104:107], a[84:87]
    ds_read_b64_tr_b16 a[198:199], v19 offset:16640
    v_mfma_f32_16x16x32_bf16 a[92:95], a[148:151], a[108:111], a[92:95]
    v_mfma_f32_16x16x32_bf16 v[32:35], a[152:155], a[96:99], v[32:35]
    ds_read_b64_tr_b16 a[200:201], v18 offset:18432
    v_mfma_f32_16x16x32_bf16 v[40:43], a[152:155], a[100:103], v[40:43]
    ds_read_b64_tr_b16 a[202:203], v18 offset:18688
    v_mfma_f32_16x16x32_bf16 v[48:51], a[152:155], a[104:107], v[48:51]
    v_mfma_f32_16x16x32_bf16 v[56:59], a[152:155], a[108:111], v[56:59]
    ds_read_b64_tr_b16 a[204:205], v19 offset:18432
    v_mfma_f32_16x16x32_bf16 v[36:39], a[156:159], a[96:99], v[36:39]
    ds_read_b64_tr_b16 a[206:207], v19 offset:18688
    v_mfma_f32_16x16x32_bf16 v[44:47], a[156:159], a[100:103], v[44:47]
    v_mfma_f32_16x16x32_bf16 v[52:55], a[156:159], a[104:107], v[52:55]
    v_mfma_f32_16x16x32_bf16 v[60:63], a[156:159], a[108:111], v[60:63]
    v_mfma_f32_16x16x32_bf16 v[64:67], a[160:163], a[96:99], v[64:67]
    v_mfma_f32_16x16x32_bf16 v[72:75], a[160:163], a[100:103], v[72:75]
    v_mfma_f32_16x16x32_bf16 v[80:83], a[160:163], a[104:107], v[80:83]
    v_mfma_f32_16x16x32_bf16 v[88:91], a[160:163], a[108:111], v[88:91]
    v_mfma_f32_16x16x32_bf16 v[68:71], a[164:167], a[96:99], v[68:71]
    v_mfma_f32_16x16x32_bf16 v[76:79], a[164:167], a[100:103], v[76:79]
    v_mfma_f32_16x16x32_bf16 v[84:87], a[164:167], a[104:107], v[84:87]
    v_mfma_f32_16x16x32_bf16 v[92:95], a[164:167], a[108:111], v[92:95]
    s_waitcnt vmcnt(18) lgkmcnt(0)
    s_barrier
    v_mfma_f32_16x16x32_bf16 v[96:99], a[168:171], a[96:99], v[96:99]
    ds_read_b128 a[112:115], v15 offset:0
    v_mfma_f32_16x16x32_bf16 v[104:107], a[168:171], a[100:103], v[104:107]
    ds_read_b128 a[116:119], v15 offset:1024
    v_mfma_f32_16x16x32_bf16 v[112:115], a[168:171], a[104:107], v[112:115]
    s_add_u32 m0, s45, 0
    v_mfma_f32_16x16x32_bf16 v[120:123], a[168:171], a[108:111], v[120:123]
    ds_read_b128 a[120:123], v15 offset:2048
    v_mfma_f32_16x16x32_bf16 v[100:103], a[172:175], a[96:99], v[100:103]
    ds_read_b128 a[124:127], v15 offset:3072
    v_mfma_f32_16x16x32_bf16 v[108:111], a[172:175], a[100:103], v[108:111]
    s_add_u32 s3, s59, 0
    v_mfma_f32_16x16x32_bf16 v[116:119], a[172:175], a[104:107], v[116:119]
    ds_read_b64_tr_b16 a[128:129], v20 offset:0
    v_mfma_f32_16x16x32_bf16 v[124:127], a[172:175], a[108:111], v[124:127]
    ds_read_b64_tr_b16 a[130:131], v20 offset:256
    v_mfma_f32_16x16x32_bf16 v[128:131], a[176:179], a[96:99], v[128:131]
    buffer_load_dwordx4 v10, s[4:7], s3 offen lds
    v_mfma_f32_16x16x32_bf16 v[136:139], a[176:179], a[100:103], v[136:139]
    ds_read_b64_tr_b16 a[132:133], v21 offset:0
    v_mfma_f32_16x16x32_bf16 v[144:147], a[176:179], a[104:107], v[144:147]
    ds_read_b64_tr_b16 a[134:135], v21 offset:256
    v_mfma_f32_16x16x32_bf16 v[152:155], a[176:179], a[108:111], v[152:155]
    s_add_u32 m0, s46, 0
    v_mfma_f32_16x16x32_bf16 v[132:135], a[180:183], a[96:99], v[132:135]
    ds_read_b64_tr_b16 a[136:137], v20 offset:2048
    v_mfma_f32_16x16x32_bf16 v[140:143], a[180:183], a[100:103], v[140:143]
    ds_read_b64_tr_b16 a[138:139], v20 offset:2304
    v_mfma_f32_16x16x32_bf16 v[148:151], a[180:183], a[104:107], v[148:151]
    s_add_u32 s3, s60, s74
    v_mfma_f32_16x16x32_bf16 v[156:159], a[180:183], a[108:111], v[156:159]
    ds_read_b64_tr_b16 a[140:141], v21 offset:2048
    v_mfma_f32_16x16x32_bf16 v[160:163], a[184:187], a[96:99], v[160:163]
    ds_read_b64_tr_b16 a[142:143], v21 offset:2304
    v_mfma_f32_16x16x32_bf16 v[168:171], a[184:187], a[100:103], v[168:171]
    buffer_load_dwordx4 v11, s[8:11], s3 offen lds
    v_mfma_f32_16x16x32_bf16 v[176:179], a[184:187], a[104:107], v[176:179]
    ds_read_b64_tr_b16 a[144:145], v20 offset:4096
    v_mfma_f32_16x16x32_bf16 v[184:187], a[184:187], a[108:111], v[184:187]
    ds_read_b64_tr_b16 a[146:147], v20 offset:4352
    v_mfma_f32_16x16x32_bf16 v[164:167], a[188:191], a[96:99], v[164:167]
    s_add_u32 m0, s45, 1024
    v_mfma_f32_16x16x32_bf16 v[172:175], a[188:191], a[100:103], v[172:175]
    ds_read_b64_tr_b16 a[148:149], v21 offset:4096
    v_mfma_f32_16x16x32_bf16 v[180:183], a[188:191], a[104:107], v[180:183]
    ds_read_b64_tr_b16 a[150:151], v21 offset:4352
    v_mfma_f32_16x16x32_bf16 v[188:191], a[188:191], a[108:111], v[188:191]
    s_add_u32 s3, s59, 32768
    v_mfma_f32_16x16x32_bf16 v[192:195], a[192:195], a[96:99], v[192:195]
    ds_read_b64_tr_b16 a[152:153], v20 offset:6144
    v_mfma_f32_16x16x32_bf16 v[200:203], a[192:195], a[100:103], v[200:203]
    ds_read_b64_tr_b16 a[154:155], v20 offset:6400
    v_mfma_f32_16x16x32_bf16 v[208:211], a[192:195], a[104:107], v[208:211]
    buffer_load_dwordx4 v10, s[4:7], s3 offen lds
    v_mfma_f32_16x16x32_bf16 v[216:219], a[192:195], a[108:111], v[216:219]
    ds_read_b64_tr_b16 a[156:157], v21 offset:6144
    v_mfma_f32_16x16x32_bf16 v[196:199], a[196:199], a[96:99], v[196:199]
    ds_read_b64_tr_b16 a[158:159], v21 offset:6400
    v_mfma_f32_16x16x32_bf16 v[204:207], a[196:199], a[100:103], v[204:207]
    s_add_u32 m0, s46, 4096
    v_mfma_f32_16x16x32_bf16 v[212:215], a[196:199], a[104:107], v[212:215]
    ds_read_b64_tr_b16 a[160:161], v20 offset:8192
    v_mfma_f32_16x16x32_bf16 v[220:223], a[196:199], a[108:111], v[220:223]
    ds_read_b64_tr_b16 a[162:163], v20 offset:8448
    v_mfma_f32_16x16x32_bf16 v[224:227], a[200:203], a[96:99], v[224:227]
    s_add_u32 s3, s62, s75
    v_mfma_f32_16x16x32_bf16 v[232:235], a[200:203], a[100:103], v[232:235]
    ds_read_b64_tr_b16 a[164:165], v21 offset:8192
    v_mfma_f32_16x16x32_bf16 v[240:243], a[200:203], a[104:107], v[240:243]
    ds_read_b64_tr_b16 a[166:167], v21 offset:8448
    v_mfma_f32_16x16x32_bf16 v[248:251], a[200:203], a[108:111], v[248:251]
    buffer_load_dwordx4 v13, s[24:27], s3 offen lds
    v_mfma_f32_16x16x32_bf16 v[228:231], a[204:207], a[96:99], v[228:231]
    s_add_u32 m0, s45, 2048
    v_mfma_f32_16x16x32_bf16 v[236:239], a[204:207], a[100:103], v[236:239]
    s_add_u32 s3, s59, 65536
    v_mfma_f32_16x16x32_bf16 v[244:247], a[204:207], a[104:107], v[244:247]
    buffer_load_dwordx4 v10, s[4:7], s3 offen lds
    v_mfma_f32_16x16x32_bf16 v[252:255], a[204:207], a[108:111], v[252:255]
K1_LOOP:
    s_waitcnt lgkmcnt(0)
    v_mfma_f32_16x16x32_bf16 a[0:3], a[112:115], a[128:131], a[0:3]
    ds_read_b64_tr_b16 a[168:169], v20 offset:10240
    v_mfma_f32_16x16x32_bf16 a[8:11], a[116:119], a[128:131], a[8:11]
    ds_read_b64_tr_b16 a[170:171], v20 offset:10496
    v_mfma_f32_16x16x32_bf16 a[16:19], a[120:123], a[128:131], a[16:19]
    s_add_u32 m0, s46, 8192
    v_mfma_f32_16x16x32_bf16 a[24:27], a[124:127], a[128:131], a[24:27]
    ds_read_b64_tr_b16 a[172:173], v21 offset:10240
    v_mfma_f32_16x16x32_bf16 a[4:7], a[112:115], a[132:135], a[4:7]
    ds_read_b64_tr_b16 a[174:175], v21 offset:10496
    v_mfma_f32_16x16x32_bf16 a[12:15], a[116:119], a[132:135], a[12:15]
    s_add_u32 s3, s61, s76
    v_mfma_f32_16x16x32_bf16 a[20:23], a[120:123], a[132:135], a[20:23]
    ds_read_b64_tr_b16 a[176:177], v20 offset:12288
    v_mfma_f32_16x16x32_bf16 a[28:31], a[124:127], a[132:135], a[28:31]
    ds_read_b64_tr_b16 a[178:179], v20 offset:12544
    v_mfma_f32_16x16x32_bf16 a[32:35], a[112:115], a[136:139], a[32:35]
    buffer_load_dwordx4 v12, s[20:23], s3 offen lds
    v_mfma_f32_16x16x32_bf16 a[40:43], a[116:119], a[136:139], a[40:43]
    ds_read_b64_tr_b16 a[180:181], v21 offset:12288
    v_mfma_f32_16x16x32_bf16 a[48:51], a[120:123], a[136:139], a[48:51]
    ds_read_b64_tr_b16 a[182:183], v21 offset:12544
    v_mfma_f32_16x16x32_bf16 a[56:59], a[124:127], a[136:139], a[56:59]
    s_add_u32 m0, s45, 3072
    v_mfma_f32_16x16x32_bf16 a[36:39], a[112:115], a[140:143], a[36:39]
    ds_read_b64_tr_b16 a[184:185], v20 offset:14336
    v_mfma_f32_16x16x32_bf16 a[44:47], a[116:119], a[140:143], a[44:47]
    ds_read_b64_tr_b16 a[186:187], v20 offset:14592
    v_mfma_f32_16x16x32_bf16 a[52:55], a[120:123], a[140:143], a[52:55]
    s_add_u32 s3, s59, 98304
    v_mfma_f32_16x16x32_bf16 a[60:63], a[124:127], a[140:143], a[60:63]
    ds_read_b64_tr_b16 a[188:189], v21 offset:14336
    v_mfma_f32_16x16x32_bf16 a[64:67], a[144:147], a[112:115], a[64:67]
    ds_read_b64_tr_b16 a[190:191], v21 offset:14592
    v_mfma_f32_16x16x32_bf16 a[72:75], a[144:147], a[116:119], a[72:75]
    buffer_load_dwordx4 v10, s[4:7], s3 offen lds
    v_mfma_f32_16x16x32_bf16 a[80:83], a[144:147], a[120:123], a[80:83]
    ds_read_b64_tr_b16 a[192:193], v20 offset:16384
    v_mfma_f32_16x16x32_bf16 a[88:91], a[144:147], a[124:127], a[88:91]
    ds_read_b64_tr_b16 a[194:195], v20 offset:16640
    v_mfma_f32_16x16x32_bf16 a[68:71], a[148:151], a[112:115], a[68:71]
    s_add_u32 m0, s46, 12288
    v_mfma_f32_16x16x32_bf16 a[76:79], a[148:151], a[116:119], a[76:79]
    ds_read_b64_tr_b16 a[196:197], v21 offset:16384
    v_mfma_f32_16x16x32_bf16 a[84:87], a[148:151], a[120:123], a[84:87]
    ds_read_b64_tr_b16 a[198:199], v21 offset:16640
    v_mfma_f32_16x16x32_bf16 a[92:95], a[148:151], a[124:127], a[92:95]
    s_add_u32 s3, s61, s77
    v_mfma_f32_16x16x32_bf16 v[32:35], a[152:155], a[112:115], v[32:35]
    ds_read_b64_tr_b16 a[200:201], v20 offset:18432
    v_mfma_f32_16x16x32_bf16 v[40:43], a[152:155], a[116:119], v[40:43]
    ds_read_b64_tr_b16 a[202:203], v20 offset:18688
    v_mfma_f32_16x16x32_bf16 v[48:51], a[152:155], a[120:123], v[48:51]
    buffer_load_dwordx4 v12, s[20:23], s3 offen lds
    v_mfma_f32_16x16x32_bf16 v[56:59], a[152:155], a[124:127], v[56:59]
    ds_read_b64_tr_b16 a[204:205], v21 offset:18432
    v_mfma_f32_16x16x32_bf16 v[36:39], a[156:159], a[112:115], v[36:39]
    ds_read_b64_tr_b16 a[206:207], v21 offset:18688
    v_mfma_f32_16x16x32_bf16 v[44:47], a[156:159], a[116:119], v[44:47]
    v_mfma_f32_16x16x32_bf16 v[52:55], a[156:159], a[120:123], v[52:55]
    s_add_u32 m0, s46, 16384
    v_mfma_f32_16x16x32_bf16 v[60:63], a[156:159], a[124:127], v[60:63]
    s_add_u32 s3, s61, s78
    v_mfma_f32_16x16x32_bf16 v[64:67], a[160:163], a[112:115], v[64:67]
    buffer_load_dwordx4 v12, s[20:23], s3 offen lds
    v_mfma_f32_16x16x32_bf16 v[72:75], a[160:163], a[116:119], v[72:75]
    s_add_u32 s79, s79, 1
    v_mfma_f32_16x16x32_bf16 v[80:83], a[160:163], a[120:123], v[80:83]
    s_and_b32 s79, s79, 31
    v_mfma_f32_16x16x32_bf16 v[88:91], a[160:163], a[124:127], v[88:91]
    s_lshl_b32 s59, s79, 6
    v_mfma_f32_16x16x32_bf16 v[68:71], a[164:167], a[112:115], v[68:71]
    s_mul_i32 s60, s79, 196608
    v_mfma_f32_16x16x32_bf16 v[76:79], a[164:167], a[116:119], v[76:79]
    s_mul_i32 s61, s79, 229376
    v_mfma_f32_16x16x32_bf16 v[84:87], a[164:167], a[120:123], v[84:87]
    s_mul_i32 s62, s79, s58
    v_mfma_f32_16x16x32_bf16 v[92:95], a[164:167], a[124:127], v[92:95]
    s_waitcnt vmcnt(18) lgkmcnt(0)
    s_barrier
    v_mfma_f32_16x16x32_bf16 v[96:99], a[168:171], a[112:115], v[96:99]
    ds_read_b128 a[96:99], v16 offset:0
    v_mfma_f32_16x16x32_bf16 v[104:107], a[168:171], a[116:119], v[104:107]
    ds_read_b128 a[100:103], v16 offset:1024
    v_mfma_f32_16x16x32_bf16 v[112:115], a[168:171], a[120:123], v[112:115]
    s_add_u32 m0, s45, 36864
    v_mfma_f32_16x16x32_bf16 v[120:123], a[168:171], a[124:127], v[120:123]
    ds_read_b128 a[104:107], v16 offset:2048
    v_mfma_f32_16x16x32_bf16 v[100:103], a[172:175], a[112:115], v[100:103]
    ds_read_b128 a[108:111], v16 offset:3072
    v_mfma_f32_16x16x32_bf16 v[108:111], a[172:175], a[116:119], v[108:111]
    s_add_u32 s3, s59, 0
    v_mfma_f32_16x16x32_bf16 v[116:119], a[172:175], a[120:123], v[116:119]
    ds_read_b64_tr_b16 a[128:129], v22 offset:0
    v_mfma_f32_16x16x32_bf16 v[124:127], a[172:175], a[124:127], v[124:127]
    ds_read_b64_tr_b16 a[130:131], v22 offset:256
    v_mfma_f32_16x16x32_bf16 v[128:131], a[176:179], a[112:115], v[128:131]
    buffer_load_dwordx4 v10, s[4:7], s3 offen lds
    v_mfma_f32_16x16x32_bf16 v[136:139], a[176:179], a[116:119], v[136:139]
    ds_read_b64_tr_b16 a[132:133], v23 offset:0
    v_mfma_f32_16x16x32_bf16 v[144:147], a[176:179], a[120:123], v[144:147]
    ds_read_b64_tr_b16 a[134:135], v23 offset:256
    v_mfma_f32_16x16x32_bf16 v[152:155], a[176:179], a[124:127], v[152:155]
    s_add_u32 m0, s46, 36864
    v_mfma_f32_16x16x32_bf16 v[132:135], a[180:183], a[112:115], v[132:135]
    ds_read_b64_tr_b16 a[136:137], v22 offset:2048
    v_mfma_f32_16x16x32_bf16 v[140:143], a[180:183], a[116:119], v[140:143]
    ds_read_b64_tr_b16 a[138:139], v22 offset:2304
    v_mfma_f32_16x16x32_bf16 v[148:151], a[180:183], a[120:123], v[148:151]
    s_add_u32 s3, s60, s74
    v_mfma_f32_16x16x32_bf16 v[156:159], a[180:183], a[124:127], v[156:159]
    ds_read_b64_tr_b16 a[140:141], v23 offset:2048
    v_mfma_f32_16x16x32_bf16 v[160:163], a[184:187], a[112:115], v[160:163]
    ds_read_b64_tr_b16 a[142:143], v23 offset:2304
    v_mfma_f32_16x16x32_bf16 v[168:171], a[184:187], a[116:119], v[168:171]
    buffer_load_dwordx4 v11, s[8:11], s3 offen lds
    v_mfma_f32_16x16x32_bf16 v[176:179], a[184:187], a[120:123], v[176:179]
    ds_read_b64_tr_b16 a[144:145], v22 offset:4096
    v_mfma_f32_16x16x32_bf16 v[184:187], a[184:187], a[124:127], v[184:187]
    ds_read_b64_tr_b16 a[146:147], v22 offset:4352
    v_mfma_f32_16x16x32_bf16 v[164:167], a[188:191], a[112:115], v[164:167]
    s_add_u32 m0, s45, 37888
    v_mfma_f32_16x16x32_bf16 v[172:175], a[188:191], a[116:119], v[172:175]
    ds_read_b64_tr_b16 a[148:149], v23 offset:4096
    v_mfma_f32_16x16x32_bf16 v[180:183], a[188:191], a[120:123], v[180:183]
    ds_read_b64_tr_b16 a[150:151], v23 offset:4352
    v_mfma_f32_16x16x32_bf16 v[188:191], a[188:191], a[124:127], v[188:191]
    s_add_u32 s3, s59, 32768
    v_mfma_f32_16x16x32_bf16 v[192:195], a[192:195], a[112:115], v[192:195]
    ds_read_b64_tr_b16 a[152:153], v22 offset:6144
    v_mfma_f32_16x16x32_bf16 v[200:203], a[192:195], a[116:119], v[200:203]
    ds_read_b64_tr_b16 a[154:155], v22 offset:6400
    v_mfma_f32_16x16x32_bf16 v[208:211], a[192:195], a[120:123], v[208:211]
    buffer_load_dwordx4 v10, s[4:7], s3 offen lds
    v_mfma_f32_16x16x32_bf16 v[216:219], a[192:195], a[124:127], v[216:219]
    ds_read_b64_tr_b16 a[156:157], v23 offset:6144
    v_mfma_f32_16x16x32_bf16 v[196:199], a[196:199], a[112:115], v[196:199]
    ds_read_b64_tr_b16 a[158:159], v23 offset:6400
    v_mfma_f32_16x16x32_bf16 v[204:207], a[196:199], a[116:119], v[204:207]
    s_add_u32 m0, s46, 40960
    v_mfma_f32_16x16x32_bf16 v[212:215], a[196:199], a[120:123], v[212:215]
    ds_read_b64_tr_b16 a[160:161], v22 offset:8192
    v_mfma_f32_16x16x32_bf16 v[220:223], a[196:199], a[124:127], v[220:223]
    ds_read_b64_tr_b16 a[162:163], v22 offset:8448
    v_mfma_f32_16x16x32_bf16 v[224:227], a[200:203], a[112:115], v[224:227]
    s_add_u32 s3, s62, s75
    v_mfma_f32_16x16x32_bf16 v[232:235], a[200:203], a[116:119], v[232:235]
    ds_read_b64_tr_b16 a[164:165], v23 offset:8192
    v_mfma_f32_16x16x32_bf16 v[240:243], a[200:203], a[120:123], v[240:243]
    ds_read_b64_tr_b16 a[166:167], v23 offset:8448
    v_mfma_f32_16x16x32_bf16 v[248:251], a[200:203], a[124:127], v[248:251]
    buffer_load_dwordx4 v13, s[24:27], s3 offen lds
    v_mfma_f32_16x16x32_bf16 v[228:231], a[204:207], a[112:115], v[228:231]
    s_add_u32 m0, s45, 38912
    v_mfma_f32_16x16x32_bf16 v[236:239], a[204:207], a[116:119], v[236:239]
    s_add_u32 s3, s59, 65536
    v_mfma_f32_16x16x32_bf16 v[244:247], a[204:207], a[120:123], v[244:247]
    buffer_load_dwordx4 v10, s[4:7], s3 offen lds
    v_mfma_f32_16x16x32_bf16 v[252:255], a[204:207], a[124:127], v[252:255]
    s_waitcnt lgkmcnt(0)
    v_mfma_f32_16x16x32_bf16 a[0:3], a[96:99], a[128:131], a[0:3]
    ds_read_b64_tr_b16 a[168:169], v22 offset:10240
    v_mfma_f32_16x16x32_bf16 a[8:11], a[100:103], a[128:131], a[8:11]
    ds_read_b64_tr_b16 a[170:171], v22 offset:10496
    v_mfma_f32_16x16x32_bf16 a[16:19], a[104:107], a[128:131], a[16:19]
    s_add_u32 m0, s46, 45056
    v_mfma_f32_16x16x32_bf16 a[24:27], a[108:111], a[128:131], a[24:27]
    ds_read_b64_tr_b16 a[172:173], v23 offset:10240
    v_mfma_f32_16x16x32_bf16 a[4:7], a[96:99], a[132:135], a[4:7]
    ds_read_b64_tr_b16 a[174:175], v23 offset:10496
    v_mfma_f32_16x16x32_bf16 a[12:15], a[100:103], a[132:135], a[12:15]
    s_add_u32 s3, s61, s76
    v_mfma_f32_16x16x32_bf16 a[20:23], a[104:107], a[132:135], a[20:23]
    ds_read_b64_tr_b16 a[176:177], v22 offset:12288
    v_mfma_f32_16x16x32_bf16 a[28:31], a[108:111], a[132:135], a[28:31]
    ds_read_b64_tr_b16 a[178:179], v22 offset:12544
    v_mfma_f32_16x16x32_bf16 a[32:35], a[96:99], a[136:139], a[32:35]
    buffer_load_dwordx4 v12, s[20:23], s3 offen lds
    v_mfma_f32_16x16x32_bf16 a[40:43], a[100:103], a[136:139], a[40:43]
    ds_read_b64_tr_b16 a[180:181], v23 offset:12288
    v_mfma_f32_16x16x32_bf16 a[48:51], a[104:107], a[136:139], a[48:51]
    ds_read_b64_tr_b16 a[182:183], v23 offset:12544
    v_mfma_f32_16x16x32_bf16 a[56:59], a[108:111], a[136:139], a[56:59]
    s_add_u32 m0, s45, 39936
    v_mfma_f32_16x16x32_bf16 a[36:39], a[96:99], a[140:143], a[36:39]
    ds_read_b64_tr_b16 a[184:185], v22 offset:14336
    v_mfma_f32_16x16x32_bf16 a[44:47], a[100:103], a[140:143], a[44:47]
    ds_read_b64_tr_b16 a[186:187], v22 offset:14592
    v_mfma_f32_16x16x32_bf16 a[52:55], a[104:107], a[140:143], a[52:55]
    s_add_u32 s3, s59, 98304
    v_mfma_f32_16x16x32_bf16 a[60:63], a[108:111], a[140:143], a[60:63]
    ds_read_b64_tr_b16 a[188:189], v23 offset:14336
    v_mfma_f32_16x16x32_bf16 a[64:67], a[144:147], a[96:99], a[64:67]
    ds_read_b64_tr_b16 a[190:191], v23 offset:14592
    v_mfma_f32_16x16x32_bf16 a[72:75], a[144:147], a[100:103], a[72:75]
    buffer_load_dwordx4 v10, s[4:7], s3 offen lds
    v_mfma_f32_16x16x32_bf16 a[80:83], a[144:147], a[104:107], a[80:83]
    ds_read_b64_tr_b16 a[192:193], v22 offset:16384
    v_mfma_f32_16x16x32_bf16 a[88:91], a[144:147], a[108:111], a[88:91]
    ds_read_b64_tr_b16 a[194:195], v22 offset:16640
    v_mfma_f32_16x16x32_bf16 a[68:71], a[148:151], a[96:99], a[68:71]
    s_add_u32 m0, s46, 49152
    v_mfma_f32_16x16x32_bf16 a[76:79], a[148:151], a[100:103], a[76:79]
    ds_read_b64_tr_b16 a[196:197], v23 offset:16384
    v_mfma_f32_16x16x32_bf16 a[84:87], a[148:151], a[104:107], a[84:87]
    ds_read_b64_tr_b16 a[198:199], v23 offset:16640
    v_mfma_f32_16x16x32_bf16 a[92:95], a[148:151], a[108:111], a[92:95]
    s_add_u32 s3, s61, s77
    v_mfma_f32_16x16x32_bf16 v[32:35], a[152:155], a[96:99], v[32:35]
    ds_read_b64_tr_b16 a[200:201], v22 offset:18432
    v_mfma_f32_16x16x32_bf16 v[40:43], a[152:155], a[100:103], v[40:43]
    ds_read_b64_tr_b16 a[202:203], v22 offset:18688
    v_mfma_f32_16x16x32_bf16 v[48:51], a[152:155], a[104:107], v[48:51]
    buffer_load_dwordx4 v12, s[20:23], s3 offen lds
    v_mfma_f32_16x16x32_bf16 v[56:59], a[152:155], a[108:111], v[56:59]
    ds_read_b64_tr_b16 a[204:205], v23 offset:18432
    v_mfma_f32_16x16x32_bf16 v[36:39], a[156:159], a[96:99], v[36:39]
    ds_read_b64_tr_b16 a[206:207], v23 offset:18688
    v_mfma_f32_16x16x32_bf16 v[44:47], a[156:159], a[100:103], v[44:47]
    v_mfma_f32_16x16x32_bf16 v[52:55], a[156:159], a[104:107], v[52:55]
    s_add_u32 m0, s46, 53248
    v_mfma_f32_16x16x32_bf16 v[60:63], a[156:159], a[108:111], v[60:63]
    s_add_u32 s3, s61, s78
    v_mfma_f32_16x16x32_bf16 v[64:67], a[160:163], a[96:99], v[64:67]
    buffer_load_dwordx4 v12, s[20:23], s3 offen lds
    v_mfma_f32_16x16x32_bf16 v[72:75], a[160:163], a[100:103], v[72:75]
    s_add_u32 s79, s79, 1
    v_mfma_f32_16x16x32_bf16 v[80:83], a[160:163], a[104:107], v[80:83]
    s_and_b32 s79, s79, 31
    v_mfma_f32_16x16x32_bf16 v[88:91], a[160:163], a[108:111], v[88:91]
    s_lshl_b32 s59, s79, 6
    v_mfma_f32_16x16x32_bf16 v[68:71], a[164:167], a[96:99], v[68:71]
    s_mul_i32 s60, s79, 196608
    v_mfma_f32_16x16x32_bf16 v[76:79], a[164:167], a[100:103], v[76:79]
    s_mul_i32 s61, s79, 229376
    v_mfma_f32_16x16x32_bf16 v[84:87], a[164:167], a[104:107], v[84:87]
    s_mul_i32 s62, s79, s58
    v_mfma_f32_16x16x32_bf16 v[92:95], a[164:167], a[108:111], v[92:95]
    s_waitcnt vmcnt(18) lgkmcnt(0)
    s_barrier
    v_mfma_f32_16x16x32_bf16 v[96:99], a[168:171], a[96:99], v[96:99]
    ds_read_b128 a[112:115], v17 offset:0
    v_mfma_f32_16x16x32_bf16 v[104:107], a[168:171], a[100:103], v[104:107]
    ds_read_b128 a[116:119], v17 offset:1024
    v_mfma_f32_16x16x32_bf16 v[112:115], a[168:171], a[104:107], v[112:115]
    s_add_u32 m0, s45, 73728
    v_mfma_f32_16x16x32_bf16 v[120:123], a[168:171], a[108:111], v[120:123]
    ds_read_b128 a[120:123], v17 offset:2048
    v_mfma_f32_16x16x32_bf16 v[100:103], a[172:175], a[96:99], v[100:103]
    ds_read_b128 a[124:127], v17 offset:3072
    v_mfma_f32_16x16x32_bf16 v[108:111], a[172:175], a[100:103], v[108:111]
    s_add_u32 s3, s59, 0
    v_mfma_f32_16x16x32_bf16 v[116:119], a[172:175], a[104:107], v[116:119]
    ds_read_b64_tr_b16 a[128:129], v24 offset:0
    v_mfma_f32_16x16x32_bf16 v[124:127], a[172:175], a[108:111], v[124:127]
    ds_read_b64_tr_b16 a[130:131], v24 offset:256
    v_mfma_f32_16x16x32_bf16 v[128:131], a[176:179], a[96:99], v[128:131]
    buffer_load_dwordx4 v10, s[4:7], s3 offen lds
    v_mfma_f32_16x16x32_bf16 v[136:139], a[176:179], a[100:103], v[136:139]
    ds_read_b64_tr_b16 a[132:133], v25 offset:0
    v_mfma_f32_16x16x32_bf16 v[144:147], a[176:179], a[104:107], v[144:147]
    ds_read_b64_tr_b16 a[134:135], v25 offset:256
    v_mfma_f32_16x16x32_bf16 v[152:155], a[176:179], a[108:111], v[152:155]
    s_add_u32 m0, s46, 73728
    v_mfma_f32_16x16x32_bf16 v[132:135], a[180:183], a[96:99], v[132:135]
    ds_read_b64_tr_b16 a[136:137], v24 offset:2048
    v_mfma_f32_16x16x32_bf16 v[140:143], a[180:183], a[100:103], v[140:143]
    ds_read_b64_tr_b16 a[138:139], v24 offset:2304
    v_mfma_f32_16x16x32_bf16 v[148:151], a[180:183], a[104:107], v[148:151]
    s_add_u32 s3, s60, s74
    v_mfma_f32_16x16x32_bf16 v[156:159], a[180:183], a[108:111], v[156:159]
    ds_read_b64_tr_b16 a[140:141], v25 offset:2048
    v_mfma_f32_16x16x32_bf16 v[160:163], a[184:187], a[96:99], v[160:163]
    ds_read_b64_tr_b16 a[142:143], v25 offset:2304
    v_mfma_f32_16x16x32_bf16 v[168:171], a[184:187], a[100:103], v[168:171]
    buffer_load_dwordx4 v11, s[8:11], s3 offen lds
    v_mfma_f32_16x16x32_bf16 v[176:179], a[184:187], a[104:107], v[176:179]
    ds_read_b64_tr_b16 a[144:145], v24 offset:4096
    v_mfma_f32_16x16x32_bf16 v[184:187], a[184:187], a[108:111], v[184:187]
    ds_read_b64_tr_b16 a[146:147], v24 offset:4352
    v_mfma_f32_16x16x32_bf16 v[164:167], a[188:191], a[96:99], v[164:167]
    s_add_u32 m0, s45, 74752
    v_mfma_f32_16x16x32_bf16 v[172:175], a[188:191], a[100:103], v[172:175]
    ds_read_b64_tr_b16 a[148:149], v25 offset:4096
    v_mfma_f32_16x16x32_bf16 v[180:183], a[188:191], a[104:107], v[180:183]
    ds_read_b64_tr_b16 a[150:151], v25 offset:4352
    v_mfma_f32_16x16x32_bf16 v[188:191], a[188:191], a[108:111], v[188:191]
    s_add_u32 s3, s59, 32768
    v_mfma_f32_16x16x32_bf16 v[192:195], a[192:195], a[96:99], v[192:195]
    ds_read_b64_tr_b16 a[152:153], v24 offset:6144
    v_mfma_f32_16x16x32_bf16 v[200:203], a[192:195], a[100:103], v[200:203]
    ds_read_b64_tr_b16 a[154:155], v24 offset:6400
    v_mfma_f32_16x16x32_bf16 v[208:211], a[192:195], a[104:107], v[208:211]
    buffer_load_dwordx4 v10, s[4:7], s3 offen lds
    v_mfma_f32_16x16x32_bf16 v[216:219], a[192:195], a[108:111], v[216:219]
    ds_read_b64_tr_b16 a[156:157], v25 offset:6144
    v_mfma_f32_16x16x32_bf16 v[196:199], a[196:199], a[96:99], v[196:199]
    ds_read_b64_tr_b16 a[158:159], v25 offset:6400
    v_mfma_f32_16x16x32_bf16 v[204:207], a[196:199], a[100:103], v[204:207]
    s_add_u32 m0, s46, 77824
    v_mfma_f32_16x16x32_bf16 v[212:215], a[196:199], a[104:107], v[212:215]
    ds_read_b64_tr_b16 a[160:161], v24 offset:8192
    v_mfma_f32_16x16x32_bf16 v[220:223], a[196:199], a[108:111], v[220:223]
    ds_read_b64_tr_b16 a[162:163], v24 offset:8448
    v_mfma_f32_16x16x32_bf16 v[224:227], a[200:203], a[96:99], v[224:227]
    s_add_u32 s3, s62, s75
    v_mfma_f32_16x16x32_bf16 v[232:235], a[200:203], a[100:103], v[232:235]
    ds_read_b64_tr_b16 a[164:165], v25 offset:8192
    v_mfma_f32_16x16x32_bf16 v[240:243], a[200:203], a[104:107], v[240:243]
    ds_read_b64_tr_b16 a[166:167], v25 offset:8448
    v_mfma_f32_16x16x32_bf16 v[248:251], a[200:203], a[108:111], v[248:251]
    buffer_load_dwordx4 v13, s[24:27], s3 offen lds
    v_mfma_f32_16x16x32_bf16 v[228:231], a[204:207], a[96:99], v[228:231]
    s_add_u32 m0, s45, 75776
    v_mfma_f32_16x16x32_bf16 v[236:239], a[204:207], a[100:103], v[236:239]
    s_add_u32 s3, s59, 65536
    v_mfma_f32_16x16x32_bf16 v[244:247], a[204:207], a[104:107], v[244:247]
    buffer_load_dwordx4 v10, s[4:7], s3 offen lds
    v_mfma_f32_16x16x32_bf16 v[252:255], a[204:207], a[108:111], v[252:255]
    s_waitcnt lgkmcnt(0)
    v_mfma_f32_16x16x32_bf16 a[0:3], a[112:115], a[128:131], a[0:3]
    ds_read_b64_tr_b16 a[168:169], v24 offset:10240
    v_mfma_f32_16x16x32_bf16 a[8:11], a[116:119], a[128:131], a[8:11]
    ds_read_b64_tr_b16 a[170:171], v24 offset:10496
    v_mfma_f32_16x16x32_bf16 a[16:19], a[120:123], a[128:131], a[16:19]
    s_add_u32 m0, s46, 81920
    v_mfma_f32_16x16x32_bf16 a[24:27], a[124:127], a[128:131], a[24:27]
    ds_read_b64_tr_b16 a[172:173], v25 offset:10240
    v_mfma_f32_16x16x32_bf16 a[4:7], a[112:115], a[132:135], a[4:7]
    ds_read_b64_tr_b16 a[174:175], v25 offset:10496
    v_mfma_f32_16x16x32_bf16 a[12:15], a[116:119], a[132:135], a[12:15]
    s_add_u32 s3, s61, s76
    v_mfma_f32_16x16x32_bf16 a[20:23], a[120:123], a[132:135], a[20:23]
    ds_read_b64_tr_b16 a[176:177], v24 offset:12288
    v_mfma_f32_16x16x32_bf16 a[28:31], a[124:127], a[132:135], a[28:31]
    ds_read_b64_tr_b16 a[178:179], v24 offset:12544
    v_mfma_f32_16x16x32_bf16 a[32:35], a[112:115], a[136:139], a[32:35]
    buffer_load_dwordx4 v12, s[20:23], s3 offen lds
    v_mfma_f32_16x16x32_bf16 a[40:43], a[116:119], a[136:139], a[40:43]
    ds_read_b64_tr_b16 a[180:181], v25 offset:12288
    v_mfma_f32_16x16x32_bf16 a[48:51], a[120:123], a[136:139], a[48:51]
    ds_read_b64_tr_b16 a[182:183], v25 offset:12544
    v_mfma_f32_16x16x32_bf16 a[56:59], a[124:127], a[136:139], a[56:59]
    s_add_u32 m0, s45, 76800
    v_mfma_f32_16x16x32_bf16 a[36:39], a[112:115], a[140:143], a[36:39]
    ds_read_b64_tr_b16 a[184:185], v24 offset:14336
    v_mfma_f32_16x16x32_bf16 a[44:47], a[116:119], a[140:143], a[44:47]
    ds_read_b64_tr_b16 a[186:187], v24 offset:14592
    v_mfma_f32_16x16x32_bf16 a[52:55], a[120:123], a[140:143], a[52:55]
    s_add_u32 s3, s59, 98304
    v_mfma_f32_16x16x32_bf16 a[60:63], a[124:127], a[140:143], a[60:63]
    ds_read_b64_tr_b16 a[188:189], v25 offset:14336
    v_mfma_f32_16x16x32_bf16 a[64:67], a[144:147], a[112:115], a[64:67]
    ds_read_b64_tr_b16 a[190:191], v25 offset:14592
    v_mfma_f32_16x16x32_bf16 a[72:75], a[144:147], a[116:119], a[72:75]
    buffer_load_dwordx4 v10, s[4:7], s3 offen lds
    v_mfma_f32_16x16x32_bf16 a[80:83], a[144:147], a[120:123], a[80:83]
    ds_read_b64_tr_b16 a[192:193], v24 offset:16384
    v_mfma_f32_16x16x32_bf16 a[88:91], a[144:147], a[124:127], a[88:91]
    ds_read_b64_tr_b16 a[194:195], v24 offset:16640
    v_mfma_f32_16x16x32_bf16 a[68:71], a[148:151], a[112:115], a[68:71]
    s_add_u32 m0, s46, 86016
    v_mfma_f32_16x16x32_bf16 a[76:79], a[148:151], a[116:119], a[76:79]
    ds_read_b64_tr_b16 a[196:197], v25 offset:16384
    v_mfma_f32_16x16x32_bf16 a[84:87], a[148:151], a[120:123], a[84:87]
    ds_read_b64_tr_b16 a[198:199], v25 offset:16640
    v_mfma_f32_16x16x32_bf16 a[92:95], a[148:151], a[124:127], a[92:95]
    s_add_u32 s3, s61, s77
    v_mfma_f32_16x16x32_bf16 v[32:35], a[152:155], a[112:115], v[32:35]
    ds_read_b64_tr_b16 a[200:201], v24 offset:18432
    v_mfma_f32_16x16x32_bf16 v[40:43], a[152:155], a[116:119], v[40:43]
    ds_read_b64_tr_b16 a[202:203], v24 offset:18688
    v_mfma_f32_16x16x32_bf16 v[48:51], a[152:155], a[120:123], v[48:51]
    buffer_load_dwordx4 v12, s[20:23], s3 offen lds
    v_mfma_f32_16x16x32_bf16 v[56:59], a[152:155], a[124:127], v[56:59]
    ds_read_b64_tr_b16 a[204:205], v25 offset:18432
    v_mfma_f32_16x16x32_bf16 v[36:39], a[156:159], a[112:115], v[36:39]
    ds_read_b64_tr_b16 a[206:207], v25 offset:18688
    v_mfma_f32_16x16x32_bf16 v[44:47], a[156:159], a[116:119], v[44:47]
    v_mfma_f32_16x16x32_bf16 v[52:55], a[156:159], a[120:123], v[52:55]
    s_add_u32 m0, s46, 90112
    v_mfma_f32_16x16x32_bf16 v[60:63], a[156:159], a[124:127], v[60:63]
    s_add_u32 s3, s61, s78
    v_mfma_f32_16x16x32_bf16 v[64:67], a[160:163], a[112:115], v[64:67]
    buffer_load_dwordx4 v12, s[20:23], s3 offen lds
    v_mfma_f32_16x16x32_bf16 v[72:75], a[160:163], a[116:119], v[72:75]
    s_add_u32 s79, s79, 1
    v_mfma_f32_16x16x32_bf16 v[80:83], a[160:163], a[120:123], v[80:83]
    s_and_b32 s79, s79, 31
    v_mfma_f32_16x16x32_bf16 v[88:91], a[160:163], a[124:127], v[88:91]
    s_lshl_b32 s59, s79, 6
    v_mfma_f32_16x16x32_bf16 v[68:71], a[164:167], a[112:115], v[68:71]
    s_mul_i32 s60, s79, 196608
    v_mfma_f32_16x16x32_bf16 v[76:79], a[164:167], a[116:119], v[76:79]
    s_mul_i32 s61, s79, 229376
    v_mfma_f32_16x16x32_bf16 v[84:87], a[164:167], a[120:123], v[84:87]
    s_mul_i32 s62, s79, s58
    v_mfma_f32_16x16x32_bf16 v[92:95], a[164:167], a[124:127], v[92:95]
    s_waitcnt vmcnt(18) lgkmcnt(0)
    s_barrier
    v_mfma_f32_16x16x32_bf16 v[96:99], a[168:171], a[112:115], v[96:99]
    ds_read_b128 a[96:99], v14 offset:0
    v_mfma_f32_16x16x32_bf16 v[104:107], a[168:171], a[116:119], v[104:107]
    ds_read_b128 a[100:103], v14 offset:1024
    v_mfma_f32_16x16x32_bf16 v[112:115], a[168:171], a[120:123], v[112:115]
    s_add_u32 m0, s45, 110592
    v_mfma_f32_16x16x32_bf16 v[120:123], a[168:171], a[124:127], v[120:123]
    ds_read_b128 a[104:107], v14 offset:2048
    v_mfma_f32_16x16x32_bf16 v[100:103], a[172:175], a[112:115], v[100:103]
    ds_read_b128 a[108:111], v14 offset:3072
    v_mfma_f32_16x16x32_bf16 v[108:111], a[172:175], a[116:119], v[108:111]
    s_add_u32 s3, s59, 0
    v_mfma_f32_16x16x32_bf16 v[116:119], a[172:175], a[120:123], v[116:119]
    ds_read_b64_tr_b16 a[128:129], v18 offset:0
    v_mfma_f32_16x16x32_bf16 v[124:127], a[172:175], a[124:127], v[124:127]
    ds_read_b64_tr_b16 a[130:131], v18 offset:256
    v_mfma_f32_16x16x32_bf16 v[128:131], a[176:179], a[112:115], v[128:131]
    buffer_load_dwordx4 v10, s[4:7], s3 offen lds
    v_mfma_f32_16x16x32_bf16 v[136:139], a[176:179], a[116:119], v[136:139]
    ds_read_b64_tr_b16 a[132:133], v19 offset:0
    v_mfma_f32_16x16x32_bf16 v[144:147], a[176:179], a[120:123], v[144:147]
    ds_read_b64_tr_b16 a[134:135], v19 offset:256
    v_mfma_f32_16x16x32_bf16 v[152:155], a[176:179], a[124:127], v[152:155]
    s_add_u32 m0, s46, 110592
    v_mfma_f32_16x16x32_bf16 v[132:135], a[180:183], a[112:115], v[132:135]
    ds_read_b64_tr_b16 a[136:137], v18 offset:2048
    v_mfma_f32_16x16x32_bf16 v[140:143], a[180:183], a[116:119], v[140:143]
    ds_read_b64_tr_b16 a[138:139], v18 offset:2304
    v_mfma_f32_16x16x32_bf16 v[148:151], a[180:183], a[120:123], v[148:151]
    s_add_u32 s3, s60, s74
    v_mfma_f32_16x16x32_bf16 v[156:159], a[180:183], a[124:127], v[156:159]
    ds_read_b64_tr_b16 a[140:141], v19 offset:2048
    v_mfma_f32_16x16x32_bf16 v[160:163], a[184:187], a[112:115], v[160:163]
    ds_read_b64_tr_b16 a[142:143], v19 offset:2304
    v_mfma_f32_16x16x32_bf16 v[168:171], a[184:187], a[116:119], v[168:171]
    buffer_load_dwordx4 v11, s[8:11], s3 offen lds
    v_mfma_f32_16x16x32_bf16 v[176:179], a[184:187], a[120:123], v[176:179]
    ds_read_b64_tr_b16 a[144:145], v18 offset:4096
    v_mfma_f32_16x16x32_bf16 v[184:187], a[184:187], a[124:127], v[184:187]
    ds_read_b64_tr_b16 a[146:147], v18 offset:4352
    v_mfma_f32_16x16x32_bf16 v[164:167], a[188:191], a[112:115], v[164:167]
    s_add_u32 m0, s45, 111616
    v_mfma_f32_16x16x32_bf16 v[172:175], a[188:191], a[116:119], v[172:175]
    ds_read_b64_tr_b16 a[148:149], v19 offset:4096
    v_mfma_f32_16x16x32_bf16 v[180:183], a[188:191], a[120:123], v[180:183]
    ds_read_b64_tr_b16 a[150:151], v19 offset:4352
    v_mfma_f32_16x16x32_bf16 v[188:191], a[188:191], a[124:127], v[188:191]
    s_add_u32 s3, s59, 32768
    v_mfma_f32_16x16x32_bf16 v[192:195], a[192:195], a[112:115], v[192:195]
    ds_read_b64_tr_b16 a[152:153], v18 offset:6144
    v_mfma_f32_16x16x32_bf16 v[200:203], a[192:195], a[116:119], v[200:203]
    ds_read_b64_tr_b16 a[154:155], v18 offset:6400
    v_mfma_f32_16x16x32_bf16 v[208:211], a[192:195], a[120:123], v[208:211]
    buffer_load_dwordx4 v10, s[4:7], s3 offen lds
    v_mfma_f32_16x16x32_bf16 v[216:219], a[192:195], a[124:127], v[216:219]
    ds_read_b64_tr_b16 a[156:157], v19 offset:6144
    v_mfma_f32_16x16x32_bf16 v[196:199], a[196:199], a[112:115], v[196:199]
    ds_read_b64_tr_b16 a[158:159], v19 offset:6400
    v_mfma_f32_16x16x32_bf16 v[204:207], a[196:199], a[116:119], v[204:207]
    s_add_u32 m0, s46, 114688
    v_mfma_f32_16x16x32_bf16 v[212:215], a[196:199], a[120:123], v[212:215]
    ds_read_b64_tr_b16 a[160:161], v18 offset:8192
    v_mfma_f32_16x16x32_bf16 v[220:223], a[196:199], a[124:127], v[220:223]
    ds_read_b64_tr_b16 a[162:163], v18 offset:8448
    v_mfma_f32_16x16x32_bf16 v[224:227], a[200:203], a[112:115], v[224:227]
    s_add_u32 s3, s62, s75
    v_mfma_f32_16x16x32_bf16 v[232:235], a[200:203], a[116:119], v[232:235]
    ds_read_b64_tr_b16 a[164:165], v19 offset:8192
    v_mfma_f32_16x16x32_bf16 v[240:243], a[200:203], a[120:123], v[240:243]
    ds_read_b64_tr_b16 a[166:167], v19 offset:8448
    v_mfma_f32_16x16x32_bf16 v[248:251], a[200:203], a[124:127], v[248:251]
    buffer_load_dwordx4 v13, s[24:27], s3 offen lds
    v_mfma_f32_16x16x32_bf16 v[228:231], a[204:207], a[112:115], v[228:231]
    s_add_u32 m0, s45, 112640
    v_mfma_f32_16x16x32_bf16 v[236:239], a[204:207], a[116:119], v[236:239]
    s_add_u32 s3, s59, 65536
    v_mfma_f32_16x16x32_bf16 v[244:247], a[204:207], a[120:123], v[244:247]
    buffer_load_dwordx4 v10, s[4:7], s3 offen lds
    v_mfma_f32_16x16x32_bf16 v[252:255], a[204:207], a[124:127], v[252:255]
    s_waitcnt lgkmcnt(0)
    v_mfma_f32_16x16x32_bf16 a[0:3], a[96:99], a[128:131], a[0:3]
    ds_read_b64_tr_b16 a[168:169], v18 offset:10240
    v_mfma_f32_16x16x32_bf16 a[8:11], a[100:103], a[128:131], a[8:11]
    ds_read_b64_tr_b16 a[170:171], v18 offset:10496
    v_mfma_f32_16x16x32_bf16 a[16:19], a[104:107], a[128:131], a[16:19]
    s_add_u32 m0, s46, 118784
    v_mfma_f32_16x16x32_bf16 a[24:27], a[108:111], a[128:131], a[24:27]
    ds_read_b64_tr_b16 a[172:173], v19 offset:10240
    v_mfma_f32_16x16x32_bf16 a[4:7], a[96:99], a[132:135], a[4:7]
    ds_read_b64_tr_b16 a[174:175], v19 offset:10496
    v_mfma_f32_16x16x32_bf16 a[12:15], a[100:103], a[132:135], a[12:15]
    s_add_u32 s3, s61, s76
    v_mfma_f32_16x16x32_bf16 a[20:23], a[104:107], a[132:135], a[20:23]
    ds_read_b64_tr_b16 a[176:177], v18 offset:12288
    v_mfma_f32_16x16x32_bf16 a[28:31], a[108:111], a[132:135], a[28:31]
    ds_read_b64_tr_b16 a[178:179], v18 offset:12544
    v_mfma_f32_16x16x32_bf16 a[32:35], a[96:99], a[136:139], a[32:35]
    buffer_load_dwordx4 v12, s[20:23], s3 offen lds
    v_mfma_f32_16x16x32_bf16 a[40:43], a[100:103], a[136:139], a[40:43]
    ds_read_b64_tr_b16 a[180:181], v19 offset:12288
    v_mfma_f32_16x16x32_bf16 a[48:51], a[104:107], a[136:139], a[48:51]
    ds_read_b64_tr_b16 a[182:183], v19 offset:12544
    v_mfma_f32_16x16x32_bf16 a[56:59], a[108:111], a[136:139], a[56:59]
    s_add_u32 m0, s45, 113664
    v_mfma_f32_16x16x32_bf16 a[36:39], a[96:99], a[140:143], a[36:39]
    ds_read_b64_tr_b16 a[184:185], v18 offset:14336
    v_mfma_f32_16x16x32_bf16 a[44:47], a[100:103], a[140:143], a[44:47]
    ds_read_b64_tr_b16 a[186:187], v18 offset:14592
    v_mfma_f32_16x16x32_bf16 a[52:55], a[104:107], a[140:143], a[52:55]
    s_add_u32 s3, s59, 98304
    v_mfma_f32_16x16x32_bf16 a[60:63], a[108:111], a[140:143], a[60:63]
    ds_read_b64_tr_b16 a[188:189], v19 offset:14336
    v_mfma_f32_16x16x32_bf16 a[64:67], a[144:147], a[96:99], a[64:67]
    ds_read_b64_tr_b16 a[190:191], v19 offset:14592
    v_mfma_f32_16x16x32_bf16 a[72:75], a[144:147], a[100:103], a[72:75]
    buffer_load_dwordx4 v10, s[4:7], s3 offen lds
    v_mfma_f32_16x16x32_bf16 a[80:83], a[144:147], a[104:107], a[80:83]
    ds_read_b64_tr_b16 a[192:193], v18 offset:16384
    v_mfma_f32_16x16x32_bf16 a[88:91], a[144:147], a[108:111], a[88:91]
    ds_read_b64_tr_b16 a[194:195], v18 offset:16640
    v_mfma_f32_16x16x32_bf16 a[68:71], a[148:151], a[96:99], a[68:71]
    s_add_u32 m0, s46, 122880
    v_mfma_f32_16x16x32_bf16 a[76:79], a[148:151], a[100:103], a[76:79]
    ds_read_b64_tr_b16 a[196:197], v19 offset:16384
    v_mfma_f32_16x16x32_bf16 a[84:87], a[148:151], a[104:107], a[84:87]
    ds_read_b64_tr_b16 a[198:199], v19 offset:16640
    v_mfma_f32_16x16x32_bf16 a[92:95], a[148:151], a[108:111], a[92:95]
    s_add_u32 s3, s61, s77
    v_mfma_f32_16x16x32_bf16 v[32:35], a[152:155], a[96:99], v[32:35]
    ds_read_b64_tr_b16 a[200:201], v18 offset:18432
    v_mfma_f32_16x16x32_bf16 v[40:43], a[152:155], a[100:103], v[40:43]
    ds_read_b64_tr_b16 a[202:203], v18 offset:18688
    v_mfma_f32_16x16x32_bf16 v[48:51], a[152:155], a[104:107], v[48:51]
    buffer_load_dwordx4 v12, s[20:23], s3 offen lds
    v_mfma_f32_16x16x32_bf16 v[56:59], a[152:155], a[108:111], v[56:59]
    ds_read_b64_tr_b16 a[204:205], v19 offset:18432
    v_mfma_f32_16x16x32_bf16 v[36:39], a[156:159], a[96:99], v[36:39]
    ds_read_b64_tr_b16 a[206:207], v19 offset:18688
    v_mfma_f32_16x16x32_bf16 v[44:47], a[156:159], a[100:103], v[44:47]
    v_mfma_f32_16x16x32_bf16 v[52:55], a[156:159], a[104:107], v[52:55]
    s_add_u32 m0, s46, 126976
    v_mfma_f32_16x16x32_bf16 v[60:63], a[156:159], a[108:111], v[60:63]
    s_add_u32 s3, s61, s78
    v_mfma_f32_16x16x32_bf16 v[64:67], a[160:163], a[96:99], v[64:67]
    buffer_load_dwordx4 v12, s[20:23], s3 offen lds
    v_mfma_f32_16x16x32_bf16 v[72:75], a[160:163], a[100:103], v[72:75]
    s_add_u32 s79, s79, 1
    v_mfma_f32_16x16x32_bf16 v[80:83], a[160:163], a[104:107], v[80:83]
    s_and_b32 s79, s79, 31
    v_mfma_f32_16x16x32_bf16 v[88:91], a[160:163], a[108:111], v[88:91]
    s_lshl_b32 s59, s79, 6
    v_mfma_f32_16x16x32_bf16 v[68:71], a[164:167], a[96:99], v[68:71]
    s_mul_i32 s60, s79, 196608
    v_mfma_f32_16x16x32_bf16 v[76:79], a[164:167], a[100:103], v[76:79]
    s_mul_i32 s61, s79, 229376
    v_mfma_f32_16x16x32_bf16 v[84:87], a[164:167], a[104:107], v[84:87]
    s_mul_i32 s62, s79, s58
    v_mfma_f32_16x16x32_bf16 v[92:95], a[164:167], a[108:111], v[92:95]
    s_waitcnt vmcnt(18) lgkmcnt(0)
    s_barrier
    v_mfma_f32_16x16x32_bf16 v[96:99], a[168:171], a[96:99], v[96:99]
    ds_read_b128 a[112:115], v15 offset:0
    v_mfma_f32_16x16x32_bf16 v[104:107], a[168:171], a[100:103], v[104:107]
    ds_read_b128 a[116:119], v15 offset:1024
    v_mfma_f32_16x16x32_bf16 v[112:115], a[168:171], a[104:107], v[112:115]
    s_add_u32 m0, s45, 0
    v_mfma_f32_16x16x32_bf16 v[120:123], a[168:171], a[108:111], v[120:123]
    ds_read_b128 a[120:123], v15 offset:2048
    v_mfma_f32_16x16x32_bf16 v[100:103], a[172:175], a[96:99], v[100:103]
    ds_read_b128 a[124:127], v15 offset:3072
    v_mfma_f32_16x16x32_bf16 v[108:111], a[172:175], a[100:103], v[108:111]
    s_add_u32 s3, s59, 0
    v_mfma_f32_16x16x32_bf16 v[116:119], a[172:175], a[104:107], v[116:119]
    ds_read_b64_tr_b16 a[128:129], v20 offset:0
    v_mfma_f32_16x16x32_bf16 v[124:127], a[172:175], a[108:111], v[124:127]
    ds_read_b64_tr_b16 a[130:131], v20 offset:256
    v_mfma_f32_16x16x32_bf16 v[128:131], a[176:179], a[96:99], v[128:131]
    buffer_load_dwordx4 v10, s[4:7], s3 offen lds
    v_mfma_f32_16x16x32_bf16 v[136:139], a[176:179], a[100:103], v[136:139]
    ds_read_b64_tr_b16 a[132:133], v21 offset:0
    v_mfma_f32_16x16x32_bf16 v[144:147], a[176:179], a[104:107], v[144:147]
    ds_read_b64_tr_b16 a[134:135], v21 offset:256
    v_mfma_f32_16x16x32_bf16 v[152:155], a[176:179], a[108:111], v[152:155]
    s_add_u32 m0, s46, 0
    v_mfma_f32_16x16x32_bf16 v[132:135], a[180:183], a[96:99], v[132:135]
    ds_read_b64_tr_b16 a[136:137], v20 offset:2048
    v_mfma_f32_16x16x32_bf16 v[140:143], a[180:183], a[100:103], v[140:143]
    ds_read_b64_tr_b16 a[138:139], v20 offset:2304
    v_mfma_f32_16x16x32_bf16 v[148:151], a[180:183], a[104:107], v[148:151]
    s_add_u32 s3, s60, s74
    v_mfma_f32_16x16x32_bf16 v[156:159], a[180:183], a[108:111], v[156:159]
    ds_read_b64_tr_b16 a[140:141], v21 offset:2048
    v_mfma_f32_16x16x32_bf16 v[160:163], a[184:187], a[96:99], v[160:163]
    ds_read_b64_tr_b16 a[142:143], v21 offset:2304
    v_mfma_f32_16x16x32_bf16 v[168:171], a[184:187], a[100:103], v[168:171]
    buffer_load_dwordx4 v11, s[8:11], s3 offen lds
    v_mfma_f32_16x16x32_bf16 v[176:179], a[184:187], a[104:107], v[176:179]
    ds_read_b64_tr_b16 a[144:145], v20 offset:4096
    v_mfma_f32_16x16x32_bf16 v[184:187], a[184:187], a[108:111], v[184:187]
    ds_read_b64_tr_b16 a[146:147], v20 offset:4352
    v_mfma_f32_16x16x32_bf16 v[164:167], a[188:191], a[96:99], v[164:167]
    s_add_u32 m0, s45, 1024
    v_mfma_f32_16x16x32_bf16 v[172:175], a[188:191], a[100:103], v[172:175]
    ds_read_b64_tr_b16 a[148:149], v21 offset:4096
    v_mfma_f32_16x16x32_bf16 v[180:183], a[188:191], a[104:107], v[180:183]
    ds_read_b64_tr_b16 a[150:151], v21 offset:4352
    v_mfma_f32_16x16x32_bf16 v[188:191], a[188:191], a[108:111], v[188:191]
    s_add_u32 s3, s59, 32768
    v_mfma_f32_16x16x32_bf16 v[192:195], a[192:195], a[96:99], v[192:195]
    ds_read_b64_tr_b16 a[152:153], v20 offset:6144
    v_mfma_f32_16x16x32_bf16 v[200:203], a[192:195], a[100:103], v[200:203]
    ds_read_b64_tr_b16 a[154:155], v20 offset:6400
    v_mfma_f32_16x16x32_bf16 v[208:211], a[192:195], a[104:107], v[208:211]
    buffer_load_dwordx4 v10, s[4:7], s3 offen lds
    v_mfma_f32_16x16x32_bf16 v[216:219], a[192:195], a[108:111], v[216:219]
    ds_read_b64_tr_b16 a[156:157], v21 offset:6144
    v_mfma_f32_16x16x32_bf16 v[196:199], a[196:199], a[96:99], v[196:199]
    ds_read_b64_tr_b16 a[158:159], v21 offset:6400
    v_mfma_f32_16x16x32_bf16 v[204:207], a[196:199], a[100:103], v[204:207]
    s_add_u32 m0, s46, 4096
    v_mfma_f32_16x16x32_bf16 v[212:215], a[196:199], a[104:107], v[212:215]
    ds_read_b64_tr_b16 a[160:161], v20 offset:8192
    v_mfma_f32_16x16x32_bf16 v[220:223], a[196:199], a[108:111], v[220:223]
    ds_read_b64_tr_b16 a[162:163], v20 offset:8448
    v_mfma_f32_16x16x32_bf16 v[224:227], a[200:203], a[96:99], v[224:227]
    s_add_u32 s3, s62, s75
    v_mfma_f32_16x16x32_bf16 v[232:235], a[200:203], a[100:103], v[232:235]
    ds_read_b64_tr_b16 a[164:165], v21 offset:8192
    v_mfma_f32_16x16x32_bf16 v[240:243], a[200:203], a[104:107], v[240:243]
    ds_read_b64_tr_b16 a[166:167], v21 offset:8448
    v_mfma_f32_16x16x32_bf16 v[248:251], a[200:203], a[108:111], v[248:251]
    buffer_load_dwordx4 v13, s[24:27], s3 offen lds
    v_mfma_f32_16x16x32_bf16 v[228:231], a[204:207], a[96:99], v[228:231]
    s_add_u32 m0, s45, 2048
    v_mfma_f32_16x16x32_bf16 v[236:239], a[204:207], a[100:103], v[236:239]
    s_add_u32 s3, s59, 65536
    v_mfma_f32_16x16x32_bf16 v[244:247], a[204:207], a[104:107], v[244:247]
    buffer_load_dwordx4 v10, s[4:7], s3 offen lds
    v_mfma_f32_16x16x32_bf16 v[252:255], a[204:207], a[108:111], v[252:255]
    s_add_u32 s63, s63, 1
    s_cmp_lt_u32 s63, 6
    s_cbranch_scc1 K1_LOOP
    s_waitcnt lgkmcnt(0)
    v_mfma_f32_16x16x32_bf16 a[0:3], a[112:115], a[128:131], a[0:3]
    ds_read_b64_tr_b16 a[168:169], v20 offset:10240
    v_mfma_f32_16x16x32_bf16 a[8:11], a[116:119], a[128:131], a[8:11]
    ds_read_b64_tr_b16 a[170:171], v20 offset:10496
    v_mfma_f32_16x16x32_bf16 a[16:19], a[120:123], a[128:131], a[16:19]
    s_add_u32 m0, s46, 8192
    v_mfma_f32_16x16x32_bf16 a[24:27], a[124:127], a[128:131], a[24:27]
    ds_read_b64_tr_b16 a[172:173], v21 offset:10240
    v_mfma_f32_16x16x32_bf16 a[4:7], a[112:115], a[132:135], a[4:7]
    ds_read_b64_tr_b16 a[174:175], v21 offset:10496
    v_mfma_f32_16x16x32_bf16 a[12:15], a[116:119], a[132:135], a[12:15]
    s_add_u32 s3, s61, s76
    v_mfma_f32_16x16x32_bf16 a[20:23], a[120:123], a[132:135], a[20:23]
    ds_read_b64_tr_b16 a[176:177], v20 offset:12288
    v_mfma_f32_16x16x32_bf16 a[28:31], a[124:127], a[132:135], a[28:31]
    ds_read_b64_tr_b16 a[178:179], v20 offset:12544
    v_mfma_f32_16x16x32_bf16 a[32:35], a[112:115], a[136:139], a[32:35]
    buffer_load_dwordx4 v12, s[20:23], s3 offen lds
    v_mfma_f32_16x16x32_bf16 a[40:43], a[116:119], a[136:139], a[40:43]
    ds_read_b64_tr_b16 a[180:181], v21 offset:12288
    v_mfma_f32_16x16x32_bf16 a[48:51], a[120:123], a[136:139], a[48:51]
    ds_read_b64_tr_b16 a[182:183], v21 offset:12544
    v_mfma_f32_16x16x32_bf16 a[56:59], a[124:127], a[136:139], a[56:59]
    s_add_u32 m0, s45, 3072
    v_mfma_f32_16x16x32_bf16 a[36:39], a[112:115], a[140:143], a[36:39]
    ds_read_b64_tr_b16 a[184:185], v20 offset:14336
    v_mfma_f32_16x16x32_bf16 a[44:47], a[116:119], a[140:143], a[44:47]
    ds_read_b64_tr_b16 a[186:187], v20 offset:14592
    v_mfma_f32_16x16x32_bf16 a[52:55], a[120:123], a[140:143], a[52:55]
    s_add_u32 s3, s59, 98304
    v_mfma_f32_16x16x32_bf16 a[60:63], a[124:127], a[140:143], a[60:63]
    ds_read_b64_tr_b16 a[188:189], v21 offset:14336
    v_mfma_f32_16x16x32_bf16 a[64:67], a[144:147], a[112:115], a[64:67]
    ds_read_b64_tr_b16 a[190:191], v21 offset:14592
    v_mfma_f32_16x16x32_bf16 a[72:75], a[144:147], a[116:119], a[72:75]
    buffer_load_dwordx4 v10, s[4:7], s3 offen lds
    v_mfma_f32_16x16x32_bf16 a[80:83], a[144:147], a[120:123], a[80:83]
    ds_read_b64_tr_b16 a[192:193], v20 offset:16384
    v_mfma_f32_16x16x32_bf16 a[88:91], a[144:147], a[124:127], a[88:91]
    ds_read_b64_tr_b16 a[194:195], v20 offset:16640
    v_mfma_f32_16x16x32_bf16 a[68:71], a[148:151], a[112:115], a[68:71]
    s_add_u32 m0, s46, 12288
    v_mfma_f32_16x16x32_bf16 a[76:79], a[148:151], a[116:119], a[76:79]
    ds_read_b64_tr_b16 a[196:197], v21 offset:16384
    v_mfma_f32_16x16x32_bf16 a[84:87], a[148:151], a[120:123], a[84:87]
    ds_read_b64_tr_b16 a[198:199], v21 offset:16640
    v_mfma_f32_16x16x32_bf16 a[92:95], a[148:151], a[124:127], a[92:95]
    s_add_u32 s3, s61, s77
    v_mfma_f32_16x16x32_bf16 v[32:35], a[152:155], a[112:115], v[32:35]
    ds_read_b64_tr_b16 a[200:201], v20 offset:18432
    v_mfma_f32_16x16x32_bf16 v[40:43], a[152:155], a[116:119], v[40:43]
    ds_read_b64_tr_b16 a[202:203], v20 offset:18688
    v_mfma_f32_16x16x32_bf16 v[48:51], a[152:155], a[120:123], v[48:51]
    buffer_load_dwordx4 v12, s[20:23], s3 offen lds
    v_mfma_f32_16x16x32_bf16 v[56:59], a[152:155], a[124:127], v[56:59]
    ds_read_b64_tr_b16 a[204:205], v21 offset:18432
    v_mfma_f32_16x16x32_bf16 v[36:39], a[156:159], a[112:115], v[36:39]
    ds_read_b64_tr_b16 a[206:207], v21 offset:18688
    v_mfma_f32_16x16x32_bf16 v[44:47], a[156:159], a[116:119], v[44:47]
    v_mfma_f32_16x16x32_bf16 v[52:55], a[156:159], a[120:123], v[52:55]
    s_add_u32 m0, s46, 16384
    v_mfma_f32_16x16x32_bf16 v[60:63], a[156:159], a[124:127], v[60:63]
    s_add_u32 s3, s61, s78
    v_mfma_f32_16x16x32_bf16 v[64:67], a[160:163], a[112:115], v[64:67]
    buffer_load_dwordx4 v12, s[20:23], s3 offen lds
    v_mfma_f32_16x16x32_bf16 v[72:75], a[160:163], a[116:119], v[72:75]
    s_add_u32 s79, s79, 1
    v_mfma_f32_16x16x32_bf16 v[80:83], a[160:163], a[120:123], v[80:83]
    s_and_b32 s79, s79, 31
    v_mfma_f32_16x16x32_bf16 v[88:91], a[160:163], a[124:127], v[88:91]
    s_lshl_b32 s59, s79, 6
    v_mfma_f32_16x16x32_bf16 v[68:71], a[164:167], a[112:115], v[68:71]
    s_mul_i32 s60, s79, 196608
    v_mfma_f32_16x16x32_bf16 v[76:79], a[164:167], a[116:119], v[76:79]
    s_mul_i32 s61, s79, 229376
    v_mfma_f32_16x16x32_bf16 v[84:87], a[164:167], a[120:123], v[84:87]
    s_mul_i32 s62, s79, s58
    v_mfma_f32_16x16x32_bf16 v[92:95], a[164:167], a[124:127], v[92:95]
    s_waitcnt vmcnt(18) lgkmcnt(0)
    s_barrier
    v_mfma_f32_16x16x32_bf16 v[96:99], a[168:171], a[112:115], v[96:99]
    ds_read_b128 a[96:99], v16 offset:0
    v_mfma_f32_16x16x32_bf16 v[104:107], a[168:171], a[116:119], v[104:107]
    ds_read_b128 a[100:103], v16 offset:1024
    v_mfma_f32_16x16x32_bf16 v[112:115], a[168:171], a[120:123], v[112:115]
    s_add_u32 m0, s45, 36864
    v_mfma_f32_16x16x32_bf16 v[120:123], a[168:171], a[124:127], v[120:123]
    ds_read_b128 a[104:107], v16 offset:2048
    v_mfma_f32_16x16x32_bf16 v[100:103], a[172:175], a[112:115], v[100:103]
    ds_read_b128 a[108:111], v16 offset:3072
    v_mfma_f32_16x16x32_bf16 v[108:111], a[172:175], a[116:119], v[108:111]
    s_add_u32 s3, s59, 0
    v_mfma_f32_16x16x32_bf16 v[116:119], a[172:175], a[120:123], v[116:119]
    ds_read_b64_tr_b16 a[128:129], v22 offset:0
    v_mfma_f32_16x16x32_bf16 v[124:127], a[172:175], a[124:127], v[124:127]
    ds_read_b64_tr_b16 a[130:131], v22 offset:256
    v_mfma_f32_16x16x32_bf16 v[128:131], a[176:179], a[112:115], v[128:131]
    buffer_load_dwordx4 v10, s[4:7], s3 offen lds
    v_mfma_f32_16x16x32_bf16 v[136:139], a[176:179], a[116:119], v[136:139]
    ds_read_b64_tr_b16 a[132:133], v23 offset:0
    v_mfma_f32_16x16x32_bf16 v[144:147], a[176:179], a[120:123], v[144:147]
    ds_read_b64_tr_b16 a[134:135], v23 offset:256
    v_mfma_f32_16x16x32_bf16 v[152:155], a[176:179], a[124:127], v[152:155]
    s_add_u32 m0, s46, 36864
    v_mfma_f32_16x16x32_bf16 v[132:135], a[180:183], a[112:115], v[132:135]
    ds_read_b64_tr_b16 a[136:137], v22 offset:2048
    v_mfma_f32_16x16x32_bf16 v[140:143], a[180:183], a[116:119], v[140:143]
    ds_read_b64_tr_b16 a[138:139], v22 offset:2304
    v_mfma_f32_16x16x32_bf16 v[148:151], a[180:183], a[120:123], v[148:151]
    s_add_u32 s3, s60, s74
    v_mfma_f32_16x16x32_bf16 v[156:159], a[180:183], a[124:127], v[156:159]
    ds_read_b64_tr_b16 a[140:141], v23 offset:2048
    v_mfma_f32_16x16x32_bf16 v[160:163], a[184:187], a[112:115], v[160:163]
    ds_read_b64_tr_b16 a[142:143], v23 offset:2304
    v_mfma_f32_16x16x32_bf16 v[168:171], a[184:187], a[116:119], v[168:171]
    buffer_load_dwordx4 v11, s[8:11], s3 offen lds
    v_mfma_f32_16x16x32_bf16 v[176:179], a[184:187], a[120:123], v[176:179]
    ds_read_b64_tr_b16 a[144:145], v22 offset:4096
    v_mfma_f32_16x16x32_bf16 v[184:187], a[184:187], a[124:127], v[184:187]
    ds_read_b64_tr_b16 a[146:147], v22 offset:4352
    v_mfma_f32_16x16x32_bf16 v[164:167], a[188:191], a[112:115], v[164:167]
    s_add_u32 m0, s45, 37888
    v_mfma_f32_16x16x32_bf16 v[172:175], a[188:191], a[116:119], v[172:175]
    ds_read_b64_tr_b16 a[148:149], v23 offset:4096
    v_mfma_f32_16x16x32_bf16 v[180:183], a[188:191], a[120:123], v[180:183]
    ds_read_b64_tr_b16 a[150:151], v23 offset:4352
    v_mfma_f32_16x16x32_bf16 v[188:191], a[188:191], a[124:127], v[188:191]
    s_add_u32 s3, s59, 32768
    v_mfma_f32_16x16x32_bf16 v[192:195], a[192:195], a[112:115], v[192:195]
    ds_read_b64_tr_b16 a[152:153], v22 offset:6144
    v_mfma_f32_16x16x32_bf16 v[200:203], a[192:195], a[116:119], v[200:203]
    ds_read_b64_tr_b16 a[154:155], v22 offset:6400
    v_mfma_f32_16x16x32_bf16 v[208:211], a[192:195], a[120:123], v[208:211]
    buffer_load_dwordx4 v10, s[4:7], s3 offen lds
    v_mfma_f32_16x16x32_bf16 v[216:219], a[192:195], a[124:127], v[216:219]
    ds_read_b64_tr_b16 a[156:157], v23 offset:6144
    v_mfma_f32_16x16x32_bf16 v[196:199], a[196:199], a[112:115], v[196:199]
    ds_read_b64_tr_b16 a[158:159], v23 offset:6400
    v_mfma_f32_16x16x32_bf16 v[204:207], a[196:199], a[116:119], v[204:207]
    s_add_u32 m0, s46, 40960
    v_mfma_f32_16x16x32_bf16 v[212:215], a[196:199], a[120:123], v[212:215]
    ds_read_b64_tr_b16 a[160:161], v22 offset:8192
    v_mfma_f32_16x16x32_bf16 v[220:223], a[196:199], a[124:127], v[220:223]
    ds_read_b64_tr_b16 a[162:163], v22 offset:8448
    v_mfma_f32_16x16x32_bf16 v[224:227], a[200:203], a[112:115], v[224:227]
    s_add_u32 s3, s62, s75
    v_mfma_f32_16x16x32_bf16 v[232:235], a[200:203], a[116:119], v[232:235]
    ds_read_b64_tr_b16 a[164:165], v23 offset:8192
    v_mfma_f32_16x16x32_bf16 v[240:243], a[200:203], a[120:123], v[240:243]
    ds_read_b64_tr_b16 a[166:167], v23 offset:8448
    v_mfma_f32_16x16x32_bf16 v[248:251], a[200:203], a[124:127], v[248:251]
    buffer_load_dwordx4 v13, s[24:27], s3 offen lds
    v_mfma_f32_16x16x32_bf16 v[228:231], a[204:207], a[112:115], v[228:231]
    s_add_u32 m0, s45, 38912
    v_mfma_f32_16x16x32_bf16 v[236:239], a[204:207], a[116:119], v[236:239]
    s_add_u32 s3, s59, 65536
    v_mfma_f32_16x16x32_bf16 v[244:247], a[204:207], a[120:123], v[244:247]
    buffer_load_dwordx4 v10, s[4:7], s3 offen lds
    v_mfma_f32_16x16x32_bf16 v[252:255], a[204:207], a[124:127], v[252:255]
    s_waitcnt lgkmcnt(0)
    v_mfma_f32_16x16x32_bf16 a[0:3], a[96:99], a[128:131], a[0:3]
    ds_read_b64_tr_b16 a[168:169], v22 offset:10240
    v_mfma_f32_16x16x32_bf16 a[8:11], a[100:103], a[128:131], a[8:11]
    ds_read_b64_tr_b16 a[170:171], v22 offset:10496
    v_mfma_f32_16x16x32_bf16 a[16:19], a[104:107], a[128:131], a[16:19]
    s_add_u32 m0, s46, 45056
    v_mfma_f32_16x16x32_bf16 a[24:27], a[108:111], a[128:131], a[24:27]
    ds_read_b64_tr_b16 a[172:173], v23 offset:10240
    v_mfma_f32_16x16x32_bf16 a[4:7], a[96:99], a[132:135], a[4:7]
    ds_read_b64_tr_b16 a[174:175], v23 offset:10496
    v_mfma_f32_16x16x32_bf16 a[12:15], a[100:103], a[132:135], a[12:15]
    s_add_u32 s3, s61, s76
    v_mfma_f32_16x16x32_bf16 a[20:23], a[104:107], a[132:135], a[20:23]
    ds_read_b64_tr_b16 a[176:177], v22 offset:12288
    v_mfma_f32_16x16x32_bf16 a[28:31], a[108:111], a[132:135], a[28:31]
    ds_read_b64_tr_b16 a[178:179], v22 offset:12544
    v_mfma_f32_16x16x32_bf16 a[32:35], a[96:99], a[136:139], a[32:35]
    buffer_load_dwordx4 v12, s[20:23], s3 offen lds
    v_mfma_f32_16x16x32_bf16 a[40:43], a[100:103], a[136:139], a[40:43]
    ds_read_b64_tr_b16 a[180:181], v23 offset:12288
    v_mfma_f32_16x16x32_bf16 a[48:51], a[104:107], a[136:139], a[48:51]
    ds_read_b64_tr_b16 a[182:183], v23 offset:12544
    v_mfma_f32_16x16x32_bf16 a[56:59], a[108:111], a[136:139], a[56:59]
    s_add_u32 m0, s45, 39936
    v_mfma_f32_16x16x32_bf16 a[36:39], a[96:99], a[140:143], a[36:39]
    ds_read_b64_tr_b16 a[184:185], v22 offset:14336
    v_mfma_f32_16x16x32_bf16 a[44:47], a[100:103], a[140:143], a[44:47]
    ds_read_b64_tr_b16 a[186:187], v22 offset:14592
    v_mfma_f32_16x16x32_bf16 a[52:55], a[104:107], a[140:143], a[52:55]
    s_add_u32 s3, s59, 98304
    v_mfma_f32_16x16x32_bf16 a[60:63], a[108:111], a[140:143], a[60:63]
    ds_read_b64_tr_b16 a[188:189], v23 offset:14336
    v_mfma_f32_16x16x32_bf16 a[64:67], a[144:147], a[96:99], a[64:67]
    ds_read_b64_tr_b16 a[190:191], v23 offset:14592
    v_mfma_f32_16x16x32_bf16 a[72:75], a[144:147], a[100:103], a[72:75]
    buffer_load_dwordx4 v10, s[4:7], s3 offen lds
    v_mfma_f32_16x16x32_bf16 a[80:83], a[144:147], a[104:107], a[80:83]
    ds_read_b64_tr_b16 a[192:193], v22 offset:16384
    v_mfma_f32_16x16x32_bf16 a[88:91], a[144:147], a[108:111], a[88:91]
    ds_read_b64_tr_b16 a[194:195], v22 offset:16640
    v_mfma_f32_16x16x32_bf16 a[68:71], a[148:151], a[96:99], a[68:71]
    s_add_u32 m0, s46, 49152
    v_mfma_f32_16x16x32_bf16 a[76:79], a[148:151], a[100:103], a[76:79]
    ds_read_b64_tr_b16 a[196:197], v23 offset:16384
    v_mfma_f32_16x16x32_bf16 a[84:87], a[148:151], a[104:107], a[84:87]
    ds_read_b64_tr_b16 a[198:199], v23 offset:16640
    v_mfma_f32_16x16x32_bf16 a[92:95], a[148:151], a[108:111], a[92:95]
    s_add_u32 s3, s61, s77
    v_mfma_f32_16x16x32_bf16 v[32:35], a[152:155], a[96:99], v[32:35]
    ds_read_b64_tr_b16 a[200:201], v22 offset:18432
    v_mfma_f32_16x16x32_bf16 v[40:43], a[152:155], a[100:103], v[40:43]
    ds_read_b64_tr_b16 a[202:203], v22 offset:18688
    v_mfma_f32_16x16x32_bf16 v[48:51], a[152:155], a[104:107], v[48:51]
    buffer_load_dwordx4 v12, s[20:23], s3 offen lds
    v_mfma_f32_16x16x32_bf16 v[56:59], a[152:155], a[108:111], v[56:59]
    ds_read_b64_tr_b16 a[204:205], v23 offset:18432
    v_mfma_f32_16x16x32_bf16 v[36:39], a[156:159], a[96:99], v[36:39]
    ds_read_b64_tr_b16 a[206:207], v23 offset:18688
    v_mfma_f32_16x16x32_bf16 v[44:47], a[156:159], a[100:103], v[44:47]
    v_mfma_f32_16x16x32_bf16 v[52:55], a[156:159], a[104:107], v[52:55]
    s_add_u32 m0, s46, 53248
    v_mfma_f32_16x16x32_bf16 v[60:63], a[156:159], a[108:111], v[60:63]
    s_add_u32 s3, s61, s78
    v_mfma_f32_16x16x32_bf16 v[64:67], a[160:163], a[96:99], v[64:67]
    buffer_load_dwordx4 v12, s[20:23], s3 offen lds
    v_mfma_f32_16x16x32_bf16 v[72:75], a[160:163], a[100:103], v[72:75]
    s_add_u32 s79, s79, 1
    v_mfma_f32_16x16x32_bf16 v[80:83], a[160:163], a[104:107], v[80:83]
    s_and_b32 s79, s79, 31
    v_mfma_f32_16x16x32_bf16 v[88:91], a[160:163], a[108:111], v[88:91]
    s_lshl_b32 s59, s79, 6
    v_mfma_f32_16x16x32_bf16 v[68:71], a[164:167], a[96:99], v[68:71]
    s_mul_i32 s60, s79, 196608
    v_mfma_f32_16x16x32_bf16 v[76:79], a[164:167], a[100:103], v[76:79]
    s_mul_i32 s61, s79, 229376
    v_mfma_f32_16x16x32_bf16 v[84:87], a[164:167], a[104:107], v[84:87]
    s_mul_i32 s62, s79, s58
    v_mfma_f32_16x16x32_bf16 v[92:95], a[164:167], a[108:111], v[92:95]
    s_waitcnt vmcnt(18) lgkmcnt(0)
    s_barrier
    v_mfma_f32_16x16x32_bf16 v[96:99], a[168:171], a[96:99], v[96:99]
    ds_read_b128 a[112:115], v17 offset:0
    v_mfma_f32_16x16x32_bf16 v[104:107], a[168:171], a[100:103], v[104:107]
    ds_read_b128 a[116:119], v17 offset:1024
    v_mfma_f32_16x16x32_bf16 v[112:115], a[168:171], a[104:107], v[112:115]
    s_add_u32 m0, s45, 73728
    v_mfma_f32_16x16x32_bf16 v[120:123], a[168:171], a[108:111], v[120:123]
    ds_read_b128 a[120:123], v17 offset:2048
    v_mfma_f32_16x16x32_bf16 v[100:103], a[172:175], a[96:99], v[100:103]
    ds_read_b128 a[124:127], v17 offset:3072
    v_mfma_f32_16x16x32_bf16 v[108:111], a[172:175], a[100:103], v[108:111]
    s_add_u32 s3, s59, 0
    v_mfma_f32_16x16x32_bf16 v[116:119], a[172:175], a[104:107], v[116:119]
    ds_read_b64_tr_b16 a[128:129], v24 offset:0
    v_mfma_f32_16x16x32_bf16 v[124:127], a[172:175], a[108:111], v[124:127]
    ds_read_b64_tr_b16 a[130:131], v24 offset:256
    v_mfma_f32_16x16x32_bf16 v[128:131], a[176:179], a[96:99], v[128:131]
    buffer_load_dwordx4 v10, s[4:7], s3 offen lds
    v_mfma_f32_16x16x32_bf16 v[136:139], a[176:179], a[100:103], v[136:139]
    ds_read_b64_tr_b16 a[132:133], v25 offset:0
    v_mfma_f32_16x16x32_bf16 v[144:147], a[176:179], a[104:107], v[144:147]
    ds_read_b64_tr_b16 a[134:135], v25 offset:256
    v_mfma_f32_16x16x32_bf16 v[152:155], a[176:179], a[108:111], v[152:155]
    s_add_u32 m0, s46, 73728
    v_mfma_f32_16x16x32_bf16 v[132:135], a[180:183], a[96:99], v[132:135]
    ds_read_b64_tr_b16 a[136:137], v24 offset:2048
    v_mfma_f32_16x16x32_bf16 v[140:143], a[180:183], a[100:103], v[140:143]
    ds_read_b64_tr_b16 a[138:139], v24 offset:2304
    v_mfma_f32_16x16x32_bf16 v[148:151], a[180:183], a[104:107], v[148:151]
    s_add_u32 s3, s60, s74
    v_mfma_f32_16x16x32_bf16 v[156:159], a[180:183], a[108:111], v[156:159]
    ds_read_b64_tr_b16 a[140:141], v25 offset:2048
    v_mfma_f32_16x16x32_bf16 v[160:163], a[184:187], a[96:99], v[160:163]
    ds_read_b64_tr_b16 a[142:143], v25 offset:2304
    v_mfma_f32_16x16x32_bf16 v[168:171], a[184:187], a[100:103], v[168:171]
    buffer_load_dwordx4 v11, s[8:11], s3 offen lds
    v_mfma_f32_16x16x32_bf16 v[176:179], a[184:187], a[104:107], v[176:179]
    ds_read_b64_tr_b16 a[144:145], v24 offset:4096
    v_mfma_f32_16x16x32_bf16 v[184:187], a[184:187], a[108:111], v[184:187]
    ds_read_b64_tr_b16 a[146:147], v24 offset:4352
    v_mfma_f32_16x16x32_bf16 v[164:167], a[188:191], a[96:99], v[164:167]
    s_add_u32 m0, s45, 74752
    v_mfma_f32_16x16x32_bf16 v[172:175], a[188:191], a[100:103], v[172:175]
    ds_read_b64_tr_b16 a[148:149], v25 offset:4096
    v_mfma_f32_16x16x32_bf16 v[180:183], a[188:191], a[104:107], v[180:183]
    ds_read_b64_tr_b16 a[150:151], v25 offset:4352
    v_mfma_f32_16x16x32_bf16 v[188:191], a[188:191], a[108:111], v[188:191]
    s_add_u32 s3, s59, 32768
    v_mfma_f32_16x16x32_bf16 v[192:195], a[192:195], a[96:99], v[192:195]
    ds_read_b64_tr_b16 a[152:153], v24 offset:6144
    v_mfma_f32_16x16x32_bf16 v[200:203], a[192:195], a[100:103], v[200:203]
    ds_read_b64_tr_b16 a[154:155], v24 offset:6400
    v_mfma_f32_16x16x32_bf16 v[208:211], a[192:195], a[104:107], v[208:211]
    buffer_load_dwordx4 v10, s[4:7], s3 offen lds
    v_mfma_f32_16x16x32_bf16 v[216:219], a[192:195], a[108:111], v[216:219]
    ds_read_b64_tr_b16 a[156:157], v25 offset:6144
    v_mfma_f32_16x16x32_bf16 v[196:199], a[196:199], a[96:99], v[196:199]
    ds_read_b64_tr_b16 a[158:159], v25 offset:6400
    v_mfma_f32_16x16x32_bf16 v[204:207], a[196:199], a[100:103], v[204:207]
    s_add_u32 m0, s46, 77824
    v_mfma_f32_16x16x32_bf16 v[212:215], a[196:199], a[104:107], v[212:215]
    ds_read_b64_tr_b16 a[160:161], v24 offset:8192
    v_mfma_f32_16x16x32_bf16 v[220:223], a[196:199], a[108:111], v[220:223]
    ds_read_b64_tr_b16 a[162:163], v24 offset:8448
    v_mfma_f32_16x16x32_bf16 v[224:227], a[200:203], a[96:99], v[224:227]
    s_add_u32 s3, s62, s75
    v_mfma_f32_16x16x32_bf16 v[232:235], a[200:203], a[100:103], v[232:235]
    ds_read_b64_tr_b16 a[164:165], v25 offset:8192
    v_mfma_f32_16x16x32_bf16 v[240:243], a[200:203], a[104:107], v[240:243]
    ds_read_b64_tr_b16 a[166:167], v25 offset:8448
    v_mfma_f32_16x16x32_bf16 v[248:251], a[200:203], a[108:111], v[248:251]
    buffer_load_dwordx4 v13, s[24:27], s3 offen lds
    v_mfma_f32_16x16x32_bf16 v[228:231], a[204:207], a[96:99], v[228:231]
    s_add_u32 m0, s45, 75776
    v_mfma_f32_16x16x32_bf16 v[236:239], a[204:207], a[100:103], v[236:239]
    s_add_u32 s3, s59, 65536
    v_mfma_f32_16x16x32_bf16 v[244:247], a[204:207], a[104:107], v[244:247]
    buffer_load_dwordx4 v10, s[4:7], s3 offen lds
    v_mfma_f32_16x16x32_bf16 v[252:255], a[204:207], a[108:111], v[252:255]
    s_waitcnt lgkmcnt(0)
    v_mfma_f32_16x16x32_bf16 a[0:3], a[112:115], a[128:131], a[0:3]
    ds_read_b64_tr_b16 a[168:169], v24 offset:10240
    v_mfma_f32_16x16x32_bf16 a[8:11], a[116:119], a[128:131], a[8:11]
    ds_read_b64_tr_b16 a[170:171], v24 offset:10496
    v_mfma_f32_16x16x32_bf16 a[16:19], a[120:123], a[128:131], a[16:19]
    s_add_u32 m0, s46, 81920
    v_mfma_f32_16x16x32_bf16 a[24:27], a[124:127], a[128:131], a[24:27]
    ds_read_b64_tr_b16 a[172:173], v25 offset:10240
    v_mfma_f32_16x16x32_bf16 a[4:7], a[112:115], a[132:135], a[4:7]
    ds_read_b64_tr_b16 a[174:175], v25 offset:10496
    v_mfma_f32_16x16x32_bf16 a[12:15], a[116:119], a[132:135], a[12:15]
    s_add_u32 s3, s61, s76
    v_mfma_f32_16x16x32_bf16 a[20:23], a[120:123], a[132:135], a[20:23]
    ds_read_b64_tr_b16 a[176:177], v24 offset:12288
    v_mfma_f32_16x16x32_bf16 a[28:31], a[124:127], a[132:135], a[28:31]
    ds_read_b64_tr_b16 a[178:179], v24 offset:12544
    v_mfma_f32_16x16x32_bf16 a[32:35], a[112:115], a[136:139], a[32:35]
    buffer_load_dwordx4 v12, s[20:23], s3 offen lds
    v_mfma_f32_16x16x32_bf16 a[40:43], a[116:119], a[136:139], a[40:43]
    ds_read_b64_tr_b16 a[180:181], v25 offset:12288
    v_mfma_f32_16x16x32_bf16 a[48:51], a[120:123], a[136:139], a[48:51]
    ds_read_b64_tr_b16 a[182:183], v25 offset:12544
    v_mfma_f32_16x16x32_bf16 a[56:59], a[124:127], a[136:139], a[56:59]
    s_add_u32 m0, s45, 76800
    v_mfma_f32_16x16x32_bf16 a[36:39], a[112:115], a[140:143], a[36:39]
    ds_read_b64_tr_b16 a[184:185], v24 offset:14336
    v_mfma_f32_16x16x32_bf16 a[44:47], a[116:119], a[140:143], a[44:47]
    ds_read_b64_tr_b16 a[186:187], v24 offset:14592
    v_mfma_f32_16x16x32_bf16 a[52:55], a[120:123], a[140:143], a[52:55]
    s_add_u32 s3, s59, 98304
    v_mfma_f32_16x16x32_bf16 a[60:63], a[124:127], a[140:143], a[60:63]
    ds_read_b64_tr_b16 a[188:189], v25 offset:14336
    v_mfma_f32_16x16x32_bf16 a[64:67], a[144:147], a[112:115], a[64:67]
    ds_read_b64_tr_b16 a[190:191], v25 offset:14592
    v_mfma_f32_16x16x32_bf16 a[72:75], a[144:147], a[116:119], a[72:75]
    buffer_load_dwordx4 v10, s[4:7], s3 offen lds
    v_mfma_f32_16x16x32_bf16 a[80:83], a[144:147], a[120:123], a[80:83]
    ds_read_b64_tr_b16 a[192:193], v24 offset:16384
    v_mfma_f32_16x16x32_bf16 a[88:91], a[144:147], a[124:127], a[88:91]
    ds_read_b64_tr_b16 a[194:195], v24 offset:16640
    v_mfma_f32_16x16x32_bf16 a[68:71], a[148:151], a[112:115], a[68:71]
    s_add_u32 m0, s46, 86016
    v_mfma_f32_16x16x32_bf16 a[76:79], a[148:151], a[116:119], a[76:79]
    ds_read_b64_tr_b16 a[196:197], v25 offset:16384
    v_mfma_f32_16x16x32_bf16 a[84:87], a[148:151], a[120:123], a[84:87]
    ds_read_b64_tr_b16 a[198:199], v25 offset:16640
    v_mfma_f32_16x16x32_bf16 a[92:95], a[148:151], a[124:127], a[92:95]
    s_add_u32 s3, s61, s77
    v_mfma_f32_16x16x32_bf16 v[32:35], a[152:155], a[112:115], v[32:35]
    ds_read_b64_tr_b16 a[200:201], v24 offset:18432
    v_mfma_f32_16x16x32_bf16 v[40:43], a[152:155], a[116:119], v[40:43]
    ds_read_b64_tr_b16 a[202:203], v24 offset:18688
    v_mfma_f32_16x16x32_bf16 v[48:51], a[152:155], a[120:123], v[48:51]
    buffer_load_dwordx4 v12, s[20:23], s3 offen lds
    v_mfma_f32_16x16x32_bf16 v[56:59], a[152:155], a[124:127], v[56:59]
    ds_read_b64_tr_b16 a[204:205], v25 offset:18432
    v_mfma_f32_16x16x32_bf16 v[36:39], a[156:159], a[112:115], v[36:39]
    ds_read_b64_tr_b16 a[206:207], v25 offset:18688
    v_mfma_f32_16x16x32_bf16 v[44:47], a[156:159], a[116:119], v[44:47]
    v_mfma_f32_16x16x32_bf16 v[52:55], a[156:159], a[120:123], v[52:55]
    s_add_u32 m0, s46, 90112
    v_mfma_f32_16x16x32_bf16 v[60:63], a[156:159], a[124:127], v[60:63]
    s_add_u32 s3, s61, s78
    v_mfma_f32_16x16x32_bf16 v[64:67], a[160:163], a[112:115], v[64:67]
    buffer_load_dwordx4 v12, s[20:23], s3 offen lds
    v_mfma_f32_16x16x32_bf16 v[72:75], a[160:163], a[116:119], v[72:75]
    s_add_u32 s79, s79, 1
    v_mfma_f32_16x16x32_bf16 v[80:83], a[160:163], a[120:123], v[80:83]
    s_and_b32 s79, s79, 31
    v_mfma_f32_16x16x32_bf16 v[88:91], a[160:163], a[124:127], v[88:91]
    s_lshl_b32 s59, s79, 6
    v_mfma_f32_16x16x32_bf16 v[68:71], a[164:167], a[112:115], v[68:71]
    s_mul_i32 s60, s79, 196608
    v_mfma_f32_16x16x32_bf16 v[76:79], a[164:167], a[116:119], v[76:79]
    s_mul_i32 s61, s79, 229376
    v_mfma_f32_16x16x32_bf16 v[84:87], a[164:167], a[120:123], v[84:87]
    s_mul_i32 s62, s79, s58
    v_mfma_f32_16x16x32_bf16 v[92:95], a[164:167], a[124:127], v[92:95]
    s_waitcnt vmcnt(18) lgkmcnt(0)
    s_barrier
    v_mfma_f32_16x16x32_bf16 v[96:99], a[168:171], a[112:115], v[96:99]
    ds_read_b128 a[96:99], v14 offset:0
    v_mfma_f32_16x16x32_bf16 v[104:107], a[168:171], a[116:119], v[104:107]
    ds_read_b128 a[100:103], v14 offset:1024
    v_mfma_f32_16x16x32_bf16 v[112:115], a[168:171], a[120:123], v[112:115]
    s_add_u32 m0, s45, 110592
    v_mfma_f32_16x16x32_bf16 v[120:123], a[168:171], a[124:127], v[120:123]
    ds_read_b128 a[104:107], v14 offset:2048
    v_mfma_f32_16x16x32_bf16 v[100:103], a[172:175], a[112:115], v[100:103]
    ds_read_b128 a[108:111], v14 offset:3072
    v_mfma_f32_16x16x32_bf16 v[108:111], a[172:175], a[116:119], v[108:111]
    s_add_u32 s3, s59, 0
    v_mfma_f32_16x16x32_bf16 v[116:119], a[172:175], a[120:123], v[116:119]
    ds_read_b64_tr_b16 a[128:129], v18 offset:0
    v_mfma_f32_16x16x32_bf16 v[124:127], a[172:175], a[124:127], v[124:127]
    ds_read_b64_tr_b16 a[130:131], v18 offset:256
    v_mfma_f32_16x16x32_bf16 v[128:131], a[176:179], a[112:115], v[128:131]
    buffer_load_dwordx4 v10, s[4:7], s3 offen lds
    v_mfma_f32_16x16x32_bf16 v[136:139], a[176:179], a[116:119], v[136:139]
    ds_read_b64_tr_b16 a[132:133], v19 offset:0
    v_mfma_f32_16x16x32_bf16 v[144:147], a[176:179], a[120:123], v[144:147]
    ds_read_b64_tr_b16 a[134:135], v19 offset:256
    v_mfma_f32_16x16x32_bf16 v[152:155], a[176:179], a[124:127], v[152:155]
    s_add_u32 m0, s46, 110592
    v_mfma_f32_16x16x32_bf16 v[132:135], a[180:183], a[112:115], v[132:135]
    ds_read_b64_tr_b16 a[136:137], v18 offset:2048
    v_mfma_f32_16x16x32_bf16 v[140:143], a[180:183], a[116:119], v[140:143]
    ds_read_b64_tr_b16 a[138:139], v18 offset:2304
    v_mfma_f32_16x16x32_bf16 v[148:151], a[180:183], a[120:123], v[148:151]
    s_add_u32 s3, s60, s74
    v_mfma_f32_16x16x32_bf16 v[156:159], a[180:183], a[124:127], v[156:159]
    ds_read_b64_tr_b16 a[140:141], v19 offset:2048
    v_mfma_f32_16x16x32_bf16 v[160:163], a[184:187], a[112:115], v[160:163]
    ds_read_b64_tr_b16 a[142:143], v19 offset:2304
    v_mfma_f32_16x16x32_bf16 v[168:171], a[184:187], a[116:119], v[168:171]
    buffer_load_dwordx4 v11, s[8:11], s3 offen lds
    v_mfma_f32_16x16x32_bf16 v[176:179], a[184:187], a[120:123], v[176:179]
    ds_read_b64_tr_b16 a[144:145], v18 offset:4096
    v_mfma_f32_16x16x32_bf16 v[184:187], a[184:187], a[124:127], v[184:187]
    ds_read_b64_tr_b16 a[146:147], v18 offset:4352
    v_mfma_f32_16x16x32_bf16 v[164:167], a[188:191], a[112:115], v[164:167]
    s_add_u32 m0, s45, 111616
    v_mfma_f32_16x16x32_bf16 v[172:175], a[188:191], a[116:119], v[172:175]
    ds_read_b64_tr_b16 a[148:149], v19 offset:4096
    v_mfma_f32_16x16x32_bf16 v[180:183], a[188:191], a[120:123], v[180:183]
    ds_read_b64_tr_b16 a[150:151], v19 offset:4352
    v_mfma_f32_16x16x32_bf16 v[188:191], a[188:191], a[124:127], v[188:191]
    s_add_u32 s3, s59, 32768
    v_mfma_f32_16x16x32_bf16 v[192:195], a[192:195], a[112:115], v[192:195]
    ds_read_b64_tr_b16 a[152:153], v18 offset:6144
    v_mfma_f32_16x16x32_bf16 v[200:203], a[192:195], a[116:119], v[200:203]
    ds_read_b64_tr_b16 a[154:155], v18 offset:6400
    v_mfma_f32_16x16x32_bf16 v[208:211], a[192:195], a[120:123], v[208:211]
    buffer_load_dwordx4 v10, s[4:7], s3 offen lds
    v_mfma_f32_16x16x32_bf16 v[216:219], a[192:195], a[124:127], v[216:219]
    ds_read_b64_tr_b16 a[156:157], v19 offset:6144
    v_mfma_f32_16x16x32_bf16 v[196:199], a[196:199], a[112:115], v[196:199]
    ds_read_b64_tr_b16 a[158:159], v19 offset:6400
    v_mfma_f32_16x16x32_bf16 v[204:207], a[196:199], a[116:119], v[204:207]
    s_add_u32 m0, s46, 114688
    v_mfma_f32_16x16x32_bf16 v[212:215], a[196:199], a[120:123], v[212:215]
    ds_read_b64_tr_b16 a[160:161], v18 offset:8192
    v_mfma_f32_16x16x32_bf16 v[220:223], a[196:199], a[124:127], v[220:223]
    ds_read_b64_tr_b16 a[162:163], v18 offset:8448
    v_mfma_f32_16x16x32_bf16 v[224:227], a[200:203], a[112:115], v[224:227]
    s_add_u32 s3, s62, s75
    v_mfma_f32_16x16x32_bf16 v[232:235], a[200:203], a[116:119], v[232:235]
    ds_read_b64_tr_b16 a[164:165], v19 offset:8192
    v_mfma_f32_16x16x32_bf16 v[240:243], a[200:203], a[120:123], v[240:243]
    ds_read_b64_tr_b16 a[166:167], v19 offset:8448
    v_mfma_f32_16x16x32_bf16 v[248:251], a[200:203], a[124:127], v[248:251]
    buffer_load_dwordx4 v13, s[24:27], s3 offen lds
    v_mfma_f32_16x16x32_bf16 v[228:231], a[204:207], a[112:115], v[228:231]
    s_add_u32 m0, s45, 112640
    v_mfma_f32_16x16x32_bf16 v[236:239], a[204:207], a[116:119], v[236:239]
    s_add_u32 s3, s59, 65536
    v_mfma_f32_16x16x32_bf16 v[244:247], a[204:207], a[120:123], v[244:247]
    buffer_load_dwordx4 v10, s[4:7], s3 offen lds
    v_mfma_f32_16x16x32_bf16 v[252:255], a[204:207], a[124:127], v[252:255]
    s_waitcnt lgkmcnt(0)
    v_mfma_f32_16x16x32_bf16 a[0:3], a[96:99], a[128:131], a[0:3]
    ds_read_b64_tr_b16 a[168:169], v18 offset:10240
    v_mfma_f32_16x16x32_bf16 a[8:11], a[100:103], a[128:131], a[8:11]
    ds_read_b64_tr_b16 a[170:171], v18 offset:10496
    v_mfma_f32_16x16x32_bf16 a[16:19], a[104:107], a[128:131], a[16:19]
    s_add_u32 m0, s46, 118784
    v_mfma_f32_16x16x32_bf16 a[24:27], a[108:111], a[128:131], a[24:27]
    ds_read_b64_tr_b16 a[172:173], v19 offset:10240
    v_mfma_f32_16x16x32_bf16 a[4:7], a[96:99], a[132:135], a[4:7]
    ds_read_b64_tr_b16 a[174:175], v19 offset:10496
    v_mfma_f32_16x16x32_bf16 a[12:15], a[100:103], a[132:135], a[12:15]
    s_add_u32 s3, s61, s76
    v_mfma_f32_16x16x32_bf16 a[20:23], a[104:107], a[132:135], a[20:23]
    ds_read_b64_tr_b16 a[176:177], v18 offset:12288
    v_mfma_f32_16x16x32_bf16 a[28:31], a[108:111], a[132:135], a[28:31]
    ds_read_b64_tr_b16 a[178:179], v18 offset:12544
    v_mfma_f32_16x16x32_bf16 a[32:35], a[96:99], a[136:139], a[32:35]
    buffer_load_dwordx4 v12, s[20:23], s3 offen lds
    v_mfma_f32_16x16x32_bf16 a[40:43], a[100:103], a[136:139], a[40:43]
    ds_read_b64_tr_b16 a[180:181], v19 offset:12288
    v_mfma_f32_16x16x32_bf16 a[48:51], a[104:107], a[136:139], a[48:51]
    ds_read_b64_tr_b16 a[182:183], v19 offset:12544
    v_mfma_f32_16x16x32_bf16 a[56:59], a[108:111], a[136:139], a[56:59]
    s_add_u32 m0, s45, 113664
    v_mfma_f32_16x16x32_bf16 a[36:39], a[96:99], a[140:143], a[36:39]
    ds_read_b64_tr_b16 a[184:185], v18 offset:14336
    v_mfma_f32_16x16x32_bf16 a[44:47], a[100:103], a[140:143], a[44:47]
    ds_read_b64_tr_b16 a[186:187], v18 offset:14592
    v_mfma_f32_16x16x32_bf16 a[52:55], a[104:107], a[140:143], a[52:55]
    s_add_u32 s3, s59, 98304
    v_mfma_f32_16x16x32_bf16 a[60:63], a[108:111], a[140:143], a[60:63]
    ds_read_b64_tr_b16 a[188:189], v19 offset:14336
    v_mfma_f32_16x16x32_bf16 a[64:67], a[144:147], a[96:99], a[64:67]
    ds_read_b64_tr_b16 a[190:191], v19 offset:14592
    v_mfma_f32_16x16x32_bf16 a[72:75], a[144:147], a[100:103], a[72:75]
    buffer_load_dwordx4 v10, s[4:7], s3 offen lds
    v_mfma_f32_16x16x32_bf16 a[80:83], a[144:147], a[104:107], a[80:83]
    ds_read_b64_tr_b16 a[192:193], v18 offset:16384
    v_mfma_f32_16x16x32_bf16 a[88:91], a[144:147], a[108:111], a[88:91]
    ds_read_b64_tr_b16 a[194:195], v18 offset:16640
    v_mfma_f32_16x16x32_bf16 a[68:71], a[148:151], a[96:99], a[68:71]
    s_add_u32 m0, s46, 122880
    v_mfma_f32_16x16x32_bf16 a[76:79], a[148:151], a[100:103], a[76:79]
    ds_read_b64_tr_b16 a[196:197], v19 offset:16384
    v_mfma_f32_16x16x32_bf16 a[84:87], a[148:151], a[104:107], a[84:87]
    ds_read_b64_tr_b16 a[198:199], v19 offset:16640
    v_mfma_f32_16x16x32_bf16 a[92:95], a[148:151], a[108:111], a[92:95]
    s_add_u32 s3, s61, s77
    v_mfma_f32_16x16x32_bf16 v[32:35], a[152:155], a[96:99], v[32:35]
    ds_read_b64_tr_b16 a[200:201], v18 offset:18432
    v_mfma_f32_16x16x32_bf16 v[40:43], a[152:155], a[100:103], v[40:43]
    ds_read_b64_tr_b16 a[202:203], v18 offset:18688
    v_mfma_f32_16x16x32_bf16 v[48:51], a[152:155], a[104:107], v[48:51]
    buffer_load_dwordx4 v12, s[20:23], s3 offen lds
    v_mfma_f32_16x16x32_bf16 v[56:59], a[152:155], a[108:111], v[56:59]
    ds_read_b64_tr_b16 a[204:205], v19 offset:18432
    v_mfma_f32_16x16x32_bf16 v[36:39], a[156:159], a[96:99], v[36:39]
    ds_read_b64_tr_b16 a[206:207], v19 offset:18688
    v_mfma_f32_16x16x32_bf16 v[44:47], a[156:159], a[100:103], v[44:47]
    v_mfma_f32_16x16x32_bf16 v[52:55], a[156:159], a[104:107], v[52:55]
    s_add_u32 m0, s46, 126976
    v_mfma_f32_16x16x32_bf16 v[60:63], a[156:159], a[108:111], v[60:63]
    s_add_u32 s3, s61, s78
    v_mfma_f32_16x16x32_bf16 v[64:67], a[160:163], a[96:99], v[64:67]
    buffer_load_dwordx4 v12, s[20:23], s3 offen lds
    v_mfma_f32_16x16x32_bf16 v[72:75], a[160:163], a[100:103], v[72:75]
    s_add_u32 s79, s79, 1
    v_mfma_f32_16x16x32_bf16 v[80:83], a[160:163], a[104:107], v[80:83]
    s_and_b32 s79, s79, 31
    v_mfma_f32_16x16x32_bf16 v[88:91], a[160:163], a[108:111], v[88:91]
    s_lshl_b32 s59, s79, 6
    v_mfma_f32_16x16x32_bf16 v[68:71], a[164:167], a[96:99], v[68:71]
    s_mul_i32 s60, s79, 196608
    v_mfma_f32_16x16x32_bf16 v[76:79], a[164:167], a[100:103], v[76:79]
    s_mul_i32 s61, s79, 229376
    v_mfma_f32_16x16x32_bf16 v[84:87], a[164:167], a[104:107], v[84:87]
    s_mul_i32 s62, s79, s58
    v_mfma_f32_16x16x32_bf16 v[92:95], a[164:167], a[108:111], v[92:95]
    s_waitcnt vmcnt(18) lgkmcnt(0)
    s_barrier
    v_mfma_f32_16x16x32_bf16 v[96:99], a[168:171], a[96:99], v[96:99]
    ds_read_b128 a[112:115], v15 offset:0
    v_mfma_f32_16x16x32_bf16 v[104:107], a[168:171], a[100:103], v[104:107]
    ds_read_b128 a[116:119], v15 offset:1024
    v_mfma_f32_16x16x32_bf16 v[112:115], a[168:171], a[104:107], v[112:115]
    v_mfma_f32_16x16x32_bf16 v[120:123], a[168:171], a[108:111], v[120:123]
    ds_read_b128 a[120:123], v15 offset:2048
    v_mfma_f32_16x16x32_bf16 v[100:103], a[172:175], a[96:99], v[100:103]
    ds_read_b128 a[124:127], v15 offset:3072
    v_mfma_f32_16x16x32_bf16 v[108:111], a[172:175], a[100:103], v[108:111]
    v_mfma_f32_16x16x32_bf16 v[116:119], a[172:175], a[104:107], v[116:119]
    ds_read_b64_tr_b16 a[128:129], v20 offset:0
    v_mfma_f32_16x16x32_bf16 v[124:127], a[172:175], a[108:111], v[124:127]
    ds_read_b64_tr_b16 a[130:131], v20 offset:256
    v_mfma_f32_16x16x32_bf16 v[128:131], a[176:179], a[96:99], v[128:131]
    v_mfma_f32_16x16x32_bf16 v[136:139], a[176:179], a[100:103], v[136:139]
    ds_read_b64_tr_b16 a[132:133], v21 offset:0
    v_mfma_f32_16x16x32_bf16 v[144:147], a[176:179], a[104:107], v[144:147]
    ds_read_b64_tr_b16 a[134:135], v21 offset:256
    v_mfma_f32_16x16x32_bf16 v[152:155], a[176:179], a[108:111], v[152:155]
    v_mfma_f32_16x16x32_bf16 v[132:135], a[180:183], a[96:99], v[132:135]
    ds_read_b64_tr_b16 a[136:137], v20 offset:2048
    v_mfma_f32_16x16x32_bf16 v[140:143], a[180:183], a[100:103], v[140:143]
    ds_read_b64_tr_b16 a[138:139], v20 offset:2304
    v_mfma_f32_16x16x32_bf16 v[148:151], a[180:183], a[104:107], v[148:151]
    v_mfma_f32_16x16x32_bf16 v[156:159], a[180:183], a[108:111], v[156:159]
    ds_read_b64_tr_b16 a[140:141], v21 offset:2048
    v_mfma_f32_16x16x32_bf16 v[160:163], a[184:187], a[96:99], v[160:163]
    ds_read_b64_tr_b16 a[142:143], v21 offset:2304
    v_mfma_f32_16x16x32_bf16 v[168:171], a[184:187], a[100:103], v[168:171]
    v_mfma_f32_16x16x32_bf16 v[176:179], a[184:187], a[104:107], v[176:179]
    ds_read_b64_tr_b16 a[144:145], v20 offset:4096
    v_mfma_f32_16x16x32_bf16 v[184:187], a[184:187], a[108:111], v[184:187]
    ds_read_b64_tr_b16 a[146:147], v20 offset:4352
    v_mfma_f32_16x16x32_bf16 v[164:167], a[188:191], a[96:99], v[164:167]
    v_mfma_f32_16x16x32_bf16 v[172:175], a[188:191], a[100:103], v[172:175]
    ds_read_b64_tr_b16 a[148:149], v21 offset:4096
    v_mfma_f32_16x16x32_bf16 v[180:183], a[188:191], a[104:107], v[180:183]
    ds_read_b64_tr_b16 a[150:151], v21 offset:4352
    v_mfma_f32_16x16x32_bf16 v[188:191], a[188:191], a[108:111], v[188:191]
    v_mfma_f32_16x16x32_bf16 v[192:195], a[192:195], a[96:99], v[192:195]
    ds_read_b64_tr_b16 a[152:153], v20 offset:6144
    v_mfma_f32_16x16x32_bf16 v[200:203], a[192:195], a[100:103], v[200:203]
    ds_read_b64_tr_b16 a[154:155], v20 offset:6400
    v_mfma_f32_16x16x32_bf16 v[208:211], a[192:195], a[104:107], v[208:211]
    v_mfma_f32_16x16x32_bf16 v[216:219], a[192:195], a[108:111], v[216:219]
    ds_read_b64_tr_b16 a[156:157], v21 offset:6144
    v_mfma_f32_16x16x32_bf16 v[196:199], a[196:199], a[96:99], v[196:199]
    ds_read_b64_tr_b16 a[158:159], v21 offset:6400
    v_mfma_f32_16x16x32_bf16 v[204:207], a[196:199], a[100:103], v[204:207]
    v_mfma_f32_16x16x32_bf16 v[212:215], a[196:199], a[104:107], v[212:215]
    ds_read_b64_tr_b16 a[160:161], v20 offset:8192
    v_mfma_f32_16x16x32_bf16 v[220:223], a[196:199], a[108:111], v[220:223]
    ds_read_b64_tr_b16 a[162:163], v20 offset:8448
    v_mfma_f32_16x16x32_bf16 v[224:227], a[200:203], a[96:99], v[224:227]
    v_mfma_f32_16x16x32_bf16 v[232:235], a[200:203], a[100:103], v[232:235]
    ds_read_b64_tr_b16 a[164:165], v21 offset:8192
    v_mfma_f32_16x16x32_bf16 v[240:243], a[200:203], a[104:107], v[240:243]
    ds_read_b64_tr_b16 a[166:167], v21 offset:8448
    v_mfma_f32_16x16x32_bf16 v[248:251], a[200:203], a[108:111], v[248:251]
    v_mfma_f32_16x16x32_bf16 v[228:231], a[204:207], a[96:99], v[228:231]
    v_mfma_f32_16x16x32_bf16 v[236:239], a[204:207], a[100:103], v[236:239]
    v_mfma_f32_16x16x32_bf16 v[244:247], a[204:207], a[104:107], v[244:247]
    v_mfma_f32_16x16x32_bf16 v[252:255], a[204:207], a[108:111], v[252:255]
    s_waitcnt lgkmcnt(0)
    v_mfma_f32_16x16x32_bf16 a[0:3], a[112:115], a[128:131], a[0:3]
    ds_read_b64_tr_b16 a[168:169], v20 offset:10240
    v_mfma_f32_16x16x32_bf16 a[8:11], a[116:119], a[128:131], a[8:11]
    ds_read_b64_tr_b16 a[170:171], v20 offset:10496
    v_mfma_f32_16x16x32_bf16 a[16:19], a[120:123], a[128:131], a[16:19]
    v_mfma_f32_16x16x32_bf16 a[24:27], a[124:127], a[128:131], a[24:27]
    ds_read_b64_tr_b16 a[172:173], v21 offset:10240
    v_mfma_f32_16x16x32_bf16 a[4:7], a[112:115], a[132:135], a[4:7]
    ds_read_b64_tr_b16 a[174:175], v21 offset:10496
    v_mfma_f32_16x16x32_bf16 a[12:15], a[116:119], a[132:135], a[12:15]
    v_mfma_f32_16x16x32_bf16 a[20:23], a[120:123], a[132:135], a[20:23]
    ds_read_b64_tr_b16 a[176:177], v20 offset:12288
    v_mfma_f32_16x16x32_bf16 a[28:31], a[124:127], a[132:135], a[28:31]
    ds_read_b64_tr_b16 a[178:179], v20 offset:12544
    v_mfma_f32_16x16x32_bf16 a[32:35], a[112:115], a[136:139], a[32:35]
    v_mfma_f32_16x16x32_bf16 a[40:43], a[116:119], a[136:139], a[40:43]
    ds_read_b64_tr_b16 a[180:181], v21 offset:12288
    v_mfma_f32_16x16x32_bf16 a[48:51], a[120:123], a[136:139], a[48:51]
    ds_read_b64_tr_b16 a[182:183], v21 offset:12544
    v_mfma_f32_16x16x32_bf16 a[56:59], a[124:127], a[136:139], a[56:59]
    v_mfma_f32_16x16x32_bf16 a[36:39], a[112:115], a[140:143], a[36:39]
    ds_read_b64_tr_b16 a[184:185], v20 offset:14336
    v_mfma_f32_16x16x32_bf16 a[44:47], a[116:119], a[140:143], a[44:47]
    ds_read_b64_tr_b16 a[186:187], v20 offset:14592
    v_mfma_f32_16x16x32_bf16 a[52:55], a[120:123], a[140:143], a[52:55]
    v_mfma_f32_16x16x32_bf16 a[60:63], a[124:127], a[140:143], a[60:63]
    ds_read_b64_tr_b16 a[188:189], v21 offset:14336
    v_mfma_f32_16x16x32_bf16 a[64:67], a[144:147], a[112:115], a[64:67]
    ds_read_b64_tr_b16 a[190:191], v21 offset:14592
    v_mfma_f32_16x16x32_bf16 a[72:75], a[144:147], a[116:119], a[72:75]
    v_mfma_f32_16x16x32_bf16 a[80:83], a[144:147], a[120:123], a[80:83]
    ds_read_b64_tr_b16 a[192:193], v20 offset:16384
    v_mfma_f32_16x16x32_bf16 a[88:91], a[144:147], a[124:127], a[88:91]
    ds_read_b64_tr_b16 a[194:195], v20 offset:16640
    v_mfma_f32_16x16x32_bf16 a[68:71], a[148:151], a[112:115], a[68:71]
    v_mfma_f32_16x16x32_bf16 a[76:79], a[148:151], a[116:119], a[76:79]
    ds_read_b64_tr_b16 a[196:197], v21 offset:16384
    v_mfma_f32_16x16x32_bf16 a[84:87], a[148:151], a[120:123], a[84:87]
    ds_read_b64_tr_b16 a[198:199], v21 offset:16640
    v_mfma_f32_16x16x32_bf16 a[92:95], a[148:151], a[124:127], a[92:95]
    v_mfma_f32_16x16x32_bf16 v[32:35], a[152:155], a[112:115], v[32:35]
    ds_read_b64_tr_b16 a[200:201], v20 offset:18432
    v_mfma_f32_16x16x32_bf16 v[40:43], a[152:155], a[116:119], v[40:43]
    ds_read_b64_tr_b16 a[202:203], v20 offset:18688
    v_mfma_f32_16x16x32_bf16 v[48:51], a[152:155], a[120:123], v[48:51]
    v_mfma_f32_16x16x32_bf16 v[56:59], a[152:155], a[124:127], v[56:59]
    ds_read_b64_tr_b16 a[204:205], v21 offset:18432
    v_mfma_f32_16x16x32_bf16 v[36:39], a[156:159], a[112:115], v[36:39]
    ds_read_b64_tr_b16 a[206:207], v21 offset:18688
    v_mfma_f32_16x16x32_bf16 v[44:47], a[156:159], a[116:119], v[44:47]
    v_mfma_f32_16x16x32_bf16 v[52:55], a[156:159], a[120:123], v[52:55]
    v_mfma_f32_16x16x32_bf16 v[60:63], a[156:159], a[124:127], v[60:63]
    v_mfma_f32_16x16x32_bf16 v[64:67], a[160:163], a[112:115], v[64:67]
    v_mfma_f32_16x16x32_bf16 v[72:75], a[160:163], a[116:119], v[72:75]
    v_mfma_f32_16x16x32_bf16 v[80:83], a[160:163], a[120:123], v[80:83]
    v_mfma_f32_16x16x32_bf16 v[88:91], a[160:163], a[124:127], v[88:91]
    v_mfma_f32_16x16x32_bf16 v[68:71], a[164:167], a[112:115], v[68:71]
    v_mfma_f32_16x16x32_bf16 v[76:79], a[164:167], a[116:119], v[76:79]
    v_mfma_f32_16x16x32_bf16 v[84:87], a[164:167], a[120:123], v[84:87]
    v_mfma_f32_16x16x32_bf16 v[92:95], a[164:167], a[124:127], v[92:95]
    s_waitcnt vmcnt(9) lgkmcnt(0)
    s_barrier
    v_mfma_f32_16x16x32_bf16 v[96:99], a[168:171], a[112:115], v[96:99]
    ds_read_b128 a[96:99], v16 offset:0
    v_mfma_f32_16x16x32_bf16 v[104:107], a[168:171], a[116:119], v[104:107]
    ds_read_b128 a[100:103], v16 offset:1024
    v_mfma_f32_16x16x32_bf16 v[112:115], a[168:171], a[120:123], v[112:115]
    v_mfma_f32_16x16x32_bf16 v[120:123], a[168:171], a[124:127], v[120:123]
    ds_read_b128 a[104:107], v16 offset:2048
    v_mfma_f32_16x16x32_bf16 v[100:103], a[172:175], a[112:115], v[100:103]
    ds_read_b128 a[108:111], v16 offset:3072
    v_mfma_f32_16x16x32_bf16 v[108:111], a[172:175], a[116:119], v[108:111]
    v_mfma_f32_16x16x32_bf16 v[116:119], a[172:175], a[120:123], v[116:119]
    ds_read_b64_tr_b16 a[128:129], v22 offset:0
    v_mfma_f32_16x16x32_bf16 v[124:127], a[172:175], a[124:127], v[124:127]
    ds_read_b64_tr_b16 a[130:131], v22 offset:256
    v_mfma_f32_16x16x32_bf16 v[128:131], a[176:179], a[112:115], v[128:131]
    v_mfma_f32_16x16x32_bf16 v[136:139], a[176:179], a[116:119], v[136:139]
    ds_read_b64_tr_b16 a[132:133], v23 offset:0
    v_mfma_f32_16x16x32_bf16 v[144:147], a[176:179], a[120:123], v[144:147]
    ds_read_b64_tr_b16 a[134:135], v23 offset:256
    v_mfma_f32_16x16x32_bf16 v[152:155], a[176:179], a[124:127], v[152:155]
    v_mfma_f32_16x16x32_bf16 v[132:135], a[180:183], a[112:115], v[132:135]
    ds_read_b64_tr_b16 a[136:137], v22 offset:2048
    v_mfma_f32_16x16x32_bf16 v[140:143], a[180:183], a[116:119], v[140:143]
    ds_read_b64_tr_b16 a[138:139], v22 offset:2304
    v_mfma_f32_16x16x32_bf16 v[148:151], a[180:183], a[120:123], v[148:151]
    v_mfma_f32_16x16x32_bf16 v[156:159], a[180:183], a[124:127], v[156:159]
    ds_read_b64_tr_b16 a[140:141], v23 offset:2048
    v_mfma_f32_16x16x32_bf16 v[160:163], a[184:187], a[112:115], v[160:163]
    ds_read_b64_tr_b16 a[142:143], v23 offset:2304
    v_mfma_f32_16x16x32_bf16 v[168:171], a[184:187], a[116:119], v[168:171]
    v_mfma_f32_16x16x32_bf16 v[176:179], a[184:187], a[120:123], v[176:179]
    ds_read_b64_tr_b16 a[144:145], v22 offset:4096
    v_mfma_f32_16x16x32_bf16 v[184:187], a[184:187], a[124:127], v[184:187]
    ds_read_b64_tr_b16 a[146:147], v22 offset:4352
    v_mfma_f32_16x16x32_bf16 v[164:167], a[188:191], a[112:115], v[164:167]
    v_mfma_f32_16x16x32_bf16 v[172:175], a[188:191], a[116:119], v[172:175]
    ds_read_b64_tr_b16 a[148:149], v23 offset:4096
    v_mfma_f32_16x16x32_bf16 v[180:183], a[188:191], a[120:123], v[180:183]
    ds_read_b64_tr_b16 a[150:151], v23 offset:4352
    v_mfma_f32_16x16x32_bf16 v[188:191], a[188:191], a[124:127], v[188:191]
    v_mfma_f32_16x16x32_bf16 v[192:195], a[192:195], a[112:115], v[192:195]
    ds_read_b64_tr_b16 a[152:153], v22 offset:6144
    v_mfma_f32_16x16x32_bf16 v[200:203], a[192:195], a[116:119], v[200:203]
    ds_read_b64_tr_b16 a[154:155], v22 offset:6400
    v_mfma_f32_16x16x32_bf16 v[208:211], a[192:195], a[120:123], v[208:211]
    v_mfma_f32_16x16x32_bf16 v[216:219], a[192:195], a[124:127], v[216:219]
    ds_read_b64_tr_b16 a[156:157], v23 offset:6144
    v_mfma_f32_16x16x32_bf16 v[196:199], a[196:199], a[112:115], v[196:199]
    ds_read_b64_tr_b16 a[158:159], v23 offset:6400
    v_mfma_f32_16x16x32_bf16 v[204:207], a[196:199], a[116:119], v[204:207]
    v_mfma_f32_16x16x32_bf16 v[212:215], a[196:199], a[120:123], v[212:215]
    ds_read_b64_tr_b16 a[160:161], v22 offset:8192
    v_mfma_f32_16x16x32_bf16 v[220:223], a[196:199], a[124:127], v[220:223]
    ds_read_b64_tr_b16 a[162:163], v22 offset:8448
    v_mfma_f32_16x16x32_bf16 v[224:227], a[200:203], a[112:115], v[224:227]
    v_mfma_f32_16x16x32_bf16 v[232:235], a[200:203], a[116:119], v[232:235]
    ds_read_b64_tr_b16 a[164:165], v23 offset:8192
    v_mfma_f32_16x16x32_bf16 v[240:243], a[200:203], a[120:123], v[240:243]
    ds_read_b64_tr_b16 a[166:167], v23 offset:8448
    v_mfma_f32_16x16x32_bf16 v[248:251], a[200:203], a[124:127], v[248:251]
    v_mfma_f32_16x16x32_bf16 v[228:231], a[204:207], a[112:115], v[228:231]
    v_mfma_f32_16x16x32_bf16 v[236:239], a[204:207], a[116:119], v[236:239]
    v_mfma_f32_16x16x32_bf16 v[244:247], a[204:207], a[120:123], v[244:247]
    v_mfma_f32_16x16x32_bf16 v[252:255], a[204:207], a[124:127], v[252:255]
    s_waitcnt lgkmcnt(0)
    v_mfma_f32_16x16x32_bf16 a[0:3], a[96:99], a[128:131], a[0:3]
    ds_read_b64_tr_b16 a[168:169], v22 offset:10240
    v_mfma_f32_16x16x32_bf16 a[8:11], a[100:103], a[128:131], a[8:11]
    ds_read_b64_tr_b16 a[170:171], v22 offset:10496
    v_mfma_f32_16x16x32_bf16 a[16:19], a[104:107], a[128:131], a[16:19]
    v_mfma_f32_16x16x32_bf16 a[24:27], a[108:111], a[128:131], a[24:27]
    ds_read_b64_tr_b16 a[172:173], v23 offset:10240
    v_mfma_f32_16x16x32_bf16 a[4:7], a[96:99], a[132:135], a[4:7]
    ds_read_b64_tr_b16 a[174:175], v23 offset:10496
    v_mfma_f32_16x16x32_bf16 a[12:15], a[100:103], a[132:135], a[12:15]
    v_mfma_f32_16x16x32_bf16 a[20:23], a[104:107], a[132:135], a[20:23]
    ds_read_b64_tr_b16 a[176:177], v22 offset:12288
    v_mfma_f32_16x16x32_bf16 a[28:31], a[108:111], a[132:135], a[28:31]
    ds_read_b64_tr_b16 a[178:179], v22 offset:12544
    v_mfma_f32_16x16x32_bf16 a[32:35], a[96:99], a[136:139], a[32:35]
    v_mfma_f32_16x16x32_bf16 a[40:43], a[100:103], a[136:139], a[40:43]
    ds_read_b64_tr_b16 a[180:181], v23 offset:12288
    v_mfma_f32_16x16x32_bf16 a[48:51], a[104:107], a[136:139], a[48:51]
    ds_read_b64_tr_b16 a[182:183], v23 offset:12544
    v_mfma_f32_16x16x32_bf16 a[56:59], a[108:111], a[136:139], a[56:59]
    v_mfma_f32_16x16x32_bf16 a[36:39], a[96:99], a[140:143], a[36:39]
    ds_read_b64_tr_b16 a[184:185], v22 offset:14336
    v_mfma_f32_16x16x32_bf16 a[44:47], a[100:103], a[140:143], a[44:47]
    ds_read_b64_tr_b16 a[186:187], v22 offset:14592
    v_mfma_f32_16x16x32_bf16 a[52:55], a[104:107], a[140:143], a[52:55]
    v_mfma_f32_16x16x32_bf16 a[60:63], a[108:111], a[140:143], a[60:63]
    ds_read_b64_tr_b16 a[188:189], v23 offset:14336
    v_mfma_f32_16x16x32_bf16 a[64:67], a[144:147], a[96:99], a[64:67]
    ds_read_b64_tr_b16 a[190:191], v23 offset:14592
    v_mfma_f32_16x16x32_bf16 a[72:75], a[144:147], a[100:103], a[72:75]
    v_mfma_f32_16x16x32_bf16 a[80:83], a[144:147], a[104:107], a[80:83]
    ds_read_b64_tr_b16 a[192:193], v22 offset:16384
    v_mfma_f32_16x16x32_bf16 a[88:91], a[144:147], a[108:111], a[88:91]
    ds_read_b64_tr_b16 a[194:195], v22 offset:16640
    v_mfma_f32_16x16x32_bf16 a[68:71], a[148:151], a[96:99], a[68:71]
    v_mfma_f32_16x16x32_bf16 a[76:79], a[148:151], a[100:103], a[76:79]
    ds_read_b64_tr_b16 a[196:197], v23 offset:16384
    v_mfma_f32_16x16x32_bf16 a[84:87], a[148:151], a[104:107], a[84:87]
    ds_read_b64_tr_b16 a[198:199], v23 offset:16640
    v_mfma_f32_16x16x32_bf16 a[92:95], a[148:151], a[108:111], a[92:95]
    v_mfma_f32_16x16x32_bf16 v[32:35], a[152:155], a[96:99], v[32:35]
    ds_read_b64_tr_b16 a[200:201], v22 offset:18432
    v_mfma_f32_16x16x32_bf16 v[40:43], a[152:155], a[100:103], v[40:43]
    ds_read_b64_tr_b16 a[202:203], v22 offset:18688
    v_mfma_f32_16x16x32_bf16 v[48:51], a[152:155], a[104:107], v[48:51]
    v_mfma_f32_16x16x32_bf16 v[56:59], a[152:155], a[108:111], v[56:59]
    ds_read_b64_tr_b16 a[204:205], v23 offset:18432
    v_mfma_f32_16x16x32_bf16 v[36:39], a[156:159], a[96:99], v[36:39]
    ds_read_b64_tr_b16 a[206:207], v23 offset:18688
    v_mfma_f32_16x16x32_bf16 v[44:47], a[156:159], a[100:103], v[44:47]
    v_mfma_f32_16x16x32_bf16 v[52:55], a[156:159], a[104:107], v[52:55]
    v_mfma_f32_16x16x32_bf16 v[60:63], a[156:159], a[108:111], v[60:63]
    v_mfma_f32_16x16x32_bf16 v[64:67], a[160:163], a[96:99], v[64:67]
    v_mfma_f32_16x16x32_bf16 v[72:75], a[160:163], a[100:103], v[72:75]
    v_mfma_f32_16x16x32_bf16 v[80:83], a[160:163], a[104:107], v[80:83]
    v_mfma_f32_16x16x32_bf16 v[88:91], a[160:163], a[108:111], v[88:91]
    v_mfma_f32_16x16x32_bf16 v[68:71], a[164:167], a[96:99], v[68:71]
    v_mfma_f32_16x16x32_bf16 v[76:79], a[164:167], a[100:103], v[76:79]
    v_mfma_f32_16x16x32_bf16 v[84:87], a[164:167], a[104:107], v[84:87]
    v_mfma_f32_16x16x32_bf16 v[92:95], a[164:167], a[108:111], v[92:95]
    s_waitcnt vmcnt(0) lgkmcnt(0)
    s_barrier
    v_mfma_f32_16x16x32_bf16 v[96:99], a[168:171], a[96:99], v[96:99]
    ds_read_b128 a[112:115], v17 offset:0
    v_mfma_f32_16x16x32_bf16 v[104:107], a[168:171], a[100:103], v[104:107]
    ds_read_b128 a[116:119], v17 offset:1024
    v_mfma_f32_16x16x32_bf16 v[112:115], a[168:171], a[104:107], v[112:115]
    v_mfma_f32_16x16x32_bf16 v[120:123], a[168:171], a[108:111], v[120:123]
    ds_read_b128 a[120:123], v17 offset:2048
    v_mfma_f32_16x16x32_bf16 v[100:103], a[172:175], a[96:99], v[100:103]
    ds_read_b128 a[124:127], v17 offset:3072
    v_mfma_f32_16x16x32_bf16 v[108:111], a[172:175], a[100:103], v[108:111]
    v_mfma_f32_16x16x32_bf16 v[116:119], a[172:175], a[104:107], v[116:119]
    ds_read_b64_tr_b16 a[128:129], v24 offset:0
    v_mfma_f32_16x16x32_bf16 v[124:127], a[172:175], a[108:111], v[124:127]
    ds_read_b64_tr_b16 a[130:131], v24 offset:256
    v_mfma_f32_16x16x32_bf16 v[128:131], a[176:179], a[96:99], v[128:131]
    v_mfma_f32_16x16x32_bf16 v[136:139], a[176:179], a[100:103], v[136:139]
    ds_read_b64_tr_b16 a[132:133], v25 offset:0
    v_mfma_f32_16x16x32_bf16 v[144:147], a[176:179], a[104:107], v[144:147]
    ds_read_b64_tr_b16 a[134:135], v25 offset:256
    v_mfma_f32_16x16x32_bf16 v[152:155], a[176:179], a[108:111], v[152:155]
    v_mfma_f32_16x16x32_bf16 v[132:135], a[180:183], a[96:99], v[132:135]
    ds_read_b64_tr_b16 a[136:137], v24 offset:2048
    v_mfma_f32_16x16x32_bf16 v[140:143], a[180:183], a[100:103], v[140:143]
    ds_read_b64_tr_b16 a[138:139], v24 offset:2304
    v_mfma_f32_16x16x32_bf16 v[148:151], a[180:183], a[104:107], v[148:151]
    v_mfma_f32_16x16x32_bf16 v[156:159], a[180:183], a[108:111], v[156:159]
    ds_read_b64_tr_b16 a[140:141], v25 offset:2048
    v_mfma_f32_16x16x32_bf16 v[160:163], a[184:187], a[96:99], v[160:163]
    ds_read_b64_tr_b16 a[142:143], v25 offset:2304
    v_mfma_f32_16x16x32_bf16 v[168:171], a[184:187], a[100:103], v[168:171]
    v_mfma_f32_16x16x32_bf16 v[176:179], a[184:187], a[104:107], v[176:179]
    ds_read_b64_tr_b16 a[144:145], v24 offset:4096
    v_mfma_f32_16x16x32_bf16 v[184:187], a[184:187], a[108:111], v[184:187]
    ds_read_b64_tr_b16 a[146:147], v24 offset:4352
    v_mfma_f32_16x16x32_bf16 v[164:167], a[188:191], a[96:99], v[164:167]
    v_mfma_f32_16x16x32_bf16 v[172:175], a[188:191], a[100:103], v[172:175]
    ds_read_b64_tr_b16 a[148:149], v25 offset:4096
    v_mfma_f32_16x16x32_bf16 v[180:183], a[188:191], a[104:107], v[180:183]
    ds_read_b64_tr_b16 a[150:151], v25 offset:4352
    v_mfma_f32_16x16x32_bf16 v[188:191], a[188:191], a[108:111], v[188:191]
    v_mfma_f32_16x16x32_bf16 v[192:195], a[192:195], a[96:99], v[192:195]
    ds_read_b64_tr_b16 a[152:153], v24 offset:6144
    v_mfma_f32_16x16x32_bf16 v[200:203], a[192:195], a[100:103], v[200:203]
    ds_read_b64_tr_b16 a[154:155], v24 offset:6400
    v_mfma_f32_16x16x32_bf16 v[208:211], a[192:195], a[104:107], v[208:211]
    v_mfma_f32_16x16x32_bf16 v[216:219], a[192:195], a[108:111], v[216:219]
    ds_read_b64_tr_b16 a[156:157], v25 offset:6144
    v_mfma_f32_16x16x32_bf16 v[196:199], a[196:199], a[96:99], v[196:199]
    ds_read_b64_tr_b16 a[158:159], v25 offset:6400
    v_mfma_f32_16x16x32_bf16 v[204:207], a[196:199], a[100:103], v[204:207]
    v_mfma_f32_16x16x32_bf16 v[212:215], a[196:199], a[104:107], v[212:215]
    ds_read_b64_tr_b16 a[160:161], v24 offset:8192
    v_mfma_f32_16x16x32_bf16 v[220:223], a[196:199], a[108:111], v[220:223]
    ds_read_b64_tr_b16 a[162:163], v24 offset:8448
    v_mfma_f32_16x16x32_bf16 v[224:227], a[200:203], a[96:99], v[224:227]
    v_mfma_f32_16x16x32_bf16 v[232:235], a[200:203], a[100:103], v[232:235]
    ds_read_b64_tr_b16 a[164:165], v25 offset:8192
    v_mfma_f32_16x16x32_bf16 v[240:243], a[200:203], a[104:107], v[240:243]
    ds_read_b64_tr_b16 a[166:167], v25 offset:8448
    v_mfma_f32_16x16x32_bf16 v[248:251], a[200:203], a[108:111], v[248:251]
    v_mfma_f32_16x16x32_bf16 v[228:231], a[204:207], a[96:99], v[228:231]
    v_mfma_f32_16x16x32_bf16 v[236:239], a[204:207], a[100:103], v[236:239]
    v_mfma_f32_16x16x32_bf16 v[244:247], a[204:207], a[104:107], v[244:247]
    v_mfma_f32_16x16x32_bf16 v[252:255], a[204:207], a[108:111], v[252:255]
    s_waitcnt lgkmcnt(0)
    v_mfma_f32_16x16x32_bf16 a[0:3], a[112:115], a[128:131], a[0:3]
    ds_read_b64_tr_b16 a[168:169], v24 offset:10240
    v_mfma_f32_16x16x32_bf16 a[8:11], a[116:119], a[128:131], a[8:11]
    ds_read_b64_tr_b16 a[170:171], v24 offset:10496
    v_mfma_f32_16x16x32_bf16 a[16:19], a[120:123], a[128:131], a[16:19]
    v_mfma_f32_16x16x32_bf16 a[24:27], a[124:127], a[128:131], a[24:27]
    ds_read_b64_tr_b16 a[172:173], v25 offset:10240
    v_mfma_f32_16x16x32_bf16 a[4:7], a[112:115], a[132:135], a[4:7]
    ds_read_b64_tr_b16 a[174:175], v25 offset:10496
    v_mfma_f32_16x16x32_bf16 a[12:15], a[116:119], a[132:135], a[12:15]
    v_mfma_f32_16x16x32_bf16 a[20:23], a[120:123], a[132:135], a[20:23]
    ds_read_b64_tr_b16 a[176:177], v24 offset:12288
    v_mfma_f32_16x16x32_bf16 a[28:31], a[124:127], a[132:135], a[28:31]
    ds_read_b64_tr_b16 a[178:179], v24 offset:12544
    v_mfma_f32_16x16x32_bf16 a[32:35], a[112:115], a[136:139], a[32:35]
    v_mfma_f32_16x16x32_bf16 a[40:43], a[116:119], a[136:139], a[40:43]
    ds_read_b64_tr_b16 a[180:181], v25 offset:12288
    v_mfma_f32_16x16x32_bf16 a[48:51], a[120:123], a[136:139], a[48:51]
    ds_read_b64_tr_b16 a[182:183], v25 offset:12544
    v_mfma_f32_16x16x32_bf16 a[56:59], a[124:127], a[136:139], a[56:59]
    v_mfma_f32_16x16x32_bf16 a[36:39], a[112:115], a[140:143], a[36:39]
    ds_read_b64_tr_b16 a[184:185], v24 offset:14336
    v_mfma_f32_16x16x32_bf16 a[44:47], a[116:119], a[140:143], a[44:47]
    ds_read_b64_tr_b16 a[186:187], v24 offset:14592
    v_mfma_f32_16x16x32_bf16 a[52:55], a[120:123], a[140:143], a[52:55]
    v_mfma_f32_16x16x32_bf16 a[60:63], a[124:127], a[140:143], a[60:63]
    ds_read_b64_tr_b16 a[188:189], v25 offset:14336
    v_mfma_f32_16x16x32_bf16 a[64:67], a[144:147], a[112:115], a[64:67]
    ds_read_b64_tr_b16 a[190:191], v25 offset:14592
    v_mfma_f32_16x16x32_bf16 a[72:75], a[144:147], a[116:119], a[72:75]
    v_mfma_f32_16x16x32_bf16 a[80:83], a[144:147], a[120:123], a[80:83]
    ds_read_b64_tr_b16 a[192:193], v24 offset:16384
    v_mfma_f32_16x16x32_bf16 a[88:91], a[144:147], a[124:127], a[88:91]
    ds_read_b64_tr_b16 a[194:195], v24 offset:16640
    v_mfma_f32_16x16x32_bf16 a[68:71], a[148:151], a[112:115], a[68:71]
    v_mfma_f32_16x16x32_bf16 a[76:79], a[148:151], a[116:119], a[76:79]
    ds_read_b64_tr_b16 a[196:197], v25 offset:16384
    v_mfma_f32_16x16x32_bf16 a[84:87], a[148:151], a[120:123], a[84:87]
    ds_read_b64_tr_b16 a[198:199], v25 offset:16640
    v_mfma_f32_16x16x32_bf16 a[92:95], a[148:151], a[124:127], a[92:95]
    v_mfma_f32_16x16x32_bf16 v[32:35], a[152:155], a[112:115], v[32:35]
    ds_read_b64_tr_b16 a[200:201], v24 offset:18432
    v_mfma_f32_16x16x32_bf16 v[40:43], a[152:155], a[116:119], v[40:43]
    ds_read_b64_tr_b16 a[202:203], v24 offset:18688
    v_mfma_f32_16x16x32_bf16 v[48:51], a[152:155], a[120:123], v[48:51]
    v_mfma_f32_16x16x32_bf16 v[56:59], a[152:155], a[124:127], v[56:59]
    ds_read_b64_tr_b16 a[204:205], v25 offset:18432
    v_mfma_f32_16x16x32_bf16 v[36:39], a[156:159], a[112:115], v[36:39]
    ds_read_b64_tr_b16 a[206:207], v25 offset:18688
    v_mfma_f32_16x16x32_bf16 v[44:47], a[156:159], a[116:119], v[44:47]
    v_mfma_f32_16x16x32_bf16 v[52:55], a[156:159], a[120:123], v[52:55]
    v_mfma_f32_16x16x32_bf16 v[60:63], a[156:159], a[124:127], v[60:63]
    v_mfma_f32_16x16x32_bf16 v[64:67], a[160:163], a[112:115], v[64:67]
    v_mfma_f32_16x16x32_bf16 v[72:75], a[160:163], a[116:119], v[72:75]
    v_mfma_f32_16x16x32_bf16 v[80:83], a[160:163], a[120:123], v[80:83]
    v_mfma_f32_16x16x32_bf16 v[88:91], a[160:163], a[124:127], v[88:91]
    v_mfma_f32_16x16x32_bf16 v[68:71], a[164:167], a[112:115], v[68:71]
    v_mfma_f32_16x16x32_bf16 v[76:79], a[164:167], a[116:119], v[76:79]
    v_mfma_f32_16x16x32_bf16 v[84:87], a[164:167], a[120:123], v[84:87]
    v_mfma_f32_16x16x32_bf16 v[92:95], a[164:167], a[124:127], v[92:95]
    s_waitcnt lgkmcnt(0)
    v_mfma_f32_16x16x32_bf16 v[96:99], a[168:171], a[112:115], v[96:99]
    v_mfma_f32_16x16x32_bf16 v[104:107], a[168:171], a[116:119], v[104:107]
    v_mfma_f32_16x16x32_bf16 v[112:115], a[168:171], a[120:123], v[112:115]
    v_mfma_f32_16x16x32_bf16 v[120:123], a[168:171], a[124:127], v[120:123]
    v_mfma_f32_16x16x32_bf16 v[100:103], a[172:175], a[112:115], v[100:103]
    v_mfma_f32_16x16x32_bf16 v[108:111], a[172:175], a[116:119], v[108:111]
    v_mfma_f32_16x16x32_bf16 v[116:119], a[172:175], a[120:123], v[116:119]
    v_mfma_f32_16x16x32_bf16 v[124:127], a[172:175], a[124:127], v[124:127]
    v_mfma_f32_16x16x32_bf16 v[128:131], a[176:179], a[112:115], v[128:131]
    v_mfma_f32_16x16x32_bf16 v[136:139], a[176:179], a[116:119], v[136:139]
    v_mfma_f32_16x16x32_bf16 v[144:147], a[176:179], a[120:123], v[144:147]
    v_mfma_f32_16x16x32_bf16 v[152:155], a[176:179], a[124:127], v[152:155]
    v_mfma_f32_16x16x32_bf16 v[132:135], a[180:183], a[112:115], v[132:135]
    v_mfma_f32_16x16x32_bf16 v[140:143], a[180:183], a[116:119], v[140:143]
    v_mfma_f32_16x16x32_bf16 v[148:151], a[180:183], a[120:123], v[148:151]
    v_mfma_f32_16x16x32_bf16 v[156:159], a[180:183], a[124:127], v[156:159]
    v_mfma_f32_16x16x32_bf16 v[160:163], a[184:187], a[112:115], v[160:163]
    v_mfma_f32_16x16x32_bf16 v[168:171], a[184:187], a[116:119], v[168:171]
    v_mfma_f32_16x16x32_bf16 v[176:179], a[184:187], a[120:123], v[176:179]
    v_mfma_f32_16x16x32_bf16 v[184:187], a[184:187], a[124:127], v[184:187]
    v_mfma_f32_16x16x32_bf16 v[164:167], a[188:191], a[112:115], v[164:167]
    v_mfma_f32_16x16x32_bf16 v[172:175], a[188:191], a[116:119], v[172:175]
    v_mfma_f32_16x16x32_bf16 v[180:183], a[188:191], a[120:123], v[180:183]
    v_mfma_f32_16x16x32_bf16 v[188:191], a[188:191], a[124:127], v[188:191]
    v_mfma_f32_16x16x32_bf16 v[192:195], a[192:195], a[112:115], v[192:195]
    v_mfma_f32_16x16x32_bf16 v[200:203], a[192:195], a[116:119], v[200:203]
    v_mfma_f32_16x16x32_bf16 v[208:211], a[192:195], a[120:123], v[208:211]
    v_mfma_f32_16x16x32_bf16 v[216:219], a[192:195], a[124:127], v[216:219]
    v_mfma_f32_16x16x32_bf16 v[196:199], a[196:199], a[112:115], v[196:199]
    v_mfma_f32_16x16x32_bf16 v[204:207], a[196:199], a[116:119], v[204:207]
    v_mfma_f32_16x16x32_bf16 v[212:215], a[196:199], a[120:123], v[212:215]
    v_mfma_f32_16x16x32_bf16 v[220:223], a[196:199], a[124:127], v[220:223]
    v_mfma_f32_16x16x32_bf16 v[224:227], a[200:203], a[112:115], v[224:227]
    v_mfma_f32_16x16x32_bf16 v[232:235], a[200:203], a[116:119], v[232:235]
    v_mfma_f32_16x16x32_bf16 v[240:243], a[200:203], a[120:123], v[240:243]
    v_mfma_f32_16x16x32_bf16 v[248:251], a[200:203], a[124:127], v[248:251]
    v_mfma_f32_16x16x32_bf16 v[228:231], a[204:207], a[112:115], v[228:231]
    v_mfma_f32_16x16x32_bf16 v[236:239], a[204:207], a[116:119], v[236:239]
    v_mfma_f32_16x16x32_bf16 v[244:247], a[204:207], a[120:123], v[244:247]
    v_mfma_f32_16x16x32_bf16 v[252:255], a[204:207], a[124:127], v[252:255]
    s_nop 15
    v_mov_b32 v3, 0
    v_lshlrev_b32 v4, 2, v0
    s_lshl_b32 s3, s2, 7
    s_add_u32 s3, s3, 28377088
    v_cmp_gt_u32 vcc, 32, v0
    s_and_saveexec_b64 s[92:93], vcc
    buffer_store_dword v3, v4, s[28:31], s3 offen
    s_mov_b64 exec, s[92:93]
    s_mov_b32 s8, s96
    s_and_b32 s9, s97, 0xffff
    s_mov_b32 s10, 0x200000
    s_mov_b32 s11, 0x00020000
    s_mov_b32 s12, s98
    s_and_b32 s13, s99, 0xffff
    s_mov_b32 s14, 0x700000
    s_mov_b32 s15, 0x00020000
    v_lshlrev_b32 v3, 4, v0
    s_lshl_b32 s3, s2, 13
    buffer_load_dwordx4 a[96:99], v3, s[8:11], s3 offen
    s_add_u32 s3, s3, 4096
    buffer_load_dwordx4 a[100:103], v3, s[8:11], s3 offen
    s_add_u32 s3, s3, 4096
    s_mul_i32 s3, s2, 28672
    buffer_load_dwordx4 a[104:107], v3, s[12:15], s3 offen
    s_add_u32 s3, s3, 4096
    buffer_load_dwordx4 a[108:111], v3, s[12:15], s3 offen
    s_add_u32 s3, s3, 4096
    buffer_load_dwordx4 a[112:115], v3, s[12:15], s3 offen
    s_add_u32 s3, s3, 4096
    buffer_load_dwordx4 a[116:119], v3, s[12:15], s3 offen
    s_add_u32 s3, s3, 4096
    buffer_load_dwordx4 a[120:123], v3, s[12:15], s3 offen
    s_add_u32 s3, s3, 4096
    buffer_load_dwordx4 a[124:127], v3, s[12:15], s3 offen
    s_add_u32 s3, s3, 4096
    buffer_load_dwordx4 a[128:131], v3, s[12:15], s3 offen
    s_add_u32 s3, s3, 4096
    v_and_b32 v3, 15, v2
    v_lshlrev_b32 v4, 6, v1
    v_add_u32 v3, v3, v4
    v_bfe_u32 v5, v2, 4, 1
    v_lshlrev_b32 v5, 5, v5
    v_lshrrev_b32 v4, 5, v2
    v_lshl_add_u32 v5, v4, 4, v5
    s_movk_i32 s3, 9216
    v_mul_lo_u32 v26, v3, s3
    v_add_u32 v26, v26, v5
    v_lshlrev_b32 v27, 11, v3
    v_add_u32 v27, v27, v5
    s_mul_i32 s64, s33, 2359296
    s_add_u32 s64, s64, 4196352
    s_lshl_b32 s65, s33, 19
    s_add_u32 s65, s65, 0
    v_pk_mul_f32 v[192:193], v[192:193], v[224:225]
    v_pk_mul_f32 v[194:195], v[194:195], v[226:227]
    v_pk_mul_f32 v[196:197], v[196:197], v[228:229]
    v_pk_mul_f32 v[198:199], v[198:199], v[230:231]
    v_pk_mul_f32 v[200:201], v[200:201], v[232:233]
    v_pk_mul_f32 v[202:203], v[202:203], v[234:235]
    v_pk_mul_f32 v[204:205], v[204:205], v[236:237]
    v_pk_mul_f32 v[206:207], v[206:207], v[238:239]
    v_pk_mul_f32 v[208:209], v[208:209], v[240:241]
    v_pk_mul_f32 v[210:211], v[210:211], v[242:243]
    v_pk_mul_f32 v[212:213], v[212:213], v[244:245]
    v_pk_mul_f32 v[214:215], v[214:215], v[246:247]
    v_pk_mul_f32 v[216:217], v[216:217], v[248:249]
    v_pk_mul_f32 v[218:219], v[218:219], v[250:251]
    v_pk_mul_f32 v[220:221], v[220:221], v[252:253]
    v_pk_mul_f32 v[222:223], v[222:223], v[254:255]
    v_cvt_pk_bf16_f32 v224, v192, v193
    v_cvt_pk_bf16_f32 v225, v194, v195
    v_cvt_pk_bf16_f32 v226, v196, v197
    v_cvt_pk_bf16_f32 v227, v198, v199
    v_cvt_pk_bf16_f32 v228, v200, v201
    v_cvt_pk_bf16_f32 v229, v202, v203
    v_cvt_pk_bf16_f32 v230, v204, v205
    v_cvt_pk_bf16_f32 v231, v206, v207
    v_cvt_pk_bf16_f32 v232, v208, v209
    v_cvt_pk_bf16_f32 v233, v210, v211
    v_cvt_pk_bf16_f32 v234, v212, v213
    v_cvt_pk_bf16_f32 v235, v214, v215
    v_cvt_pk_bf16_f32 v236, v216, v217
    v_cvt_pk_bf16_f32 v237, v218, v219
    v_cvt_pk_bf16_f32 v238, v220, v221
    v_cvt_pk_bf16_f32 v239, v222, v223
    s_nop 0
    v_permlane16_swap_b32 v224, v226
    v_permlane16_swap_b32 v225, v227
    v_permlane16_swap_b32 v228, v230
    v_permlane16_swap_b32 v229, v231
    v_permlane16_swap_b32 v232, v234
    v_permlane16_swap_b32 v233, v235
    v_permlane16_swap_b32 v236, v238
    v_permlane16_swap_b32 v237, v239
    s_add_u32 s3, s64, s56
    buffer_store_dwordx4 v[224:227], v26, s[28:31], s3 offen
    s_add_u32 s3, s3, 147456
    buffer_store_dwordx4 v[228:231], v26, s[28:31], s3 offen
    s_add_u32 s3, s3, 147456
    buffer_store_dwordx4 v[232:235], v26, s[28:31], s3 offen
    s_add_u32 s3, s3, 147456
    buffer_store_dwordx4 v[236:239], v26, s[28:31], s3 offen
    v_pk_mul_f32 v[128:129], v[128:129], v[160:161]
    v_pk_mul_f32 v[130:131], v[130:131], v[162:163]
    v_pk_mul_f32 v[132:133], v[132:133], v[164:165]
    v_pk_mul_f32 v[134:135], v[134:135], v[166:167]
    v_pk_mul_f32 v[136:137], v[136:137], v[168:169]
    v_pk_mul_f32 v[138:139], v[138:139], v[170:171]
    v_pk_mul_f32 v[140:141], v[140:141], v[172:173]
    v_pk_mul_f32 v[142:143], v[142:143], v[174:175]
    v_pk_mul_f32 v[144:145], v[144:145], v[176:177]
    v_pk_mul_f32 v[146:147], v[146:147], v[178:179]
    v_pk_mul_f32 v[148:149], v[148:149], v[180:181]
    v_pk_mul_f32 v[150:151], v[150:151], v[182:183]
    v_pk_mul_f32 v[152:153], v[152:153], v[184:185]
    v_pk_mul_f32 v[154:155], v[154:155], v[186:187]
    v_pk_mul_f32 v[156:157], v[156:157], v[188:189]
    v_pk_mul_f32 v[158:159], v[158:159], v[190:191]
    v_cvt_pk_bf16_f32 v160, v128, v129
    v_cvt_pk_bf16_f32 v161, v130, v131
    v_cvt_pk_bf16_f32 v162, v132, v133
    v_cvt_pk_bf16_f32 v163, v134, v135
    v_cvt_pk_bf16_f32 v164, v136, v137
    v_cvt_pk_bf16_f32 v165, v138, v139
    v_cvt_pk_bf16_f32 v166, v140, v141
    v_cvt_pk_bf16_f32 v167, v142, v143
    v_cvt_pk_bf16_f32 v168, v144, v145
    v_cvt_pk_bf16_f32 v169, v146, v147
    v_cvt_pk_bf16_f32 v170, v148, v149
    v_cvt_pk_bf16_f32 v171, v150, v151
    v_cvt_pk_bf16_f32 v172, v152, v153
    v_cvt_pk_bf16_f32 v173, v154, v155
    v_cvt_pk_bf16_f32 v174, v156, v157
    v_cvt_pk_bf16_f32 v175, v158, v159
    s_nop 0
    v_permlane16_swap_b32 v160, v162
    v_permlane16_swap_b32 v161, v163
    v_permlane16_swap_b32 v164, v166
    v_permlane16_swap_b32 v165, v167
    v_permlane16_swap_b32 v168, v170
    v_permlane16_swap_b32 v169, v171
    v_permlane16_swap_b32 v172, v174
    v_permlane16_swap_b32 v173, v175
    s_add_u32 s3, s64, s54
    buffer_store_dwordx4 v[160:163], v26, s[28:31], s3 offen
    s_add_u32 s3, s3, 147456
    buffer_store_dwordx4 v[164:167], v26, s[28:31], s3 offen
    s_add_u32 s3, s3, 147456
    buffer_store_dwordx4 v[168:171], v26, s[28:31], s3 offen
    s_add_u32 s3, s3, 147456
    buffer_store_dwordx4 v[172:175], v26, s[28:31], s3 offen
    v_mov_b32 v28, 0x3f803f80
    v_mov_b32 v29, 0x3f803f80
    v_mov_b32 v30, 0x3f803f80
    v_mov_b32 v31, 0x3f803f80
    v_accvgpr_read_b32 v192, a0
    v_accvgpr_read_b32 v193, a1
    v_accvgpr_read_b32 v194, a2
    v_accvgpr_read_b32 v195, a3
    v_accvgpr_read_b32 v196, a4
    v_accvgpr_read_b32 v197, a5
    v_accvgpr_read_b32 v198, a6
    v_accvgpr_read_b32 v199, a7
    v_accvgpr_read_b32 v200, a8
    v_accvgpr_read_b32 v201, a9
    v_accvgpr_read_b32 v202, a10
    v_accvgpr_read_b32 v203, a11
    v_accvgpr_read_b32 v204, a12
    v_accvgpr_read_b32 v205, a13
    v_accvgpr_read_b32 v206, a14
    v_accvgpr_read_b32 v207, a15
    v_accvgpr_read_b32 v208, a16
    v_accvgpr_read_b32 v209, a17
    v_accvgpr_read_b32 v210, a18
    v_accvgpr_read_b32 v211, a19
    v_accvgpr_read_b32 v212, a20
    v_accvgpr_read_b32 v213, a21
    v_accvgpr_read_b32 v214, a22
    v_accvgpr_read_b32 v215, a23
    v_accvgpr_read_b32 v216, a24
    v_accvgpr_read_b32 v217, a25
    v_accvgpr_read_b32 v218, a26
    v_accvgpr_read_b32 v219, a27
    v_accvgpr_read_b32 v220, a28
    v_accvgpr_read_b32 v221, a29
    v_accvgpr_read_b32 v222, a30
    v_accvgpr_read_b32 v223, a31
    v_mul_f32 v128, 0x3fb8aa3b, v192
    v_mul_f32 v129, 0x3fb8aa3b, v193
    v_mul_f32 v130, 0x3fb8aa3b, v194
    v_mul_f32 v131, 0x3fb8aa3b, v195
    v_mul_f32 v132, 0x3fb8aa3b, v196
    v_mul_f32 v133, 0x3fb8aa3b, v197
    v_mul_f32 v134, 0x3fb8aa3b, v198
    v_mul_f32 v135, 0x3fb8aa3b, v199
    v_mul_f32 v136, 0x3fb8aa3b, v200
    v_mul_f32 v137, 0x3fb8aa3b, v201
    v_mul_f32 v138, 0x3fb8aa3b, v202
    v_mul_f32 v139, 0x3fb8aa3b, v203
    v_mul_f32 v140, 0x3fb8aa3b, v204
    v_mul_f32 v141, 0x3fb8aa3b, v205
    v_mul_f32 v142, 0x3fb8aa3b, v206
    v_mul_f32 v143, 0x3fb8aa3b, v207
    v_mul_f32 v144, 0x3fb8aa3b, v208
    v_mul_f32 v145, 0x3fb8aa3b, v209
    v_mul_f32 v146, 0x3fb8aa3b, v210
    v_mul_f32 v147, 0x3fb8aa3b, v211
    v_mul_f32 v148, 0x3fb8aa3b, v212
    v_mul_f32 v149, 0x3fb8aa3b, v213
    v_mul_f32 v150, 0x3fb8aa3b, v214
    v_mul_f32 v151, 0x3fb8aa3b, v215
    v_mul_f32 v152, 0x3fb8aa3b, v216
    v_mul_f32 v153, 0x3fb8aa3b, v217
    v_mul_f32 v154, 0x3fb8aa3b, v218
    v_mul_f32 v155, 0x3fb8aa3b, v219
    v_mul_f32 v156, 0x3fb8aa3b, v220
    v_mul_f32 v157, 0x3fb8aa3b, v221
    v_mul_f32 v158, 0x3fb8aa3b, v222
    v_mul_f32 v159, 0x3fb8aa3b, v223
    v_min_f32 v128, 0, v128
    v_min_f32 v129, 0, v129
    v_min_f32 v130, 0, v130
    v_min_f32 v131, 0, v131
    v_min_f32 v132, 0, v132
    v_min_f32 v133, 0, v133
    v_min_f32 v134, 0, v134
    v_min_f32 v135, 0, v135
    v_min_f32 v136, 0, v136
    v_min_f32 v137, 0, v137
    v_min_f32 v138, 0, v138
    v_min_f32 v139, 0, v139
    v_min_f32 v140, 0, v140
    v_min_f32 v141, 0, v141
    v_min_f32 v142, 0, v142
    v_min_f32 v143, 0, v143
    v_min_f32 v144, 0, v144
    v_min_f32 v145, 0, v145
    v_min_f32 v146, 0, v146
    v_min_f32 v147, 0, v147
    v_min_f32 v148, 0, v148
    v_min_f32 v149, 0, v149
    v_min_f32 v150, 0, v150
    v_min_f32 v151, 0, v151
    v_min_f32 v152, 0, v152
    v_min_f32 v153, 0, v153
    v_min_f32 v154, 0, v154
    v_min_f32 v155, 0, v155
    v_min_f32 v156, 0, v156
    v_min_f32 v157, 0, v157
    v_min_f32 v158, 0, v158
    v_min_f32 v159, 0, v159
    v_exp_f32 v128, v128
    v_exp_f32 v129, v129
    v_exp_f32 v130, v130
    v_exp_f32 v131, v131
    v_exp_f32 v132, v132
    v_exp_f32 v133, v133
    v_exp_f32 v134, v134
    v_exp_f32 v135, v135
    v_exp_f32 v136, v136
    v_exp_f32 v137, v137
    v_exp_f32 v138, v138
    v_exp_f32 v139, v139
    v_exp_f32 v140, v140
    v_exp_f32 v141, v141
    v_exp_f32 v142, v142
    v_exp_f32 v143, v143
    v_exp_f32 v144, v144
    v_exp_f32 v145, v145
    v_exp_f32 v146, v146
    v_exp_f32 v147, v147
    v_exp_f32 v148, v148
    v_exp_f32 v149, v149
    v_exp_f32 v150, v150
    v_exp_f32 v151, v151
    v_exp_f32 v152, v152
    v_exp_f32 v153, v153
    v_exp_f32 v154, v154
    v_exp_f32 v155, v155
    v_exp_f32 v156, v156
    v_exp_f32 v157, v157
    v_exp_f32 v158, v158
    v_exp_f32 v159, v159
    v_max_f32 v192, 0, v192
    v_max_f32 v193, 0, v193
    v_max_f32 v194, 0, v194
    v_max_f32 v195, 0, v195
    v_max_f32 v196, 0, v196
    v_max_f32 v197, 0, v197
    v_max_f32 v198, 0, v198
    v_max_f32 v199, 0, v199
    v_max_f32 v200, 0, v200
    v_max_f32 v201, 0, v201
    v_max_f32 v202, 0, v202
    v_max_f32 v203, 0, v203
    v_max_f32 v204, 0, v204
    v_max_f32 v205, 0, v205
    v_max_f32 v206, 0, v206
    v_max_f32 v207, 0, v207
    v_max_f32 v208, 0, v208
    v_max_f32 v209, 0, v209
    v_max_f32 v210, 0, v210
    v_max_f32 v211, 0, v211
    v_max_f32 v212, 0, v212
    v_max_f32 v213, 0, v213
    v_max_f32 v214, 0, v214
    v_max_f32 v215, 0, v215
    v_max_f32 v216, 0, v216
    v_max_f32 v217, 0, v217
    v_max_f32 v218, 0, v218
    v_max_f32 v219, 0, v219
    v_max_f32 v220, 0, v220
    v_max_f32 v221, 0, v221
    v_max_f32 v222, 0, v222
    v_max_f32 v223, 0, v223
    v_add_f32 v192, 0x358637bd, v192
    v_add_f32 v193, 0x358637bd, v193
    v_add_f32 v194, 0x358637bd, v194
    v_add_f32 v195, 0x358637bd, v195
    v_add_f32 v196, 0x358637bd, v196
    v_add_f32 v197, 0x358637bd, v197
    v_add_f32 v198, 0x358637bd, v198
    v_add_f32 v199, 0x358637bd, v199
    v_add_f32 v200, 0x358637bd, v200
    v_add_f32 v201, 0x358637bd, v201
    v_add_f32 v202, 0x358637bd, v202
    v_add_f32 v203, 0x358637bd, v203
    v_add_f32 v204, 0x358637bd, v204
    v_add_f32 v205, 0x358637bd, v205
    v_add_f32 v206, 0x358637bd, v206
    v_add_f32 v207, 0x358637bd, v207
    v_add_f32 v208, 0x358637bd, v208
    v_add_f32 v209, 0x358637bd, v209
    v_add_f32 v210, 0x358637bd, v210
    v_add_f32 v211, 0x358637bd, v211
    v_add_f32 v212, 0x358637bd, v212
    v_add_f32 v213, 0x358637bd, v213
    v_add_f32 v214, 0x358637bd, v214
    v_add_f32 v215, 0x358637bd, v215
    v_add_f32 v216, 0x358637bd, v216
    v_add_f32 v217, 0x358637bd, v217
    v_add_f32 v218, 0x358637bd, v218
    v_add_f32 v219, 0x358637bd, v219
    v_add_f32 v220, 0x358637bd, v220
    v_add_f32 v221, 0x358637bd, v221
    v_add_f32 v222, 0x358637bd, v222
    v_add_f32 v223, 0x358637bd, v223
    v_add_f32 v192, v192, v128
    v_add_f32 v193, v193, v129
    v_add_f32 v194, v194, v130
    v_add_f32 v195, v195, v131
    v_add_f32 v196, v196, v132
    v_add_f32 v197, v197, v133
    v_add_f32 v198, v198, v134
    v_add_f32 v199, v199, v135
    v_add_f32 v200, v200, v136
    v_add_f32 v201, v201, v137
    v_add_f32 v202, v202, v138
    v_add_f32 v203, v203, v139
    v_add_f32 v204, v204, v140
    v_add_f32 v205, v205, v141
    v_add_f32 v206, v206, v142
    v_add_f32 v207, v207, v143
    v_add_f32 v208, v208, v144
    v_add_f32 v209, v209, v145
    v_add_f32 v210, v210, v146
    v_add_f32 v211, v211, v147
    v_add_f32 v212, v212, v148
    v_add_f32 v213, v213, v149
    v_add_f32 v214, v214, v150
    v_add_f32 v215, v215, v151
    v_add_f32 v216, v216, v152
    v_add_f32 v217, v217, v153
    v_add_f32 v218, v218, v154
    v_add_f32 v219, v219, v155
    v_add_f32 v220, v220, v156
    v_add_f32 v221, v221, v157
    v_add_f32 v222, v222, v158
    v_add_f32 v223, v223, v159
    v_cvt_pk_bf16_f32 v240, v192, v193
    v_cvt_pk_bf16_f32 v241, v194, v195
    v_cvt_pk_bf16_f32 v242, v200, v201
    v_cvt_pk_bf16_f32 v243, v202, v203
    v_cvt_pk_bf16_f32 v244, v196, v197
    v_cvt_pk_bf16_f32 v245, v198, v199
    v_cvt_pk_bf16_f32 v246, v204, v205
    v_cvt_pk_bf16_f32 v247, v206, v207
    v_cvt_pk_bf16_f32 v248, v208, v209
    v_cvt_pk_bf16_f32 v249, v210, v211
    v_cvt_pk_bf16_f32 v250, v216, v217
    v_cvt_pk_bf16_f32 v251, v218, v219
    v_cvt_pk_bf16_f32 v252, v212, v213
    v_cvt_pk_bf16_f32 v253, v214, v215
    v_cvt_pk_bf16_f32 v254, v220, v221
    v_cvt_pk_bf16_f32 v255, v222, v223
    v_accvgpr_read_b32 v192, a32
    v_accvgpr_read_b32 v193, a33
    v_accvgpr_read_b32 v194, a34
    v_accvgpr_read_b32 v195, a35
    v_accvgpr_read_b32 v196, a36
    v_accvgpr_read_b32 v197, a37
    v_accvgpr_read_b32 v198, a38
    v_accvgpr_read_b32 v199, a39
    v_accvgpr_read_b32 v200, a40
    v_accvgpr_read_b32 v201, a41
    v_accvgpr_read_b32 v202, a42
    v_accvgpr_read_b32 v203, a43
    v_accvgpr_read_b32 v204, a44
    v_accvgpr_read_b32 v205, a45
    v_accvgpr_read_b32 v206, a46
    v_accvgpr_read_b32 v207, a47
    v_accvgpr_read_b32 v208, a48
    v_accvgpr_read_b32 v209, a49
    v_accvgpr_read_b32 v210, a50
    v_accvgpr_read_b32 v211, a51
    v_accvgpr_read_b32 v212, a52
    v_accvgpr_read_b32 v213, a53
    v_accvgpr_read_b32 v214, a54
    v_accvgpr_read_b32 v215, a55
    v_accvgpr_read_b32 v216, a56
    v_accvgpr_read_b32 v217, a57
    v_accvgpr_read_b32 v218, a58
    v_accvgpr_read_b32 v219, a59
    v_accvgpr_read_b32 v220, a60
    v_accvgpr_read_b32 v221, a61
    v_accvgpr_read_b32 v222, a62
    v_accvgpr_read_b32 v223, a63
    v_cvt_pk_bf16_f32 v176, v192, v193
    v_cvt_pk_bf16_f32 v177, v194, v195
    v_cvt_pk_bf16_f32 v178, v200, v201
    v_cvt_pk_bf16_f32 v179, v202, v203
    v_cvt_pk_bf16_f32 v180, v196, v197
    v_cvt_pk_bf16_f32 v181, v198, v199
    v_cvt_pk_bf16_f32 v182, v204, v205
    v_cvt_pk_bf16_f32 v183, v206, v207
    v_cvt_pk_bf16_f32 v184, v208, v209
    v_cvt_pk_bf16_f32 v185, v210, v211
    v_cvt_pk_bf16_f32 v186, v216, v217
    v_cvt_pk_bf16_f32 v187, v218, v219
    v_cvt_pk_bf16_f32 v188, v212, v213
    v_cvt_pk_bf16_f32 v189, v214, v215
    v_cvt_pk_bf16_f32 v190, v220, v221
    v_cvt_pk_bf16_f32 v191, v222, v223
    s_nop 1
    v_mfma_f32_16x16x32_bf16 v[128:131], v[240:243], v[176:179], 0
    v_mfma_f32_16x16x32_bf16 v[132:135], v[240:243], v[180:183], 0
    v_mfma_f32_16x16x32_bf16 v[144:147], v[240:243], v[28:31], 0
    v_mfma_f32_16x16x32_bf16 v[136:139], v[244:247], v[176:179], 0
    v_mfma_f32_16x16x32_bf16 v[140:143], v[244:247], v[180:183], 0
    v_mfma_f32_16x16x32_bf16 v[148:151], v[244:247], v[28:31], 0
    v_mfma_f32_16x16x32_bf16 v[128:131], v[248:251], v[184:187], v[128:131]
    v_mfma_f32_16x16x32_bf16 v[132:135], v[248:251], v[188:191], v[132:135]
    v_mfma_f32_16x16x32_bf16 v[144:147], v[248:251], v[28:31], v[144:147]
    v_mfma_f32_16x16x32_bf16 v[136:139], v[252:255], v[184:187], v[136:139]
    v_mfma_f32_16x16x32_bf16 v[140:143], v[252:255], v[188:191], v[140:143]
    v_mfma_f32_16x16x32_bf16 v[148:151], v[252:255], v[28:31], v[148:151]
    s_barrier
    v_lshlrev_b32 v3, 4, v2
    v_lshlrev_b32 v4, 13, v1
    v_add_u32 v3, v3, v4
    s_nop 7
    ds_write_b128 v3, v[128:131] offset:0
    ds_write_b128 v3, v[132:135] offset:1024
    ds_write_b128 v3, v[136:139] offset:2048
    ds_write_b128 v3, v[140:143] offset:3072
    ds_write_b128 v3, v[144:147] offset:4096
    ds_write_b128 v3, v[144:147] offset:5120
    ds_write_b128 v3, v[148:151] offset:6144
    ds_write_b128 v3, v[148:151] offset:7168
    v_pk_mul_f32 v[64:65], v[64:65], v[96:97]
    v_pk_mul_f32 v[66:67], v[66:67], v[98:99]
    v_pk_mul_f32 v[68:69], v[68:69], v[100:101]
    v_pk_mul_f32 v[70:71], v[70:71], v[102:103]
    v_pk_mul_f32 v[72:73], v[72:73], v[104:105]
    v_pk_mul_f32 v[74:75], v[74:75], v[106:107]
    v_pk_mul_f32 v[76:77], v[76:77], v[108:109]
    v_pk_mul_f32 v[78:79], v[78:79], v[110:111]
    v_pk_mul_f32 v[80:81], v[80:81], v[112:113]
    v_pk_mul_f32 v[82:83], v[82:83], v[114:115]
    v_pk_mul_f32 v[84:85], v[84:85], v[116:117]
    v_pk_mul_f32 v[86:87], v[86:87], v[118:119]
    v_pk_mul_f32 v[88:89], v[88:89], v[120:121]
    v_pk_mul_f32 v[90:91], v[90:91], v[122:123]
    v_pk_mul_f32 v[92:93], v[92:93], v[124:125]
    v_pk_mul_f32 v[94:95], v[94:95], v[126:127]
    v_cvt_pk_bf16_f32 v96, v64, v65
    v_cvt_pk_bf16_f32 v97, v66, v67
    v_cvt_pk_bf16_f32 v98, v68, v69
    v_cvt_pk_bf16_f32 v99, v70, v71
    v_cvt_pk_bf16_f32 v100, v72, v73
    v_cvt_pk_bf16_f32 v101, v74, v75
    v_cvt_pk_bf16_f32 v102, v76, v77
    v_cvt_pk_bf16_f32 v103, v78, v79
    v_cvt_pk_bf16_f32 v104, v80, v81
    v_cvt_pk_bf16_f32 v105, v82, v83
    v_cvt_pk_bf16_f32 v106, v84, v85
    v_cvt_pk_bf16_f32 v107, v86, v87
    v_cvt_pk_bf16_f32 v108, v88, v89
    v_cvt_pk_bf16_f32 v109, v90, v91
    v_cvt_pk_bf16_f32 v110, v92, v93
    v_cvt_pk_bf16_f32 v111, v94, v95
    s_nop 0
    v_permlane16_swap_b32 v96, v98
    v_permlane16_swap_b32 v97, v99
    v_permlane16_swap_b32 v100, v102
    v_permlane16_swap_b32 v101, v103
    v_permlane16_swap_b32 v104, v106
    v_permlane16_swap_b32 v105, v107
    v_permlane16_swap_b32 v108, v110
    v_permlane16_swap_b32 v109, v111
    s_add_u32 s3, s64, s52
    buffer_store_dwordx4 v[96:99], v26, s[28:31], s3 offen
    s_add_u32 s3, s3, 147456
    buffer_store_dwordx4 v[100:103], v26, s[28:31], s3 offen
    s_add_u32 s3, s3, 147456
    buffer_store_dwordx4 v[104:107], v26, s[28:31], s3 offen
    s_add_u32 s3, s3, 147456
    buffer_store_dwordx4 v[108:111], v26, s[28:31], s3 offen
    v_accvgpr_read_b32 v192, a64
    v_accvgpr_read_b32 v193, a65
    v_accvgpr_read_b32 v194, a66
    v_accvgpr_read_b32 v195, a67
    v_accvgpr_read_b32 v196, a68
    v_accvgpr_read_b32 v197, a69
    v_accvgpr_read_b32 v198, a70
    v_accvgpr_read_b32 v199, a71
    v_accvgpr_read_b32 v200, a72
    v_accvgpr_read_b32 v201, a73
    v_accvgpr_read_b32 v202, a74
    v_accvgpr_read_b32 v203, a75
    v_accvgpr_read_b32 v204, a76
    v_accvgpr_read_b32 v205, a77
    v_accvgpr_read_b32 v206, a78
    v_accvgpr_read_b32 v207, a79
    v_accvgpr_read_b32 v208, a80
    v_accvgpr_read_b32 v209, a81
    v_accvgpr_read_b32 v210, a82
    v_accvgpr_read_b32 v211, a83
    v_accvgpr_read_b32 v212, a84
    v_accvgpr_read_b32 v213, a85
    v_accvgpr_read_b32 v214, a86
    v_accvgpr_read_b32 v215, a87
    v_accvgpr_read_b32 v216, a88
    v_accvgpr_read_b32 v217, a89
    v_accvgpr_read_b32 v218, a90
    v_accvgpr_read_b32 v219, a91
    v_accvgpr_read_b32 v220, a92
    v_accvgpr_read_b32 v221, a93
    v_accvgpr_read_b32 v222, a94
    v_accvgpr_read_b32 v223, a95
    s_cmp_eq_u32 s37, 0
    s_cbranch_scc0 K1_SLOT1_GLU
    v_cvt_pk_bf16_f32 v64, v192, v193
    v_cvt_pk_bf16_f32 v65, v194, v195
    v_cvt_pk_bf16_f32 v66, v196, v197
    v_cvt_pk_bf16_f32 v67, v198, v199
    v_cvt_pk_bf16_f32 v68, v200, v201
    v_cvt_pk_bf16_f32 v69, v202, v203
    v_cvt_pk_bf16_f32 v70, v204, v205
    v_cvt_pk_bf16_f32 v71, v206, v207
    v_cvt_pk_bf16_f32 v72, v208, v209
    v_cvt_pk_bf16_f32 v73, v210, v211
    v_cvt_pk_bf16_f32 v74, v212, v213
    v_cvt_pk_bf16_f32 v75, v214, v215
    v_cvt_pk_bf16_f32 v76, v216, v217
    v_cvt_pk_bf16_f32 v77, v218, v219
    v_cvt_pk_bf16_f32 v78, v220, v221
    v_cvt_pk_bf16_f32 v79, v222, v223
    s_nop 0
    v_permlane16_swap_b32 v64, v66
    v_permlane16_swap_b32 v65, v67
    v_permlane16_swap_b32 v68, v70
    v_permlane16_swap_b32 v69, v71
    v_permlane16_swap_b32 v72, v74
    v_permlane16_swap_b32 v73, v75
    v_permlane16_swap_b32 v76, v78
    v_permlane16_swap_b32 v77, v79
    s_add_u32 s3, s65, s50
    buffer_store_dwordx4 v[64:67], v27, s[28:31], s3 offen
    s_add_u32 s3, s3, 32768
    buffer_store_dwordx4 v[68:71], v27, s[28:31], s3 offen
    s_add_u32 s3, s3, 32768
    buffer_store_dwordx4 v[72:75], v27, s[28:31], s3 offen
    s_add_u32 s3, s3, 32768
    buffer_store_dwordx4 v[76:79], v27, s[28:31], s3 offen
    v_cvt_pk_bf16_f32 v80, v32, v33
    v_cvt_pk_bf16_f32 v81, v34, v35
    v_cvt_pk_bf16_f32 v82, v36, v37
    v_cvt_pk_bf16_f32 v83, v38, v39
    v_cvt_pk_bf16_f32 v84, v40, v41
    v_cvt_pk_bf16_f32 v85, v42, v43
    v_cvt_pk_bf16_f32 v86, v44, v45
    v_cvt_pk_bf16_f32 v87, v46, v47
    v_cvt_pk_bf16_f32 v88, v48, v49
    v_cvt_pk_bf16_f32 v89, v50, v51
    v_cvt_pk_bf16_f32 v90, v52, v53
    v_cvt_pk_bf16_f32 v91, v54, v55
    v_cvt_pk_bf16_f32 v92, v56, v57
    v_cvt_pk_bf16_f32 v93, v58, v59
    v_cvt_pk_bf16_f32 v94, v60, v61
    v_cvt_pk_bf16_f32 v95, v62, v63
    s_nop 0
    v_permlane16_swap_b32 v80, v82
    v_permlane16_swap_b32 v81, v83
    v_permlane16_swap_b32 v84, v86
    v_permlane16_swap_b32 v85, v87
    v_permlane16_swap_b32 v88, v90
    v_permlane16_swap_b32 v89, v91
    v_permlane16_swap_b32 v92, v94
    v_permlane16_swap_b32 v93, v95
    s_add_u32 s3, s65, s51
    buffer_store_dwordx4 v[80:83], v27, s[28:31], s3 offen
    s_add_u32 s3, s3, 32768
    buffer_store_dwordx4 v[84:87], v27, s[28:31], s3 offen
    s_add_u32 s3, s3, 32768
    buffer_store_dwordx4 v[88:91], v27, s[28:31], s3 offen
    s_add_u32 s3, s3, 32768
    buffer_store_dwordx4 v[92:95], v27, s[28:31], s3 offen
    s_branch K1_SLOT1_DONE
K1_SLOT1_GLU:
    v_pk_mul_f32 v[192:193], v[192:193], v[32:33]
    v_pk_mul_f32 v[194:195], v[194:195], v[34:35]
    v_pk_mul_f32 v[196:197], v[196:197], v[36:37]
    v_pk_mul_f32 v[198:199], v[198:199], v[38:39]
    v_pk_mul_f32 v[200:201], v[200:201], v[40:41]
    v_pk_mul_f32 v[202:203], v[202:203], v[42:43]
    v_pk_mul_f32 v[204:205], v[204:205], v[44:45]
    v_pk_mul_f32 v[206:207], v[206:207], v[46:47]
    v_pk_mul_f32 v[208:209], v[208:209], v[48:49]
    v_pk_mul_f32 v[210:211], v[210:211], v[50:51]
    v_pk_mul_f32 v[212:213], v[212:213], v[52:53]
    v_pk_mul_f32 v[214:215], v[214:215], v[54:55]
    v_pk_mul_f32 v[216:217], v[216:217], v[56:57]
    v_pk_mul_f32 v[218:219], v[218:219], v[58:59]
    v_pk_mul_f32 v[220:221], v[220:221], v[60:61]
    v_pk_mul_f32 v[222:223], v[222:223], v[62:63]
    v_cvt_pk_bf16_f32 v64, v192, v193
    v_cvt_pk_bf16_f32 v65, v194, v195
    v_cvt_pk_bf16_f32 v66, v196, v197
    v_cvt_pk_bf16_f32 v67, v198, v199
    v_cvt_pk_bf16_f32 v68, v200, v201
    v_cvt_pk_bf16_f32 v69, v202, v203
    v_cvt_pk_bf16_f32 v70, v204, v205
    v_cvt_pk_bf16_f32 v71, v206, v207
    v_cvt_pk_bf16_f32 v72, v208, v209
    v_cvt_pk_bf16_f32 v73, v210, v211
    v_cvt_pk_bf16_f32 v74, v212, v213
    v_cvt_pk_bf16_f32 v75, v214, v215
    v_cvt_pk_bf16_f32 v76, v216, v217
    v_cvt_pk_bf16_f32 v77, v218, v219
    v_cvt_pk_bf16_f32 v78, v220, v221
    v_cvt_pk_bf16_f32 v79, v222, v223
    s_nop 0
    v_permlane16_swap_b32 v64, v66
    v_permlane16_swap_b32 v65, v67
    v_permlane16_swap_b32 v68, v70
    v_permlane16_swap_b32 v69, v71
    v_permlane16_swap_b32 v72, v74
    v_permlane16_swap_b32 v73, v75
    v_permlane16_swap_b32 v76, v78
    v_permlane16_swap_b32 v77, v79
    s_add_u32 s3, s64, s50
    buffer_store_dwordx4 v[64:67], v26, s[28:31], s3 offen
    s_add_u32 s3, s3, 147456
    buffer_store_dwordx4 v[68:71], v26, s[28:31], s3 offen
    s_add_u32 s3, s3, 147456
    buffer_store_dwordx4 v[72:75], v26, s[28:31], s3 offen
    s_add_u32 s3, s3, 147456
    buffer_store_dwordx4 v[76:79], v26, s[28:31], s3 offen
K1_SLOT1_DONE:
    s_waitcnt lgkmcnt(0)
    s_barrier
    v_lshlrev_b32 v3, 4, v0
    ds_read_b128 v[160:163], v3 offset:0
    ds_read_b128 v[176:179], v3 offset:4096
    ds_read_b128 v[164:167], v3 offset:8192
    ds_read_b128 v[180:183], v3 offset:12288
    ds_read_b128 v[168:171], v3 offset:16384
    ds_read_b128 v[184:187], v3 offset:20480
    ds_read_b128 v[172:175], v3 offset:24576
    ds_read_b128 v[188:191], v3 offset:28672
    s_waitcnt lgkmcnt(0)
    v_add_f32 v160, v160, v164
    v_add_f32 v168, v168, v172
    v_add_f32 v161, v161, v165
    v_add_f32 v169, v169, v173
    v_add_f32 v162, v162, v166
    v_add_f32 v170, v170, v174
    v_add_f32 v163, v163, v167
    v_add_f32 v171, v171, v175
    v_add_f32 v160, v160, v168
    v_add_f32 v161, v161, v169
    v_add_f32 v162, v162, v170
    v_add_f32 v163, v163, v171
    v_add_f32 v176, v176, v180
    v_add_f32 v184, v184, v188
    v_add_f32 v177, v177, v181
    v_add_f32 v185, v185, v189
    v_add_f32 v178, v178, v182
    v_add_f32 v186, v186, v190
    v_add_f32 v179, v179, v183
    v_add_f32 v187, v187, v191
    v_add_f32 v176, v176, v184
    v_add_f32 v177, v177, v185
    v_add_f32 v178, v178, v186
    v_add_f32 v179, v179, v187
    s_lshl_b32 s3, s34, 3
    s_add_u32 s3, s3, s33
    s_lshl_b32 s3, s3, 13
    s_add_u32 s3, s3, 25165824
    buffer_store_dwordx4 v[160:163], v3, s[28:31], s3 offen
    s_add_u32 s3, s3, 4096
    buffer_store_dwordx4 v[176:179], v3, s[28:31], s3 offen
K1_END:
    s_endpgm

.section .rodata,"a"
.p2align 6
.amdhsa_kernel k1_gemm1_kernel
  .amdhsa_next_free_vgpr 464
  .amdhsa_next_free_sgpr 102
  .amdhsa_accum_offset 256
  .amdhsa_group_segment_fixed_size 0
  .amdhsa_kernarg_size 88
  .amdhsa_user_sgpr_count 2
  .amdhsa_user_sgpr_kernarg_segment_ptr 1
  .amdhsa_system_sgpr_workgroup_id_x 1
.end_amdhsa_kernel
.text

.globl k3_gemm2_kernel
.p2align 8
.type k3_gemm2_kernel,@function
k3_gemm2_kernel:
    s_cmp_ge_u32 s2, 256
    s_cbranch_scc1 K3_END
    s_load_dwordx2 s[64:65], s[0:1], 16
    s_load_dwordx2 s[66:67], s[0:1], 48
    s_load_dwordx4 s[72:75], s[0:1], 72
    s_load_dwordx2 s[76:77], s[0:1], 0
    s_load_dwordx4 s[96:99], s[0:1], 56
    s_and_b32 s36, s2, 1
    s_bfe_u32 s3, s2, 0x20001
    s_lshr_b32 s32, s2, 3
    s_and_b32 s33, s32, 3
    s_lshl_b32 s3, s3, 2
    s_add_u32 s33, s33, s3
    s_lshr_b32 s34, s32, 2
    v_lshrrev_b32 v1, 6, v0
    v_and_b32 v2, 63, v0
    v_readfirstlane_b32 s35, v1
    s_waitcnt lgkmcnt(0)
    s_mov_b32 s28, s74
    s_and_b32 s29, s75, 0xffff
    s_mov_b32 s30, 0x10000000
    s_mov_b32 s31, 0x00020000
    s_mov_b32 s16, s72
    s_and_b32 s17, s73, 0xffff
    s_mov_b32 s18, 0x100
    s_mov_b32 s19, 0x00020000
    s_mul_i32 s3, s33, 1179648
    s_add_u32 s3, s3, 4194304
    s_add_u32 s68, s74, s3
    s_addc_u32 s69, s75, 0
    s_mov_b32 s4, s68
    s_and_b32 s5, s69, 0xffff
    s_mov_b32 s6, 0x120000
    s_mov_b32 s7, 0x00020000
    s_mov_b32 s8, s64
    s_and_b32 s9, s65, 0xffff
    s_mov_b32 s10, 0x200000
    s_mov_b32 s11, 0x00020000
    s_mov_b32 s12, s66
    s_and_b32 s13, s67, 0xffff
    s_mov_b32 s14, 0x700000
    s_mov_b32 s15, 0x00020000
    s_mov_b32 s20, s12
    s_mov_b32 s21, s13
    s_mov_b32 s22, s14
    s_mov_b32 s23, s15
    s_cmp_eq_u32 s36, 0
    s_cselect_b32 s24, s8, s12
    s_cselect_b32 s25, s9, s13
    s_cselect_b32 s26, s10, s14
    s_mul_i32 s60, s36, 2621440
    s_mul_i32 s61, s36, 5242880
    s_lshl_b32 s3, s34, 8
    s_add_u32 s60, s60, s3
    s_add_u32 s61, s61, s3
    s_mul_i32 s59, s36, 2560
    s_add_u32 s59, s59, 2048
    s_mul_i32 s57, s36, 7168
    s_mov_b32 s62, 0
    s_mov_b32 s38, s98
    s_mov_b32 s39, s99
    s_mov_b32 s100, s59
    s_mov_b32 s101, s60
    s_mov_b32 s99, 0
    s_lshl_b32 s3, s99, 7
    s_add_u32 s59, s59, s3
    s_lshl_b32 s3, s99, 17
    s_add_u32 s60, s60, s3
    s_mov_b32 s68, s38
    s_and_b32 s69, s39, 0xffff
    s_mov_b32 s70, 0x400000
    s_mov_b32 s71, 0x00020000
    s_lshl_b32 s45, s35, 12
    s_lshl_b32 s46, s35, 12
    s_add_u32 s46, s46, 16384
    v_lshrrev_b32 v3, 3, v2
    v_lshlrev_b32 v4, 5, v1
    v_add_u32 v3, v3, v4
    s_movk_i32 s3, 9216
    v_mul_lo_u32 v3, v3, s3
    v_lshrrev_b32 v5, 4, v2
    v_and_b32 v6, 7, v2
    v_xor_b32 v7, v6, v5
    v_lshl_add_u32 v10, v7, 4, v3
    v_xor_b32 v7, 4, v7
    v_lshl_add_u32 v11, v7, 4, v3
    v_lshrrev_b32 v3, 4, v2
    v_lshlrev_b32 v4, 4, v1
    v_add_u32 v4, v3, v4
    v_lshlrev_b32 v4, 11, v4
    v_bfe_u32 v5, v2, 2, 2
    v_xor_b32 v5, v5, v3
    v_lshl_add_u32 v4, v5, 6, v4
    v_and_b32 v5, 3, v2
    v_lshl_add_u32 v12, v5, 4, v4
    s_add_u32 m0, s45, 0
    s_add_u32 s3, s59, 0
    buffer_load_dwordx4 v10, s[4:7], s3 offen lds
    s_add_u32 m0, s46, 0
    s_add_u32 s3, s60, 0
    buffer_load_dwordx4 v12, s[20:23], s3 offen lds
    s_add_u32 m0, s45, 1024
    s_add_u32 s3, s59, 73728
    buffer_load_dwordx4 v11, s[4:7], s3 offen lds
    s_add_u32 m0, s46, 1024
    s_add_u32 s3, s60, 8192
    buffer_load_dwordx4 v12, s[20:23], s3 offen lds
    s_add_u32 m0, s45, 2048
    s_add_u32 s3, s59, 147456
    buffer_load_dwordx4 v10, s[4:7], s3 offen lds
    s_add_u32 m0, s46, 2048
    s_add_u32 s3, s60, 16384
    buffer_load_dwordx4 v12, s[20:23], s3 offen lds
    s_add_u32 m0, s45, 3072
    s_add_u32 s3, s59, 221184
    buffer_load_dwordx4 v11, s[4:7], s3 offen lds
    s_add_u32 m0, s46, 3072
    s_add_u32 s3, s60, 24576
    buffer_load_dwordx4 v12, s[20:23], s3 offen lds
    s_add_u32 s59, s59, 128
    s_add_u32 s60, s60, 131072
    s_add_u32 s99, s99, 1
    s_cmp_eq_u32 s99, 20
    s_cselect_b32 s59, s100, s59
    s_cselect_b32 s60, s101, s60
    s_add_u32 s62, s62, 1
    s_cmp_eq_u32 s62, 20
    s_cselect_b32 s60, s61, s60
    s_cselect_b32 s59, s57, s59
    s_cselect_b32 s20, s24, s20
    s_cselect_b32 s21, s25, s21
    s_cselect_b32 s22, s26, s22
    s_add_u32 m0, s45, 32768
    s_add_u32 s3, s59, 0
    buffer_load_dwordx4 v10, s[4:7], s3 offen lds
    s_add_u32 m0, s46, 32768
    s_add_u32 s3, s60, 0
    buffer_load_dwordx4 v12, s[20:23], s3 offen lds
    s_add_u32 m0, s45, 33792
    s_add_u32 s3, s59, 73728
    buffer_load_dwordx4 v11, s[4:7], s3 offen lds
    s_add_u32 m0, s46, 33792
    s_add_u32 s3, s60, 8192
    buffer_load_dwordx4 v12, s[20:23], s3 offen lds
    s_add_u32 m0, s45, 34816
    s_add_u32 s3, s59, 147456
    buffer_load_dwordx4 v10, s[4:7], s3 offen lds
    s_add_u32 m0, s46, 34816
    s_add_u32 s3, s60, 16384
    buffer_load_dwordx4 v12, s[20:23], s3 offen lds
    s_add_u32 m0, s45, 35840
    s_add_u32 s3, s59, 221184
    buffer_load_dwordx4 v11, s[4:7], s3 offen lds
    s_add_u32 m0, s46, 35840
    s_add_u32 s3, s60, 24576
    buffer_load_dwordx4 v12, s[20:23], s3 offen lds
    s_add_u32 s59, s59, 128
    s_add_u32 s60, s60, 131072
    s_add_u32 s99, s99, 1
    s_cmp_eq_u32 s99, 20
    s_cselect_b32 s59, s100, s59
    s_cselect_b32 s60, s101, s60
    s_add_u32 s62, s62, 1
    s_cmp_eq_u32 s62, 20
    s_cselect_b32 s60, s61, s60
    s_cselect_b32 s59, s57, s59
    s_cselect_b32 s20, s24, s20
    s_cselect_b32 s21, s25, s21
    s_cselect_b32 s22, s26, s22
    s_add_u32 m0, s45, 65536
    s_add_u32 s3, s59, 0
    buffer_load_dwordx4 v10, s[4:7], s3 offen lds
    s_add_u32 m0, s46, 65536
    s_add_u32 s3, s60, 0
    buffer_load_dwordx4 v12, s[20:23], s3 offen lds
    s_add_u32 m0, s45, 66560
    s_add_u32 s3, s59, 73728
    buffer_load_dwordx4 v11, s[4:7], s3 offen lds
    s_add_u32 m0, s46, 66560
    s_add_u32 s3, s60, 8192
    buffer_load_dwordx4 v12, s[20:23], s3 offen lds
    s_add_u32 m0, s45, 67584
    s_add_u32 s3, s59, 147456
    buffer_load_dwordx4 v10, s[4:7], s3 offen lds
    s_add_u32 m0, s46, 67584
    s_add_u32 s3, s60, 16384
    buffer_load_dwordx4 v12, s[20:23], s3 offen lds
    s_add_u32 m0, s45, 68608
    s_add_u32 s3, s59, 221184
    buffer_load_dwordx4 v11, s[4:7], s3 offen lds
    s_add_u32 m0, s46, 68608
    s_add_u32 s3, s60, 24576
    buffer_load_dwordx4 v12, s[20:23], s3 offen lds
    s_add_u32 s59, s59, 128
    s_add_u32 s60, s60, 131072
    s_add_u32 s99, s99, 1
    s_cmp_eq_u32 s99, 20
    s_cselect_b32 s59, s100, s59
    s_cselect_b32 s60, s101, s60
    s_add_u32 s62, s62, 1
    s_cmp_eq_u32 s62, 20
    s_cselect_b32 s60, s61, s60
    s_cselect_b32 s59, s57, s59
    s_cselect_b32 s20, s24, s20
    s_cselect_b32 s21, s25, s21
    s_cselect_b32 s22, s26, s22
    s_and_b32 s50, s2, 31
    s_lshr_b32 s51, s2, 5
    s_mov_b32 s40, s76
    s_and_b32 s41, s77, 0xffff
    s_mov_b32 s42, 0x400000
    s_mov_b32 s43, 0x00020000
    s_mov_b32 s52, s96
    s_and_b32 s53, s97, 0xffff
    s_mov_b32 s54, 0x800
    s_mov_b32 s55, 0x00020000
    v_and_b32 v3, 31, v2
    v_lshrrev_b32 v4, 1, v1
    v_lshlrev_b32 v4, 6, v4
    v_add_u32 v4, v4, v3
    v_lshlrev_b32 v4, 7, v4
    v_bfe_u32 v5, v3, 1, 3
    v_lshrrev_b32 v6, 5, v2
    v_add_u32 v7, 0, v6
    v_xor_b32 v7, v7, v5
    v_lshl_add_u32 v14, v7, 4, v4
    v_add_u32 v18, 65536, v14
    v_add_u32 v7, 2, v6
    v_xor_b32 v7, v7, v5
    v_lshl_add_u32 v15, v7, 4, v4
    v_add_u32 v19, 65536, v15
    v_add_u32 v7, 4, v6
    v_xor_b32 v7, v7, v5
    v_lshl_add_u32 v16, v7, 4, v4
    v_add_u32 v20, 65536, v16
    v_add_u32 v7, 6, v6
    v_xor_b32 v7, v7, v5
    v_lshl_add_u32 v17, v7, 4, v4
    v_add_u32 v21, 65536, v17
    v_lshrrev_b32 v3, 5, v2
    v_lshlrev_b32 v3, 11, v3
    v_bfe_u32 v4, v2, 2, 2
    v_lshl_add_u32 v3, v4, 8, v3
    v_bfe_u32 v5, v2, 4, 1
    v_lshl_add_u32 v3, v5, 5, v3
    v_and_b32 v5, 3, v2
    v_lshl_add_u32 v3, v5, 3, v3
    v_and_b32 v5, 1, v1
    v_lshlrev_b32 v5, 1, v5
    v_add_u32 v6, 0, v5
    v_xor_b32 v6, v6, v4
    v_lshl_add_u32 v6, v6, 6, v3
    v_add_u32 v22, 16384, v6
    v_add_u32 v28, 81920, v6
    v_add_u32 v6, 1, v5
    v_xor_b32 v6, v6, v4
    v_lshl_add_u32 v6, v6, 6, v3
    v_add_u32 v23, 16384, v6
    v_add_u32 v29, 81920, v6
    v_mov_b32 v64, 0
    v_mov_b32 v65, 0
    v_mov_b32 v66, 0
    v_mov_b32 v67, 0
    v_mov_b32 v68, 0
    v_mov_b32 v69, 0
    v_mov_b32 v70, 0
    v_mov_b32 v71, 0
    v_mov_b32 v72, 0
    v_mov_b32 v73, 0
    v_mov_b32 v74, 0
    v_mov_b32 v75, 0
    v_mov_b32 v76, 0
    v_mov_b32 v77, 0
    v_mov_b32 v78, 0
    v_mov_b32 v79, 0
    v_mov_b32 v80, 0
    v_mov_b32 v81, 0
    v_mov_b32 v82, 0
    v_mov_b32 v83, 0
    v_mov_b32 v84, 0
    v_mov_b32 v85, 0
    v_mov_b32 v86, 0
    v_mov_b32 v87, 0
    v_mov_b32 v88, 0
    v_mov_b32 v89, 0
    v_mov_b32 v90, 0
    v_mov_b32 v91, 0
    v_mov_b32 v92, 0
    v_mov_b32 v93, 0
    v_mov_b32 v94, 0
    v_mov_b32 v95, 0
    v_mov_b32 v96, 0
    v_mov_b32 v97, 0
    v_mov_b32 v98, 0
    v_mov_b32 v99, 0
    v_mov_b32 v100, 0
    v_mov_b32 v101, 0
    v_mov_b32 v102, 0
    v_mov_b32 v103, 0
    v_mov_b32 v104, 0
    v_mov_b32 v105, 0
    v_mov_b32 v106, 0
    v_mov_b32 v107, 0
    v_mov_b32 v108, 0
    v_mov_b32 v109, 0
    v_mov_b32 v110, 0
    v_mov_b32 v111, 0
    v_mov_b32 v112, 0
    v_mov_b32 v113, 0
    v_mov_b32 v114, 0
    v_mov_b32 v115, 0
    v_mov_b32 v116, 0
    v_mov_b32 v117, 0
    v_mov_b32 v118, 0
    v_mov_b32 v119, 0
    v_mov_b32 v120, 0
    v_mov_b32 v121, 0
    v_mov_b32 v122, 0
    v_mov_b32 v123, 0
    v_mov_b32 v124, 0
    v_mov_b32 v125, 0
    v_mov_b32 v126, 0
    v_mov_b32 v127, 0
    v_mov_b32 v128, 0
    v_mov_b32 v129, 0
    v_mov_b32 v130, 0
    v_mov_b32 v131, 0
    v_mov_b32 v132, 0
    v_mov_b32 v133, 0
    v_mov_b32 v134, 0
    v_mov_b32 v135, 0
    v_mov_b32 v136, 0
    v_mov_b32 v137, 0
    v_mov_b32 v138, 0
    v_mov_b32 v139, 0
    v_mov_b32 v140, 0
    v_mov_b32 v141, 0
    v_mov_b32 v142, 0
    v_mov_b32 v143, 0
    v_mov_b32 v144, 0
    v_mov_b32 v145, 0
    v_mov_b32 v146, 0
    v_mov_b32 v147, 0
    v_mov_b32 v148, 0
    v_mov_b32 v149, 0
    v_mov_b32 v150, 0
    v_mov_b32 v151, 0
    v_mov_b32 v152, 0
    v_mov_b32 v153, 0
    v_mov_b32 v154, 0
    v_mov_b32 v155, 0
    v_mov_b32 v156, 0
    v_mov_b32 v157, 0
    v_mov_b32 v158, 0
    v_mov_b32 v159, 0
    v_mov_b32 v160, 0
    v_mov_b32 v161, 0
    v_mov_b32 v162, 0
    v_mov_b32 v163, 0
    v_mov_b32 v164, 0
    v_mov_b32 v165, 0
    v_mov_b32 v166, 0
    v_mov_b32 v167, 0
    v_mov_b32 v168, 0
    v_mov_b32 v169, 0
    v_mov_b32 v170, 0
    v_mov_b32 v171, 0
    v_mov_b32 v172, 0
    v_mov_b32 v173, 0
    v_mov_b32 v174, 0
    v_mov_b32 v175, 0
    v_mov_b32 v176, 0
    v_mov_b32 v177, 0
    v_mov_b32 v178, 0
    v_mov_b32 v179, 0
    v_mov_b32 v180, 0
    v_mov_b32 v181, 0
    v_mov_b32 v182, 0
    v_mov_b32 v183, 0
    v_mov_b32 v184, 0
    v_mov_b32 v185, 0
    v_mov_b32 v186, 0
    v_mov_b32 v187, 0
    v_mov_b32 v188, 0
    v_mov_b32 v189, 0
    v_mov_b32 v190, 0
    v_mov_b32 v191, 0
    s_waitcnt vmcnt(16)
    s_barrier
    ds_read_b128 v[32:35], v14 offset:0
    ds_read_b128 v[36:39], v14 offset:4096
    ds_read_b64_tr_b16 v[48:49], v22 offset:0
    ds_read_b64_tr_b16 v[50:51], v22 offset:1024
    ds_read_b64_tr_b16 v[52:53], v23 offset:0
    ds_read_b64_tr_b16 v[54:55], v23 offset:1024
    s_lshr_b32 s44, s33, 1
    s_lshl_b32 s44, s44, 2
    s_waitcnt lgkmcnt(0)
    v_mfma_f32_32x32x16_bf16 v[128:143], v[48:51], v[32:35], v[128:143]
    ds_read_b128 v[40:43], v15 offset:0
    ds_read_b128 v[44:47], v15 offset:4096
    ds_read_b64_tr_b16 v[56:57], v22 offset:4096
    v_and_b32 v192, 31, v2
    v_lshlrev_b32 v4, 6, v1
    v_add_u32 v192, v192, v4
    v_lshrrev_b32 v193, 5, v2
    v_lshlrev_b32 v193, 4, v193
    v_mfma_f32_32x32x16_bf16 v[144:159], v[48:51], v[36:39], v[144:159]
    ds_read_b64_tr_b16 v[58:59], v22 offset:5120
    ds_read_b64_tr_b16 v[60:61], v23 offset:4096
    ds_read_b64_tr_b16 v[62:63], v23 offset:5120
    v_lshlrev_b32 v6, 11, v192
    v_add_u32 v6, v6, v193
    s_lshl_b32 s38, s51, 19
    s_lshl_b32 s37, s50, 6
    s_add_u32 s38, s38, s37
    v_mfma_f32_32x32x16_bf16 v[160:175], v[52:55], v[32:35], v[160:175]
    s_add_u32 m0, s45, 98304
    s_add_u32 s3, s59, 0
    buffer_load_dwordx4 v10, s[4:7], s3 offen lds
    s_add_u32 s38, s38, 0
    s_add_u32 s39, s38, 65536
    buffer_load_dwordx4 a[0:3], v6, s[28:31], s38 offen
    buffer_load_dwordx4 a[4:7], v6, s[28:31], s38 offen offset:32
    buffer_load_dwordx4 a[8:11], v6, s[28:31], s39 offen
    v_mfma_f32_32x32x16_bf16 v[176:191], v[52:55], v[36:39], v[176:191]
    s_add_u32 m0, s46, 98304
    s_add_u32 s3, s60, 0
    buffer_load_dwordx4 v12, s[20:23], s3 offen lds
    buffer_load_dwordx4 a[12:15], v6, s[28:31], s39 offen offset:32
    v_lshlrev_b32 v7, 4, v0
    s_lshl_b32 s39, s50, 16
    s_add_u32 s39, s39, 25165824
    s_add_u32 s27, s39, 0
    s_waitcnt lgkmcnt(0)
    v_mfma_f32_32x32x16_bf16 v[128:143], v[56:59], v[40:43], v[128:143]
    ds_read_b128 v[32:35], v16 offset:0
    ds_read_b128 v[36:39], v16 offset:4096
    ds_read_b64_tr_b16 v[48:49], v22 offset:8192
    buffer_load_dwordx4 a[16:19], v7, s[28:31], s27 offen
    s_add_u32 s27, s39, 4096
    buffer_load_dwordx4 a[20:23], v7, s[28:31], s27 offen
    s_add_u32 s27, s39, 8192
    buffer_load_dwordx4 a[24:27], v7, s[28:31], s27 offen
    v_mfma_f32_32x32x16_bf16 v[144:159], v[56:59], v[44:47], v[144:159]
    ds_read_b64_tr_b16 v[50:51], v22 offset:9216
    ds_read_b64_tr_b16 v[52:53], v23 offset:8192
    ds_read_b64_tr_b16 v[54:55], v23 offset:9216
    s_add_u32 s27, s39, 12288
    buffer_load_dwordx4 a[28:31], v7, s[28:31], s27 offen
    s_add_u32 s27, s39, 16384
    buffer_load_dwordx4 a[32:35], v7, s[28:31], s27 offen
    s_add_u32 s27, s39, 20480
    v_mfma_f32_32x32x16_bf16 v[160:175], v[60:63], v[40:43], v[160:175]
    s_add_u32 m0, s45, 99328
    s_add_u32 s3, s59, 73728
    buffer_load_dwordx4 v11, s[4:7], s3 offen lds
    buffer_load_dwordx4 a[36:39], v7, s[28:31], s27 offen
    s_add_u32 s27, s39, 24576
    buffer_load_dwordx4 a[40:43], v7, s[28:31], s27 offen
    s_add_u32 s27, s39, 28672
    buffer_load_dwordx4 a[44:47], v7, s[28:31], s27 offen
    v_mfma_f32_32x32x16_bf16 v[176:191], v[60:63], v[44:47], v[176:191]
    s_add_u32 m0, s46, 99328
    s_add_u32 s3, s60, 8192
    buffer_load_dwordx4 v12, s[20:23], s3 offen lds
    s_add_u32 s27, s39, 32768
    buffer_load_dwordx4 a[48:51], v7, s[28:31], s27 offen
    s_add_u32 s27, s39, 36864
    buffer_load_dwordx4 a[52:55], v7, s[28:31], s27 offen
    s_add_u32 s27, s39, 40960
    s_waitcnt lgkmcnt(0)
    v_mfma_f32_32x32x16_bf16 v[128:143], v[48:51], v[32:35], v[128:143]
    ds_read_b128 v[40:43], v17 offset:0
    ds_read_b128 v[44:47], v17 offset:4096
    ds_read_b64_tr_b16 v[56:57], v22 offset:12288
    buffer_load_dwordx4 a[56:59], v7, s[28:31], s27 offen
    s_add_u32 s27, s39, 45056
    buffer_load_dwordx4 a[60:63], v7, s[28:31], s27 offen
    s_add_u32 s27, s39, 49152
    buffer_load_dwordx4 a[64:67], v7, s[28:31], s27 offen
    v_mfma_f32_32x32x16_bf16 v[144:159], v[48:51], v[36:39], v[144:159]
    ds_read_b64_tr_b16 v[58:59], v22 offset:13312
    ds_read_b64_tr_b16 v[60:61], v23 offset:12288
    ds_read_b64_tr_b16 v[62:63], v23 offset:13312
    s_add_u32 s27, s39, 53248
    buffer_load_dwordx4 a[68:71], v7, s[28:31], s27 offen
    s_add_u32 s27, s39, 57344
    buffer_load_dwordx4 a[72:75], v7, s[28:31], s27 offen
    s_add_u32 s27, s39, 61440
    v_mfma_f32_32x32x16_bf16 v[160:175], v[52:55], v[32:35], v[160:175]
    s_add_u32 m0, s45, 100352
    s_add_u32 s3, s59, 147456
    buffer_load_dwordx4 v10, s[4:7], s3 offen lds
    buffer_load_dwordx4 a[76:79], v7, s[28:31], s27 offen
    v_lshlrev_b32 v8, 5, v2
    s_lshl_b32 s48, s51, 8
    s_lshl_b32 s27, s50, 3
    s_add_u32 s48, s48, s27
    v_mfma_f32_32x32x16_bf16 v[176:191], v[52:55], v[36:39], v[176:191]
    s_add_u32 m0, s46, 100352
    s_add_u32 s3, s60, 16384
    buffer_load_dwordx4 v12, s[20:23], s3 offen lds
    s_lshl_b32 s27, s35, 1
    s_add_u32 s48, s48, s27
    s_lshl_b32 s47, s48, 11
    s_add_u32 s49, s47, 2048
    buffer_load_dwordx4 a[80:83], v8, s[40:43], s47 offen
    s_waitcnt vmcnt(35) lgkmcnt(0)
    s_barrier
    s_waitcnt lgkmcnt(0)
    v_mfma_f32_32x32x16_bf16 v[128:143], v[56:59], v[40:43], v[128:143]
    ds_read_b128 v[32:35], v14 offset:32768
    ds_read_b128 v[36:39], v14 offset:36864
    ds_read_b64_tr_b16 v[48:49], v22 offset:32768
    buffer_load_dwordx4 a[84:87], v8, s[40:43], s47 offen offset:16
    buffer_load_dwordx4 a[88:91], v8, s[40:43], s49 offen
    buffer_load_dwordx4 a[92:95], v8, s[40:43], s49 offen offset:16
    buffer_load_dwordx4 a[96:99], v8, s[52:55], 0 offen
    buffer_load_dwordx4 a[100:103], v8, s[52:55], 0 offen offset:16
    v_mfma_f32_32x32x16_bf16 v[144:159], v[56:59], v[44:47], v[144:159]
    ds_read_b64_tr_b16 v[50:51], v22 offset:33792
    ds_read_b64_tr_b16 v[52:53], v23 offset:32768
    ds_read_b64_tr_b16 v[54:55], v23 offset:33792
    v_mfma_f32_32x32x16_bf16 v[160:175], v[60:63], v[40:43], v[160:175]
    s_add_u32 m0, s45, 101376
    s_add_u32 s3, s59, 221184
    buffer_load_dwordx4 v11, s[4:7], s3 offen lds
    v_mfma_f32_32x32x16_bf16 v[176:191], v[60:63], v[44:47], v[176:191]
    s_add_u32 m0, s46, 101376
    s_add_u32 s3, s60, 24576
    buffer_load_dwordx4 v12, s[20:23], s3 offen lds
    s_add_u32 s59, s59, 128
    s_add_u32 s60, s60, 131072
    s_add_u32 s99, s99, 1
    s_cmp_eq_u32 s99, 20
    s_cselect_b32 s59, s100, s59
    s_cselect_b32 s60, s101, s60
    s_add_u32 s62, s62, 1
    s_cmp_eq_u32 s62, 20
    s_cselect_b32 s60, s61, s60
    s_cselect_b32 s59, s57, s59
    s_cselect_b32 s20, s24, s20
    s_cselect_b32 s21, s25, s21
    s_cselect_b32 s22, s26, s22
    s_waitcnt lgkmcnt(0)
    v_mfma_f32_32x32x16_bf16 v[128:143], v[48:51], v[32:35], v[128:143]
    ds_read_b128 v[40:43], v15 offset:32768
    ds_read_b128 v[44:47], v15 offset:36864
    ds_read_b64_tr_b16 v[56:57], v22 offset:36864
    v_mfma_f32_32x32x16_bf16 v[144:159], v[48:51], v[36:39], v[144:159]
    ds_read_b64_tr_b16 v[58:59], v22 offset:37888
    ds_read_b64_tr_b16 v[60:61], v23 offset:36864
    ds_read_b64_tr_b16 v[62:63], v23 offset:37888
    v_mfma_f32_32x32x16_bf16 v[160:175], v[52:55], v[32:35], v[160:175]
    s_add_u32 m0, s45, 0
    s_add_u32 s3, s59, 0
    buffer_load_dwordx4 v10, s[4:7], s3 offen lds
    v_mfma_f32_32x32x16_bf16 v[176:191], v[52:55], v[36:39], v[176:191]
    s_add_u32 m0, s46, 0
    s_add_u32 s3, s60, 0
    buffer_load_dwordx4 v12, s[20:23], s3 offen lds
    s_waitcnt lgkmcnt(0)
    v_mfma_f32_32x32x16_bf16 v[128:143], v[56:59], v[40:43], v[128:143]
    ds_read_b128 v[32:35], v16 offset:32768
    ds_read_b128 v[36:39], v16 offset:36864
    ds_read_b64_tr_b16 v[48:49], v22 offset:40960
    v_mfma_f32_32x32x16_bf16 v[144:159], v[56:59], v[44:47], v[144:159]
    ds_read_b64_tr_b16 v[50:51], v22 offset:41984
    ds_read_b64_tr_b16 v[52:53], v23 offset:40960
    ds_read_b64_tr_b16 v[54:55], v23 offset:41984
    v_mfma_f32_32x32x16_bf16 v[160:175], v[60:63], v[40:43], v[160:175]
    s_add_u32 m0, s45, 1024
    s_add_u32 s3, s59, 73728
    buffer_load_dwordx4 v11, s[4:7], s3 offen lds
    v_mfma_f32_32x32x16_bf16 v[176:191], v[60:63], v[44:47], v[176:191]
    s_add_u32 m0, s46, 1024
    s_add_u32 s3, s60, 8192
    buffer_load_dwordx4 v12, s[20:23], s3 offen lds
    s_waitcnt lgkmcnt(0)
    v_mfma_f32_32x32x16_bf16 v[128:143], v[48:51], v[32:35], v[128:143]
    ds_read_b128 v[40:43], v17 offset:32768
    ds_read_b128 v[44:47], v17 offset:36864
    ds_read_b64_tr_b16 v[56:57], v22 offset:45056
    v_mfma_f32_32x32x16_bf16 v[144:159], v[48:51], v[36:39], v[144:159]
    ds_read_b64_tr_b16 v[58:59], v22 offset:46080
    ds_read_b64_tr_b16 v[60:61], v23 offset:45056
    ds_read_b64_tr_b16 v[62:63], v23 offset:46080
    v_mfma_f32_32x32x16_bf16 v[160:175], v[52:55], v[32:35], v[160:175]
    s_add_u32 m0, s45, 2048
    s_add_u32 s3, s59, 147456
    buffer_load_dwordx4 v10, s[4:7], s3 offen lds
    v_mfma_f32_32x32x16_bf16 v[176:191], v[52:55], v[36:39], v[176:191]
    s_add_u32 m0, s46, 2048
    s_add_u32 s3, s60, 16384
    buffer_load_dwordx4 v12, s[20:23], s3 offen lds
    s_waitcnt vmcnt(40) lgkmcnt(0)
    s_barrier
    s_waitcnt lgkmcnt(0)
    v_mfma_f32_32x32x16_bf16 v[128:143], v[56:59], v[40:43], v[128:143]
    ds_read_b128 v[32:35], v18 offset:0
    ds_read_b128 v[36:39], v18 offset:4096
    ds_read_b64_tr_b16 v[48:49], v28 offset:0
    v_mfma_f32_32x32x16_bf16 v[144:159], v[56:59], v[44:47], v[144:159]
    ds_read_b64_tr_b16 v[50:51], v28 offset:1024
    ds_read_b64_tr_b16 v[52:53], v29 offset:0
    ds_read_b64_tr_b16 v[54:55], v29 offset:1024
    v_mfma_f32_32x32x16_bf16 v[160:175], v[60:63], v[40:43], v[160:175]
    s_add_u32 m0, s45, 3072
    s_add_u32 s3, s59, 221184
    buffer_load_dwordx4 v11, s[4:7], s3 offen lds
    v_mfma_f32_32x32x16_bf16 v[176:191], v[60:63], v[44:47], v[176:191]
    s_add_u32 m0, s46, 3072
    s_add_u32 s3, s60, 24576
    buffer_load_dwordx4 v12, s[20:23], s3 offen lds
    s_add_u32 s59, s59, 128
    s_add_u32 s60, s60, 131072
    s_add_u32 s99, s99, 1
    s_cmp_eq_u32 s99, 20
    s_cselect_b32 s59, s100, s59
    s_cselect_b32 s60, s101, s60
    s_add_u32 s62, s62, 1
    s_cmp_eq_u32 s62, 20
    s_cselect_b32 s60, s61, s60
    s_cselect_b32 s59, s57, s59
    s_cselect_b32 s20, s24, s20
    s_cselect_b32 s21, s25, s21
    s_cselect_b32 s22, s26, s22
    s_waitcnt lgkmcnt(0)
    v_mfma_f32_32x32x16_bf16 v[128:143], v[48:51], v[32:35], v[128:143]
    ds_read_b128 v[40:43], v19 offset:0
    ds_read_b128 v[44:47], v19 offset:4096
    ds_read_b64_tr_b16 v[56:57], v28 offset:4096
    v_mfma_f32_32x32x16_bf16 v[144:159], v[48:51], v[36:39], v[144:159]
    ds_read_b64_tr_b16 v[58:59], v28 offset:5120
    ds_read_b64_tr_b16 v[60:61], v29 offset:4096
    ds_read_b64_tr_b16 v[62:63], v29 offset:5120
    v_mfma_f32_32x32x16_bf16 v[160:175], v[52:55], v[32:35], v[160:175]
    s_add_u32 m0, s45, 32768
    s_add_u32 s3, s59, 0
    buffer_load_dwordx4 v10, s[4:7], s3 offen lds
    v_mfma_f32_32x32x16_bf16 v[176:191], v[52:55], v[36:39], v[176:191]
    s_add_u32 m0, s46, 32768
    s_add_u32 s3, s60, 0
    buffer_load_dwordx4 v12, s[20:23], s3 offen lds
    s_waitcnt lgkmcnt(0)
    v_mfma_f32_32x32x16_bf16 v[128:143], v[56:59], v[40:43], v[128:143]
    ds_read_b128 v[32:35], v20 offset:0
    ds_read_b128 v[36:39], v20 offset:4096
    ds_read_b64_tr_b16 v[48:49], v28 offset:8192
    v_mfma_f32_32x32x16_bf16 v[144:159], v[56:59], v[44:47], v[144:159]
    ds_read_b64_tr_b16 v[50:51], v28 offset:9216
    ds_read_b64_tr_b16 v[52:53], v29 offset:8192
    ds_read_b64_tr_b16 v[54:55], v29 offset:9216
    v_mfma_f32_32x32x16_bf16 v[160:175], v[60:63], v[40:43], v[160:175]
    s_add_u32 m0, s45, 33792
    s_add_u32 s3, s59, 73728
    buffer_load_dwordx4 v11, s[4:7], s3 offen lds
    v_mfma_f32_32x32x16_bf16 v[176:191], v[60:63], v[44:47], v[176:191]
    s_add_u32 m0, s46, 33792
    s_add_u32 s3, s60, 8192
    buffer_load_dwordx4 v12, s[20:23], s3 offen lds
    s_waitcnt lgkmcnt(0)
    v_mfma_f32_32x32x16_bf16 v[128:143], v[48:51], v[32:35], v[128:143]
    ds_read_b128 v[40:43], v21 offset:0
    ds_read_b128 v[44:47], v21 offset:4096
    ds_read_b64_tr_b16 v[56:57], v28 offset:12288
    v_mfma_f32_32x32x16_bf16 v[144:159], v[48:51], v[36:39], v[144:159]
    ds_read_b64_tr_b16 v[58:59], v28 offset:13312
    ds_read_b64_tr_b16 v[60:61], v29 offset:12288
    ds_read_b64_tr_b16 v[62:63], v29 offset:13312
    v_mfma_f32_32x32x16_bf16 v[160:175], v[52:55], v[32:35], v[160:175]
    s_add_u32 m0, s45, 34816
    s_add_u32 s3, s59, 147456
    buffer_load_dwordx4 v10, s[4:7], s3 offen lds
    v_mfma_f32_32x32x16_bf16 v[176:191], v[52:55], v[36:39], v[176:191]
    s_add_u32 m0, s46, 34816
    s_add_u32 s3, s60, 16384
    buffer_load_dwordx4 v12, s[20:23], s3 offen lds
    s_waitcnt vmcnt(14) lgkmcnt(0)
    s_barrier
    s_waitcnt lgkmcnt(0)
    v_mfma_f32_32x32x16_bf16 v[128:143], v[56:59], v[40:43], v[128:143]
    ds_read_b128 v[32:35], v18 offset:32768
    ds_read_b128 v[36:39], v18 offset:36864
    ds_read_b64_tr_b16 v[48:49], v28 offset:32768
    v_mfma_f32_32x32x16_bf16 v[144:159], v[56:59], v[44:47], v[144:159]
    ds_read_b64_tr_b16 v[50:51], v28 offset:33792
    ds_read_b64_tr_b16 v[52:53], v29 offset:32768
    ds_read_b64_tr_b16 v[54:55], v29 offset:33792
    v_mfma_f32_32x32x16_bf16 v[160:175], v[60:63], v[40:43], v[160:175]
    s_add_u32 m0, s45, 35840
    s_add_u32 s3, s59, 221184
    buffer_load_dwordx4 v11, s[4:7], s3 offen lds
    v_mfma_f32_32x32x16_bf16 v[176:191], v[60:63], v[44:47], v[176:191]
    s_add_u32 m0, s46, 35840
    s_add_u32 s3, s60, 24576
    buffer_load_dwordx4 v12, s[20:23], s3 offen lds
    s_add_u32 s59, s59, 128
    s_add_u32 s60, s60, 131072
    s_add_u32 s99, s99, 1
    s_cmp_eq_u32 s99, 20
    s_cselect_b32 s59, s100, s59
    s_cselect_b32 s60, s101, s60
    s_add_u32 s62, s62, 1
    s_cmp_eq_u32 s62, 20
    s_cselect_b32 s60, s61, s60
    s_cselect_b32 s59, s57, s59
    s_cselect_b32 s20, s24, s20
    s_cselect_b32 s21, s25, s21
    s_cselect_b32 s22, s26, s22
    s_waitcnt lgkmcnt(0)
    v_mfma_f32_32x32x16_bf16 v[128:143], v[48:51], v[32:35], v[128:143]
    ds_read_b128 v[40:43], v19 offset:32768
    ds_read_b128 v[44:47], v19 offset:36864
    ds_read_b64_tr_b16 v[56:57], v28 offset:36864
    v_accvgpr_read_b32 v217, a0
    v_accvgpr_read_b32 v219, a1
    v_accvgpr_read_b32 v221, a2
    v_accvgpr_read_b32 v223, a3
    v_accvgpr_read_b32 v225, a4
    v_accvgpr_read_b32 v227, a5
    v_accvgpr_read_b32 v229, a6
    v_accvgpr_read_b32 v231, a7
    v_lshlrev_b32 v216, 16, v217
    v_and_b32 v217, 0xffff0000, v217
    v_lshlrev_b32 v218, 16, v219
    v_and_b32 v219, 0xffff0000, v219
    v_lshlrev_b32 v220, 16, v221
    v_and_b32 v221, 0xffff0000, v221
    v_mfma_f32_32x32x16_bf16 v[144:159], v[48:51], v[36:39], v[144:159]
    ds_read_b64_tr_b16 v[58:59], v28 offset:37888
    ds_read_b64_tr_b16 v[60:61], v29 offset:36864
    ds_read_b64_tr_b16 v[62:63], v29 offset:37888
    v_lshlrev_b32 v222, 16, v223
    v_and_b32 v223, 0xffff0000, v223
    v_lshlrev_b32 v224, 16, v225
    v_and_b32 v225, 0xffff0000, v225
    v_lshlrev_b32 v226, 16, v227
    v_and_b32 v227, 0xffff0000, v227
    v_lshlrev_b32 v228, 16, v229
    v_and_b32 v229, 0xffff0000, v229
    v_lshlrev_b32 v230, 16, v231
    v_and_b32 v231, 0xffff0000, v231
    v_mul_f32 v232, 0x3fb8aa3b, v216
    v_mul_f32 v233, 0x3fb8aa3b, v217
    v_mul_f32 v234, 0x3fb8aa3b, v218
    v_mul_f32 v235, 0x3fb8aa3b, v219
    v_mfma_f32_32x32x16_bf16 v[160:175], v[52:55], v[32:35], v[160:175]
    s_add_u32 m0, s45, 65536
    s_add_u32 s3, s59, 0
    buffer_load_dwordx4 v10, s[4:7], s3 offen lds
    v_mul_f32 v236, 0x3fb8aa3b, v220
    v_mul_f32 v237, 0x3fb8aa3b, v221
    v_mul_f32 v238, 0x3fb8aa3b, v222
    v_mul_f32 v239, 0x3fb8aa3b, v223
    v_mul_f32 v240, 0x3fb8aa3b, v224
    v_mul_f32 v241, 0x3fb8aa3b, v225
    v_mul_f32 v242, 0x3fb8aa3b, v226
    v_mul_f32 v243, 0x3fb8aa3b, v227
    v_mul_f32 v244, 0x3fb8aa3b, v228
    v_mul_f32 v245, 0x3fb8aa3b, v229
    v_mul_f32 v246, 0x3fb8aa3b, v230
    v_mul_f32 v247, 0x3fb8aa3b, v231
    v_min_f32 v232, 0, v232
    v_min_f32 v233, 0, v233
    v_mfma_f32_32x32x16_bf16 v[176:191], v[52:55], v[36:39], v[176:191]
    s_add_u32 m0, s46, 65536
    s_add_u32 s3, s60, 0
    buffer_load_dwordx4 v12, s[20:23], s3 offen lds
    v_min_f32 v234, 0, v234
    v_min_f32 v235, 0, v235
    v_min_f32 v236, 0, v236
    v_min_f32 v237, 0, v237
    v_min_f32 v238, 0, v238
    v_min_f32 v239, 0, v239
    v_min_f32 v240, 0, v240
    v_min_f32 v241, 0, v241
    v_min_f32 v242, 0, v242
    v_min_f32 v243, 0, v243
    v_min_f32 v244, 0, v244
    v_min_f32 v245, 0, v245
    v_min_f32 v246, 0, v246
    v_min_f32 v247, 0, v247
    s_waitcnt lgkmcnt(0)
    v_mfma_f32_32x32x16_bf16 v[128:143], v[56:59], v[40:43], v[128:143]
    ds_read_b128 v[32:35], v20 offset:32768
    ds_read_b128 v[36:39], v20 offset:36864
    ds_read_b64_tr_b16 v[48:49], v28 offset:40960
    v_exp_f32 v232, v232
    v_exp_f32 v233, v233
    v_exp_f32 v234, v234
    v_exp_f32 v235, v235
    v_exp_f32 v236, v236
    v_exp_f32 v237, v237
    v_exp_f32 v238, v238
    v_exp_f32 v239, v239
    v_exp_f32 v240, v240
    v_exp_f32 v241, v241
    v_exp_f32 v242, v242
    v_exp_f32 v243, v243
    v_exp_f32 v244, v244
    v_exp_f32 v245, v245
    v_mfma_f32_32x32x16_bf16 v[144:159], v[56:59], v[44:47], v[144:159]
    ds_read_b64_tr_b16 v[50:51], v28 offset:41984
    ds_read_b64_tr_b16 v[52:53], v29 offset:40960
    ds_read_b64_tr_b16 v[54:55], v29 offset:41984
    v_exp_f32 v246, v246
    v_exp_f32 v247, v247
    v_max_f32 v216, 0, v216
    v_max_f32 v217, 0, v217
    v_max_f32 v218, 0, v218
    v_max_f32 v219, 0, v219
    v_max_f32 v220, 0, v220
    v_max_f32 v221, 0, v221
    v_max_f32 v222, 0, v222
    v_max_f32 v223, 0, v223
    v_max_f32 v224, 0, v224
    v_max_f32 v225, 0, v225
    v_max_f32 v226, 0, v226
    v_max_f32 v227, 0, v227
    v_mfma_f32_32x32x16_bf16 v[160:175], v[60:63], v[40:43], v[160:175]
    s_add_u32 m0, s45, 66560
    s_add_u32 s3, s59, 73728
    buffer_load_dwordx4 v11, s[4:7], s3 offen lds
    v_max_f32 v228, 0, v228
    v_max_f32 v229, 0, v229
    v_max_f32 v230, 0, v230
    v_max_f32 v231, 0, v231
    v_add_f32 v216, 0x358637bd, v216
    v_add_f32 v217, 0x358637bd, v217
    v_add_f32 v218, 0x358637bd, v218
    v_add_f32 v219, 0x358637bd, v219
    v_add_f32 v220, 0x358637bd, v220
    v_add_f32 v221, 0x358637bd, v221
    v_add_f32 v222, 0x358637bd, v222
    v_add_f32 v223, 0x358637bd, v223
    v_add_f32 v224, 0x358637bd, v224
    v_add_f32 v225, 0x358637bd, v225
    v_mfma_f32_32x32x16_bf16 v[176:191], v[60:63], v[44:47], v[176:191]
    s_add_u32 m0, s46, 66560
    s_add_u32 s3, s60, 8192
    buffer_load_dwordx4 v12, s[20:23], s3 offen lds
    v_add_f32 v226, 0x358637bd, v226
    v_add_f32 v227, 0x358637bd, v227
    v_add_f32 v228, 0x358637bd, v228
    v_add_f32 v229, 0x358637bd, v229
    v_add_f32 v230, 0x358637bd, v230
    v_add_f32 v231, 0x358637bd, v231
    v_add_f32 v216, v216, v232
    v_add_f32 v217, v217, v233
    v_add_f32 v218, v218, v234
    v_add_f32 v219, v219, v235
    v_add_f32 v220, v220, v236
    v_add_f32 v221, v221, v237
    v_add_f32 v222, v222, v238
    v_add_f32 v223, v223, v239
    s_waitcnt lgkmcnt(0)
    v_mfma_f32_32x32x16_bf16 v[128:143], v[48:51], v[32:35], v[128:143]
    ds_read_b128 v[40:43], v21 offset:32768
    ds_read_b128 v[44:47], v21 offset:36864
    ds_read_b64_tr_b16 v[56:57], v28 offset:45056
    v_add_f32 v224, v224, v240
    v_add_f32 v225, v225, v241
    v_add_f32 v226, v226, v242
    v_add_f32 v227, v227, v243
    v_add_f32 v228, v228, v244
    v_add_f32 v229, v229, v245
    v_add_f32 v230, v230, v246
    v_add_f32 v231, v231, v247
    v_cvt_pk_bf16_f32 v200, v216, v217
    v_cvt_pk_bf16_f32 v201, v218, v219
    v_cvt_pk_bf16_f32 v202, v220, v221
    v_cvt_pk_bf16_f32 v203, v222, v223
    v_cvt_pk_bf16_f32 v204, v224, v225
    v_cvt_pk_bf16_f32 v205, v226, v227
    v_mfma_f32_32x32x16_bf16 v[144:159], v[48:51], v[36:39], v[144:159]
    ds_read_b64_tr_b16 v[58:59], v28 offset:46080
    ds_read_b64_tr_b16 v[60:61], v29 offset:45056
    ds_read_b64_tr_b16 v[62:63], v29 offset:46080
    v_cvt_pk_bf16_f32 v206, v228, v229
    v_cvt_pk_bf16_f32 v207, v230, v231
    v_accvgpr_read_b32 v217, a8
    v_accvgpr_read_b32 v219, a9
    v_accvgpr_read_b32 v221, a10
    v_accvgpr_read_b32 v223, a11
    v_accvgpr_read_b32 v225, a12
    v_accvgpr_read_b32 v227, a13
    v_accvgpr_read_b32 v229, a14
    v_accvgpr_read_b32 v231, a15
    v_lshlrev_b32 v216, 16, v217
    v_and_b32 v217, 0xffff0000, v217
    v_lshlrev_b32 v218, 16, v219
    v_and_b32 v219, 0xffff0000, v219
    v_mfma_f32_32x32x16_bf16 v[160:175], v[52:55], v[32:35], v[160:175]
    s_add_u32 m0, s45, 67584
    s_add_u32 s3, s59, 147456
    buffer_load_dwordx4 v10, s[4:7], s3 offen lds
    v_lshlrev_b32 v220, 16, v221
    v_and_b32 v221, 0xffff0000, v221
    v_lshlrev_b32 v222, 16, v223
    v_and_b32 v223, 0xffff0000, v223
    v_lshlrev_b32 v224, 16, v225
    v_and_b32 v225, 0xffff0000, v225
    v_lshlrev_b32 v226, 16, v227
    v_and_b32 v227, 0xffff0000, v227
    v_lshlrev_b32 v228, 16, v229
    v_and_b32 v229, 0xffff0000, v229
    v_lshlrev_b32 v230, 16, v231
    v_and_b32 v231, 0xffff0000, v231
    v_mul_f32 v232, 0x3fb8aa3b, v216
    v_mul_f32 v233, 0x3fb8aa3b, v217
    v_mfma_f32_32x32x16_bf16 v[176:191], v[52:55], v[36:39], v[176:191]
    s_add_u32 m0, s46, 67584
    s_add_u32 s3, s60, 16384
    buffer_load_dwordx4 v12, s[20:23], s3 offen lds
    v_mul_f32 v234, 0x3fb8aa3b, v218
    v_mul_f32 v235, 0x3fb8aa3b, v219
    v_mul_f32 v236, 0x3fb8aa3b, v220
    v_mul_f32 v237, 0x3fb8aa3b, v221
    v_mul_f32 v238, 0x3fb8aa3b, v222
    v_mul_f32 v239, 0x3fb8aa3b, v223
    v_mul_f32 v240, 0x3fb8aa3b, v224
    v_mul_f32 v241, 0x3fb8aa3b, v225
    v_mul_f32 v242, 0x3fb8aa3b, v226
    v_mul_f32 v243, 0x3fb8aa3b, v227
    v_mul_f32 v244, 0x3fb8aa3b, v228
    v_mul_f32 v245, 0x3fb8aa3b, v229
    v_mul_f32 v246, 0x3fb8aa3b, v230
    v_mul_f32 v247, 0x3fb8aa3b, v231
    s_waitcnt vmcnt(14) lgkmcnt(0)
    s_barrier
    s_waitcnt lgkmcnt(0)
    v_mfma_f32_32x32x16_bf16 v[128:143], v[56:59], v[40:43], v[128:143]
    ds_read_b128 v[32:35], v14 offset:0
    ds_read_b128 v[36:39], v14 offset:4096
    ds_read_b64_tr_b16 v[48:49], v22 offset:0
    v_min_f32 v232, 0, v232
    v_min_f32 v233, 0, v233
    v_min_f32 v234, 0, v234
    v_min_f32 v235, 0, v235
    v_min_f32 v236, 0, v236
    v_min_f32 v237, 0, v237
    v_min_f32 v238, 0, v238
    v_min_f32 v239, 0, v239
    v_min_f32 v240, 0, v240
    v_min_f32 v241, 0, v241
    v_min_f32 v242, 0, v242
    v_min_f32 v243, 0, v243
    v_min_f32 v244, 0, v244
    v_min_f32 v245, 0, v245
    v_mfma_f32_32x32x16_bf16 v[144:159], v[56:59], v[44:47], v[144:159]
    ds_read_b64_tr_b16 v[50:51], v22 offset:1024
    ds_read_b64_tr_b16 v[52:53], v23 offset:0
    ds_read_b64_tr_b16 v[54:55], v23 offset:1024
    v_min_f32 v246, 0, v246
    v_min_f32 v247, 0, v247
    v_exp_f32 v232, v232
    v_exp_f32 v233, v233
    v_exp_f32 v234, v234
    v_exp_f32 v235, v235
    v_exp_f32 v236, v236
    v_exp_f32 v237, v237
    v_exp_f32 v238, v238
    v_exp_f32 v239, v239
    v_exp_f32 v240, v240
    v_exp_f32 v241, v241
    v_exp_f32 v242, v242
    v_exp_f32 v243, v243
    v_mfma_f32_32x32x16_bf16 v[160:175], v[60:63], v[40:43], v[160:175]
    s_add_u32 m0, s45, 68608
    s_add_u32 s3, s59, 221184
    buffer_load_dwordx4 v11, s[4:7], s3 offen lds
    v_exp_f32 v244, v244
    v_exp_f32 v245, v245
    v_exp_f32 v246, v246
    v_exp_f32 v247, v247
    v_max_f32 v216, 0, v216
    v_max_f32 v217, 0, v217
    v_max_f32 v218, 0, v218
    v_max_f32 v219, 0, v219
    v_max_f32 v220, 0, v220
    v_max_f32 v221, 0, v221
    v_max_f32 v222, 0, v222
    v_max_f32 v223, 0, v223
    v_max_f32 v224, 0, v224
    v_max_f32 v225, 0, v225
    v_mfma_f32_32x32x16_bf16 v[176:191], v[60:63], v[44:47], v[176:191]
    s_add_u32 m0, s46, 68608
    s_add_u32 s3, s60, 24576
    buffer_load_dwordx4 v12, s[20:23], s3 offen lds
    s_add_u32 s59, s59, 128
    s_add_u32 s60, s60, 131072
    s_add_u32 s99, s99, 1
    s_cmp_eq_u32 s99, 20
    s_cselect_b32 s59, s100, s59
    s_cselect_b32 s60, s101, s60
    s_add_u32 s62, s62, 1
    s_cmp_eq_u32 s62, 20
    s_cselect_b32 s60, s61, s60
    s_cselect_b32 s59, s57, s59
    s_cselect_b32 s20, s24, s20
    s_cselect_b32 s21, s25, s21
    s_cselect_b32 s22, s26, s22
    v_max_f32 v226, 0, v226
    v_max_f32 v227, 0, v227
    v_max_f32 v228, 0, v228
    v_max_f32 v229, 0, v229
    v_max_f32 v230, 0, v230
    v_max_f32 v231, 0, v231
    v_add_f32 v216, 0x358637bd, v216
    s_waitcnt lgkmcnt(0)
    v_mfma_f32_32x32x16_bf16 v[128:143], v[48:51], v[32:35], v[128:143]
    ds_read_b128 v[40:43], v15 offset:0
    ds_read_b128 v[44:47], v15 offset:4096
    ds_read_b64_tr_b16 v[56:57], v22 offset:4096
    v_add_f32 v217, 0x358637bd, v217
    v_add_f32 v218, 0x358637bd, v218
    v_add_f32 v219, 0x358637bd, v219
    v_add_f32 v220, 0x358637bd, v220
    v_add_f32 v221, 0x358637bd, v221
    v_add_f32 v222, 0x358637bd, v222
    v_add_f32 v223, 0x358637bd, v223
    v_add_f32 v224, 0x358637bd, v224
    v_add_f32 v225, 0x358637bd, v225
    v_add_f32 v226, 0x358637bd, v226
    v_add_f32 v227, 0x358637bd, v227
    v_add_f32 v228, 0x358637bd, v228
    v_add_f32 v229, 0x358637bd, v229
    v_add_f32 v230, 0x358637bd, v230
    v_mfma_f32_32x32x16_bf16 v[144:159], v[48:51], v[36:39], v[144:159]
    ds_read_b64_tr_b16 v[58:59], v22 offset:5120
    ds_read_b64_tr_b16 v[60:61], v23 offset:4096
    ds_read_b64_tr_b16 v[62:63], v23 offset:5120
    v_add_f32 v231, 0x358637bd, v231
    v_add_f32 v216, v216, v232
    v_add_f32 v217, v217, v233
    v_add_f32 v218, v218, v234
    v_add_f32 v219, v219, v235
    v_add_f32 v220, v220, v236
    v_add_f32 v221, v221, v237
    v_add_f32 v222, v222, v238
    v_add_f32 v223, v223, v239
    v_add_f32 v224, v224, v240
    v_add_f32 v225, v225, v241
    v_add_f32 v226, v226, v242
    v_add_f32 v227, v227, v243
    v_add_f32 v228, v228, v244
    v_mfma_f32_32x32x16_bf16 v[160:175], v[52:55], v[32:35], v[160:175]
    s_add_u32 m0, s45, 98304
    s_add_u32 s3, s59, 0
    buffer_load_dwordx4 v10, s[4:7], s3 offen lds
    v_add_f32 v229, v229, v245
    v_add_f32 v230, v230, v246
    v_add_f32 v231, v231, v247
    v_cvt_pk_bf16_f32 v208, v216, v217
    v_cvt_pk_bf16_f32 v209, v218, v219
    v_cvt_pk_bf16_f32 v210, v220, v221
    v_cvt_pk_bf16_f32 v211, v222, v223
    v_cvt_pk_bf16_f32 v212, v224, v225
    v_cvt_pk_bf16_f32 v213, v226, v227
    v_cvt_pk_bf16_f32 v214, v228, v229
    v_cvt_pk_bf16_f32 v215, v230, v231
    v_accvgpr_read_b32 v248, a16
    v_accvgpr_read_b32 v249, a17
    v_accvgpr_read_b32 v250, a18
    v_mfma_f32_32x32x16_bf16 v[176:191], v[52:55], v[36:39], v[176:191]
    s_add_u32 m0, s46, 98304
    s_add_u32 s3, s60, 0
    buffer_load_dwordx4 v12, s[20:23], s3 offen lds
    v_accvgpr_read_b32 v251, a19
    v_accvgpr_read_b32 v252, a20
    v_accvgpr_read_b32 v253, a21
    v_accvgpr_read_b32 v254, a22
    v_accvgpr_read_b32 v255, a23
    v_accvgpr_read_b32 v216, a24
    v_accvgpr_read_b32 v217, a25
    v_accvgpr_read_b32 v218, a26
    v_accvgpr_read_b32 v219, a27
    v_accvgpr_read_b32 v220, a28
    v_accvgpr_read_b32 v221, a29
    v_accvgpr_read_b32 v222, a30
    v_accvgpr_read_b32 v223, a31
    v_accvgpr_read_b32 v224, a32
    s_waitcnt lgkmcnt(0)
    v_mfma_f32_32x32x16_bf16 v[128:143], v[56:59], v[40:43], v[128:143]
    ds_read_b128 v[32:35], v16 offset:0
    ds_read_b128 v[36:39], v16 offset:4096
    ds_read_b64_tr_b16 v[48:49], v22 offset:8192
    v_accvgpr_read_b32 v225, a33
    v_accvgpr_read_b32 v226, a34
    v_accvgpr_read_b32 v227, a35
    v_accvgpr_read_b32 v228, a36
    v_accvgpr_read_b32 v229, a37
    v_accvgpr_read_b32 v230, a38
    v_accvgpr_read_b32 v231, a39
    v_accvgpr_read_b32 v232, a40
    v_accvgpr_read_b32 v233, a41
    v_accvgpr_read_b32 v234, a42
    v_accvgpr_read_b32 v235, a43
    v_accvgpr_read_b32 v236, a44
    v_accvgpr_read_b32 v237, a45
    v_accvgpr_read_b32 v238, a46
    v_mfma_f32_32x32x16_bf16 v[144:159], v[56:59], v[44:47], v[144:159]
    ds_read_b64_tr_b16 v[50:51], v22 offset:9216
    ds_read_b64_tr_b16 v[52:53], v23 offset:8192
    ds_read_b64_tr_b16 v[54:55], v23 offset:9216
    v_accvgpr_read_b32 v239, a47
    v_accvgpr_read_b32 v240, a48
    v_accvgpr_read_b32 v241, a49
    v_accvgpr_read_b32 v242, a50
    v_accvgpr_read_b32 v243, a51
    v_accvgpr_read_b32 v244, a52
    v_accvgpr_read_b32 v245, a53
    v_accvgpr_read_b32 v246, a54
    v_accvgpr_read_b32 v247, a55
    v_add_f32 v248, v248, v216
    v_add_f32 v249, v249, v217
    v_add_f32 v250, v250, v218
    v_add_f32 v251, v251, v219
    v_add_f32 v252, v252, v220
    v_mfma_f32_32x32x16_bf16 v[160:175], v[60:63], v[40:43], v[160:175]
    s_add_u32 m0, s45, 99328
    s_add_u32 s3, s59, 73728
    buffer_load_dwordx4 v11, s[4:7], s3 offen lds
    v_add_f32 v253, v253, v221
    v_add_f32 v254, v254, v222
    v_add_f32 v255, v255, v223
    v_add_f32 v248, v248, v224
    v_add_f32 v249, v249, v225
    v_add_f32 v250, v250, v226
    v_add_f32 v251, v251, v227
    v_add_f32 v252, v252, v228
    v_add_f32 v253, v253, v229
    v_add_f32 v254, v254, v230
    v_add_f32 v255, v255, v231
    v_add_f32 v248, v248, v232
    v_add_f32 v249, v249, v233
    v_add_f32 v250, v250, v234
    v_mfma_f32_32x32x16_bf16 v[176:191], v[60:63], v[44:47], v[176:191]
    s_add_u32 m0, s46, 99328
    s_add_u32 s3, s60, 8192
    buffer_load_dwordx4 v12, s[20:23], s3 offen lds
    v_add_f32 v251, v251, v235
    v_add_f32 v252, v252, v236
    v_add_f32 v253, v253, v237
    v_add_f32 v254, v254, v238
    v_add_f32 v255, v255, v239
    v_add_f32 v248, v248, v240
    v_add_f32 v249, v249, v241
    v_add_f32 v250, v250, v242
    v_add_f32 v251, v251, v243
    v_add_f32 v252, v252, v244
    v_add_f32 v253, v253, v245
    v_add_f32 v254, v254, v246
    v_add_f32 v255, v255, v247
    v_accvgpr_read_b32 v216, a56
    s_waitcnt lgkmcnt(0)
    v_mfma_f32_32x32x16_bf16 v[128:143], v[48:51], v[32:35], v[128:143]
    ds_read_b128 v[40:43], v17 offset:0
    ds_read_b128 v[44:47], v17 offset:4096
    ds_read_b64_tr_b16 v[56:57], v22 offset:12288
    v_accvgpr_read_b32 v217, a57
    v_accvgpr_read_b32 v218, a58
    v_accvgpr_read_b32 v219, a59
    v_accvgpr_read_b32 v220, a60
    v_accvgpr_read_b32 v221, a61
    v_accvgpr_read_b32 v222, a62
    v_accvgpr_read_b32 v223, a63
    v_accvgpr_read_b32 v224, a64
    v_accvgpr_read_b32 v225, a65
    v_accvgpr_read_b32 v226, a66
    v_accvgpr_read_b32 v227, a67
    v_accvgpr_read_b32 v228, a68
    v_accvgpr_read_b32 v229, a69
    v_accvgpr_read_b32 v230, a70
    v_mfma_f32_32x32x16_bf16 v[144:159], v[48:51], v[36:39], v[144:159]
    ds_read_b64_tr_b16 v[58:59], v22 offset:13312
    ds_read_b64_tr_b16 v[60:61], v23 offset:12288
    ds_read_b64_tr_b16 v[62:63], v23 offset:13312
    v_accvgpr_read_b32 v231, a71
    v_accvgpr_read_b32 v232, a72
    v_accvgpr_read_b32 v233, a73
    v_accvgpr_read_b32 v234, a74
    v_accvgpr_read_b32 v235, a75
    v_accvgpr_read_b32 v236, a76
    v_accvgpr_read_b32 v237, a77
    v_accvgpr_read_b32 v238, a78
    v_accvgpr_read_b32 v239, a79
    v_add_f32 v248, v248, v216
    v_add_f32 v249, v249, v217
    v_add_f32 v250, v250, v218
    v_add_f32 v251, v251, v219
    v_add_f32 v252, v252, v220
    v_mfma_f32_32x32x16_bf16 v[160:175], v[52:55], v[32:35], v[160:175]
    s_add_u32 m0, s45, 100352
    s_add_u32 s3, s59, 147456
    buffer_load_dwordx4 v10, s[4:7], s3 offen lds
    v_add_f32 v253, v253, v221
    v_add_f32 v254, v254, v222
    v_add_f32 v255, v255, v223
    v_add_f32 v248, v248, v224
    v_add_f32 v249, v249, v225
    v_add_f32 v250, v250, v226
    v_add_f32 v251, v251, v227
    v_add_f32 v252, v252, v228
    v_add_f32 v253, v253, v229
    v_add_f32 v254, v254, v230
    v_add_f32 v255, v255, v231
    v_add_f32 v248, v248, v232
    v_add_f32 v249, v249, v233
    v_add_f32 v250, v250, v234
    v_mfma_f32_32x32x16_bf16 v[176:191], v[52:55], v[36:39], v[176:191]
    s_add_u32 m0, s46, 100352
    s_add_u32 s3, s60, 16384
    buffer_load_dwordx4 v12, s[20:23], s3 offen lds
    v_add_f32 v251, v251, v235
    v_add_f32 v252, v252, v236
    v_add_f32 v253, v253, v237
    v_add_f32 v254, v254, v238
    v_add_f32 v255, v255, v239
    v_cvt_pk_bf16_f32 v240, v248, v249
    v_cvt_pk_bf16_f32 v241, v250, v251
    v_cvt_pk_bf16_f32 v242, v252, v253
    v_cvt_pk_bf16_f32 v243, v254, v255
    v_and_b32 v194, 15, v2
    v_lshlrev_b32 v194, 6, v194
    v_and_b32 v197, 1, v1
    v_lshl_add_u32 v194, v197, 10, v194
    v_lshrrev_b32 v197, 1, v1
    s_waitcnt vmcnt(14) lgkmcnt(0)
    s_barrier
    s_waitcnt lgkmcnt(0)
    v_mfma_f32_32x32x16_bf16 v[128:143], v[56:59], v[40:43], v[128:143]
    ds_read_b128 v[32:35], v14 offset:32768
    ds_read_b128 v[36:39], v14 offset:36864
    ds_read_b64_tr_b16 v[48:49], v22 offset:32768
    v_lshl_add_u32 v194, v197, 5, v194
    v_lshrrev_b32 v197, 4, v2
    v_lshl_add_u32 v194, v197, 3, v194
    v_add_u32 v194, 131072, v194
    ds_write_b64 v194, v[240:241]
    ds_write_b64 v194, v[242:243] offset:2048
    v_accvgpr_read_b32 v216, a80
    v_accvgpr_read_b32 v217, a81
    v_accvgpr_read_b32 v218, a82
    v_accvgpr_read_b32 v219, a83
    v_accvgpr_read_b32 v220, a84
    v_accvgpr_read_b32 v221, a85
    v_accvgpr_read_b32 v222, a86
    v_accvgpr_read_b32 v223, a87
    v_mfma_f32_32x32x16_bf16 v[144:159], v[56:59], v[44:47], v[144:159]
    ds_read_b64_tr_b16 v[50:51], v22 offset:33792
    ds_read_b64_tr_b16 v[52:53], v23 offset:32768
    ds_read_b64_tr_b16 v[54:55], v23 offset:33792
    v_accvgpr_read_b32 v224, a88
    v_accvgpr_read_b32 v225, a89
    v_accvgpr_read_b32 v226, a90
    v_accvgpr_read_b32 v227, a91
    v_accvgpr_read_b32 v228, a92
    v_accvgpr_read_b32 v229, a93
    v_accvgpr_read_b32 v230, a94
    v_accvgpr_read_b32 v231, a95
    v_accvgpr_read_b32 v232, a96
    v_accvgpr_read_b32 v233, a97
    v_accvgpr_read_b32 v234, a98
    v_accvgpr_read_b32 v235, a99
    v_accvgpr_read_b32 v236, a100
    v_accvgpr_read_b32 v237, a101
    v_mfma_f32_32x32x16_bf16 v[160:175], v[60:63], v[40:43], v[160:175]
    s_add_u32 m0, s45, 101376
    s_add_u32 s3, s59, 221184
    buffer_load_dwordx4 v11, s[4:7], s3 offen lds
    v_accvgpr_read_b32 v238, a102
    v_accvgpr_read_b32 v239, a103
    v_mov_b32 v195, 0
    v_mov_b32 v196, 0
    v_dot2_f32_bf16 v195, v216, v232, v195
    v_dot2_f32_bf16 v196, v224, v232, v196
    v_dot2_f32_bf16 v195, v217, v233, v195
    v_dot2_f32_bf16 v196, v225, v233, v196
    v_dot2_f32_bf16 v195, v218, v234, v195
    v_dot2_f32_bf16 v196, v226, v234, v196
    v_dot2_f32_bf16 v195, v219, v235, v195
    v_dot2_f32_bf16 v196, v227, v235, v196
    v_dot2_f32_bf16 v195, v220, v236, v195
    v_dot2_f32_bf16 v196, v228, v236, v196
    v_mfma_f32_32x32x16_bf16 v[176:191], v[60:63], v[44:47], v[176:191]
    s_add_u32 m0, s46, 101376
    s_add_u32 s3, s60, 24576
    buffer_load_dwordx4 v12, s[20:23], s3 offen lds
    s_add_u32 s59, s59, 128
    s_add_u32 s60, s60, 131072
    s_add_u32 s99, s99, 1
    s_cmp_eq_u32 s99, 20
    s_cselect_b32 s59, s100, s59
    s_cselect_b32 s60, s101, s60
    s_add_u32 s62, s62, 1
    s_cmp_eq_u32 s62, 20
    s_cselect_b32 s60, s61, s60
    s_cselect_b32 s59, s57, s59
    s_cselect_b32 s20, s24, s20
    s_cselect_b32 s21, s25, s21
    s_cselect_b32 s22, s26, s22
    v_dot2_f32_bf16 v195, v221, v237, v195
    v_dot2_f32_bf16 v196, v229, v237, v196
    v_dot2_f32_bf16 v195, v222, v238, v195
    v_dot2_f32_bf16 v196, v230, v238, v196
    v_dot2_f32_bf16 v195, v223, v239, v195
    v_dot2_f32_bf16 v196, v231, v239, v196
    s_waitcnt lgkmcnt(0)
    v_mfma_f32_32x32x16_bf16 v[128:143], v[48:51], v[32:35], v[128:143]
    ds_read_b128 v[40:43], v15 offset:32768
    ds_read_b128 v[44:47], v15 offset:36864
    ds_read_b64_tr_b16 v[56:57], v22 offset:36864
    v_mfma_f32_32x32x16_bf16 v[144:159], v[48:51], v[36:39], v[144:159]
    ds_read_b64_tr_b16 v[58:59], v22 offset:37888
    ds_read_b64_tr_b16 v[60:61], v23 offset:36864
    ds_read_b64_tr_b16 v[62:63], v23 offset:37888
    v_mfma_f32_32x32x16_bf16 v[160:175], v[52:55], v[32:35], v[160:175]
    s_add_u32 m0, s45, 0
    s_add_u32 s3, s59, 0
    buffer_load_dwordx4 v10, s[4:7], s3 offen lds
    v_mfma_f32_32x32x16_bf16 v[176:191], v[52:55], v[36:39], v[176:191]
    s_add_u32 m0, s46, 0
    s_add_u32 s3, s60, 0
    buffer_load_dwordx4 v12, s[20:23], s3 offen lds
    s_waitcnt lgkmcnt(0)
    v_mfma_f32_32x32x16_bf16 v[128:143], v[56:59], v[40:43], v[128:143]
    ds_read_b128 v[32:35], v16 offset:32768
    ds_read_b128 v[36:39], v16 offset:36864
    ds_read_b64_tr_b16 v[48:49], v22 offset:40960
    v_mfma_f32_32x32x16_bf16 v[144:159], v[56:59], v[44:47], v[144:159]
    ds_read_b64_tr_b16 v[50:51], v22 offset:41984
    ds_read_b64_tr_b16 v[52:53], v23 offset:40960
    ds_read_b64_tr_b16 v[54:55], v23 offset:41984
    v_mfma_f32_32x32x16_bf16 v[160:175], v[60:63], v[40:43], v[160:175]
    s_add_u32 m0, s45, 1024
    s_add_u32 s3, s59, 73728
    buffer_load_dwordx4 v11, s[4:7], s3 offen lds
    v_mfma_f32_32x32x16_bf16 v[176:191], v[60:63], v[44:47], v[176:191]
    s_add_u32 m0, s46, 1024
    s_add_u32 s3, s60, 8192
    buffer_load_dwordx4 v12, s[20:23], s3 offen lds
    s_waitcnt lgkmcnt(0)
    v_mfma_f32_32x32x16_bf16 v[128:143], v[48:51], v[32:35], v[128:143]
    ds_read_b128 v[40:43], v17 offset:32768
    ds_read_b128 v[44:47], v17 offset:36864
    ds_read_b64_tr_b16 v[56:57], v22 offset:45056
    v_mfma_f32_32x32x16_bf16 v[144:159], v[48:51], v[36:39], v[144:159]
    ds_read_b64_tr_b16 v[58:59], v22 offset:46080
    ds_read_b64_tr_b16 v[60:61], v23 offset:45056
    ds_read_b64_tr_b16 v[62:63], v23 offset:46080
    v_mfma_f32_32x32x16_bf16 v[160:175], v[52:55], v[32:35], v[160:175]
    s_add_u32 m0, s45, 2048
    s_add_u32 s3, s59, 147456
    buffer_load_dwordx4 v10, s[4:7], s3 offen lds
    v_mfma_f32_32x32x16_bf16 v[176:191], v[52:55], v[36:39], v[176:191]
    s_add_u32 m0, s46, 2048
    s_add_u32 s3, s60, 16384
    buffer_load_dwordx4 v12, s[20:23], s3 offen lds
    s_waitcnt vmcnt(14) lgkmcnt(0)
    s_barrier
    s_waitcnt lgkmcnt(0)
    v_mfma_f32_32x32x16_bf16 v[128:143], v[56:59], v[40:43], v[128:143]
    ds_read_b128 v[32:35], v18 offset:0
    ds_read_b128 v[36:39], v18 offset:4096
    ds_read_b64_tr_b16 v[48:49], v28 offset:0
    v_mfma_f32_32x32x16_bf16 v[144:159], v[56:59], v[44:47], v[144:159]
    ds_read_b64_tr_b16 v[50:51], v28 offset:1024
    ds_read_b64_tr_b16 v[52:53], v29 offset:0
    ds_read_b64_tr_b16 v[54:55], v29 offset:1024
    v_mfma_f32_32x32x16_bf16 v[160:175], v[60:63], v[40:43], v[160:175]
    s_add_u32 m0, s45, 3072
    s_add_u32 s3, s59, 221184
    buffer_load_dwordx4 v11, s[4:7], s3 offen lds
    v_mfma_f32_32x32x16_bf16 v[176:191], v[60:63], v[44:47], v[176:191]
    s_add_u32 m0, s46, 3072
    s_add_u32 s3, s60, 24576
    buffer_load_dwordx4 v12, s[20:23], s3 offen lds
    s_add_u32 s59, s59, 128
    s_add_u32 s60, s60, 131072
    s_add_u32 s99, s99, 1
    s_cmp_eq_u32 s99, 20
    s_cselect_b32 s59, s100, s59
    s_cselect_b32 s60, s101, s60
    s_add_u32 s62, s62, 1
    s_cmp_eq_u32 s62, 20
    s_cselect_b32 s60, s61, s60
    s_cselect_b32 s59, s57, s59
    s_cselect_b32 s20, s24, s20
    s_cselect_b32 s21, s25, s21
    s_cselect_b32 s22, s26, s22
    s_waitcnt lgkmcnt(0)
    v_mfma_f32_32x32x16_bf16 v[128:143], v[48:51], v[32:35], v[128:143]
    ds_read_b128 v[40:43], v19 offset:0
    ds_read_b128 v[44:47], v19 offset:4096
    ds_read_b64_tr_b16 v[56:57], v28 offset:4096
    v_and_b32 v194, 31, v2
    v_lshlrev_b32 v194, 6, v194
    v_add_u32 v194, v194, v193
    v_add_u32 v194, 131072, v194
    ds_read_b128 v[216:219], v194
    ds_read_b128 v[220:223], v194 offset:32
    v_mfma_f32_32x32x16_bf16 v[144:159], v[48:51], v[36:39], v[144:159]
    ds_read_b64_tr_b16 v[58:59], v28 offset:5120
    ds_read_b64_tr_b16 v[60:61], v29 offset:4096
    ds_read_b64_tr_b16 v[62:63], v29 offset:5120
    ds_read_b128 v[224:227], v194 offset:2048
    ds_read_b128 v[228:231], v194 offset:2080
    ds_swizzle_b32 v197, v195 offset:0x41f
    ds_swizzle_b32 v198, v196 offset:0x41f
    s_waitcnt lgkmcnt(0)
    v_add_f32 v195, v195, v197
    v_mfma_f32_32x32x16_bf16 v[160:175], v[52:55], v[32:35], v[160:175]
    s_add_u32 m0, s45, 32768
    s_add_u32 s3, s59, 0
    buffer_load_dwordx4 v10, s[4:7], s3 offen lds
    v_add_f32 v196, v196, v198
    ds_swizzle_b32 v197, v195 offset:0x81f
    ds_swizzle_b32 v198, v196 offset:0x81f
    s_waitcnt lgkmcnt(0)
    v_add_f32 v195, v195, v197
    v_add_f32 v196, v196, v198
    v_mfma_f32_32x32x16_bf16 v[176:191], v[52:55], v[36:39], v[176:191]
    s_add_u32 m0, s46, 32768
    s_add_u32 s3, s60, 0
    buffer_load_dwordx4 v12, s[20:23], s3 offen lds
    ds_swizzle_b32 v197, v195 offset:0x101f
    ds_swizzle_b32 v198, v196 offset:0x101f
    s_waitcnt lgkmcnt(0)
    v_add_f32 v195, v195, v197
    v_add_f32 v196, v196, v198
    ds_swizzle_b32 v197, v195 offset:0x201f
    s_waitcnt lgkmcnt(0)
    v_mfma_f32_32x32x16_bf16 v[128:143], v[56:59], v[40:43], v[128:143]
    ds_read_b128 v[32:35], v20 offset:0
    ds_read_b128 v[36:39], v20 offset:4096
    ds_read_b64_tr_b16 v[48:49], v28 offset:8192
    ds_swizzle_b32 v198, v196 offset:0x201f
    s_waitcnt lgkmcnt(0)
    v_add_f32 v195, v195, v197
    v_add_f32 v196, v196, v198
    ds_swizzle_b32 v197, v195 offset:0x401f
    ds_swizzle_b32 v198, v196 offset:0x401f
    v_mfma_f32_32x32x16_bf16 v[144:159], v[56:59], v[44:47], v[144:159]
    ds_read_b64_tr_b16 v[50:51], v28 offset:9216
    ds_read_b64_tr_b16 v[52:53], v29 offset:8192
    ds_read_b64_tr_b16 v[54:55], v29 offset:9216
    s_waitcnt lgkmcnt(0)
    v_add_f32 v195, v195, v197
    v_add_f32 v196, v196, v198
    v_mfma_f32_32x32x16_bf16 a[0:15], v[216:219], v[200:203], 0
    v_mfma_f32_32x32x16_bf16 a[32:47], v[224:227], v[200:203], 0
    v_mfma_f32_32x32x16_bf16 a[0:15], v[220:223], v[204:207], a[0:15]
    v_mfma_f32_32x32x16_bf16 v[160:175], v[60:63], v[40:43], v[160:175]
    s_add_u32 m0, s45, 33792
    s_add_u32 s3, s59, 73728
    buffer_load_dwordx4 v11, s[4:7], s3 offen lds
    v_mfma_f32_32x32x16_bf16 a[32:47], v[228:231], v[204:207], a[32:47]
    v_mfma_f32_32x32x16_bf16 a[16:31], v[216:219], v[208:211], 0
    v_mfma_f32_32x32x16_bf16 a[48:63], v[224:227], v[208:211], 0
    v_mfma_f32_32x32x16_bf16 a[16:31], v[220:223], v[212:215], a[16:31]
    v_mfma_f32_32x32x16_bf16 a[48:63], v[228:231], v[212:215], a[48:63]
    v_readlane_b32 s56, v195, 32
    v_mfma_f32_32x32x16_bf16 v[176:191], v[60:63], v[44:47], v[176:191]
    s_add_u32 m0, s46, 33792
    s_add_u32 s3, s60, 8192
    buffer_load_dwordx4 v12, s[20:23], s3 offen lds
    v_readlane_b32 s58, v196, 32
    s_nop 1
    v_add_f32 v195, s56, v195
    v_add_f32 v196, s58, v196
    v_mul_f32 v195, 0xbfb8aa3b, v195
    v_mul_f32 v196, 0xbfb8aa3b, v196
    s_waitcnt lgkmcnt(0)
    v_mfma_f32_32x32x16_bf16 v[128:143], v[48:51], v[32:35], v[128:143]
    ds_read_b128 v[40:43], v21 offset:0
    ds_read_b128 v[44:47], v21 offset:4096
    ds_read_b64_tr_b16 v[56:57], v28 offset:12288
    v_exp_f32 v195, v195
    v_exp_f32 v196, v196
    s_nop 0
    v_add_f32 v195, 1.0, v195
    v_add_f32 v196, 1.0, v196
    v_rcp_f32 v248, v195
    v_mfma_f32_32x32x16_bf16 v[144:159], v[48:51], v[36:39], v[144:159]
    ds_read_b64_tr_b16 v[58:59], v28 offset:13312
    ds_read_b64_tr_b16 v[60:61], v29 offset:12288
    ds_read_b64_tr_b16 v[62:63], v29 offset:13312
    v_rcp_f32 v249, v196
    s_lshl_b32 s27, s48, 2
    s_add_u32 s27, s27, 28311552
    v_mov_b32 v195, 0
    v_cmp_eq_u32 vcc, 0, v2
    s_and_saveexec_b64 s[78:79], vcc
    buffer_store_dwordx2 v[248:249], v195, s[28:31], s27 offen sc1
    s_mov_b64 exec, s[78:79]
    v_and_b32 v194, 31, v2
    v_mfma_f32_32x32x16_bf16 v[160:175], v[52:55], v[32:35], v[160:175]
    s_add_u32 m0, s45, 34816
    s_add_u32 s3, s59, 147456
    buffer_load_dwordx4 v10, s[4:7], s3 offen lds
    v_lshlrev_b32 v194, 5, v194
    v_add_u32 v194, v194, v193
    s_lshl_b32 s48, s51, 3
    s_lshl_b32 s27, s35, 1
    s_add_u32 s48, s48, s27
    s_lshl_b32 s48, s48, 5
    v_mfma_f32_32x32x16_bf16 v[176:191], v[52:55], v[36:39], v[176:191]
    s_add_u32 m0, s46, 34816
    s_add_u32 s3, s60, 16384
    buffer_load_dwordx4 v12, s[20:23], s3 offen lds
    s_add_u32 s48, s48, s50
    s_lshl_b32 s48, s48, 11
    s_add_u32 s48, s48, 41943040
    s_add_u32 s49, s48, 65536
    s_nop 7
    v_accvgpr_read_b32 v196, a32
    s_waitcnt vmcnt(15) lgkmcnt(0)
    s_barrier
    s_waitcnt lgkmcnt(0)
    v_mfma_f32_32x32x16_bf16 v[128:143], v[56:59], v[40:43], v[128:143]
    ds_read_b128 v[32:35], v18 offset:32768
    ds_read_b128 v[36:39], v18 offset:36864
    ds_read_b64_tr_b16 v[48:49], v28 offset:32768
    v_accvgpr_read_b32 v216, a0
    v_accvgpr_read_b32 v217, a1
    v_accvgpr_read_b32 v218, a2
    v_accvgpr_read_b32 v219, a3
    v_accvgpr_read_b32 v220, a4
    v_accvgpr_read_b32 v221, a5
    v_mfma_f32_32x32x16_bf16 v[144:159], v[56:59], v[44:47], v[144:159]
    ds_read_b64_tr_b16 v[50:51], v28 offset:33792
    ds_read_b64_tr_b16 v[52:53], v29 offset:32768
    ds_read_b64_tr_b16 v[54:55], v29 offset:33792
    v_accvgpr_read_b32 v222, a6
    v_accvgpr_read_b32 v223, a7
    v_accvgpr_read_b32 v224, a8
    v_accvgpr_read_b32 v225, a9
    v_accvgpr_read_b32 v226, a10
    v_accvgpr_read_b32 v227, a11
    v_mfma_f32_32x32x16_bf16 v[160:175], v[60:63], v[40:43], v[160:175]
    s_add_u32 m0, s45, 35840
    s_add_u32 s3, s59, 221184
    buffer_load_dwordx4 v11, s[4:7], s3 offen lds
    v_accvgpr_read_b32 v228, a12
    v_accvgpr_read_b32 v229, a13
    v_accvgpr_read_b32 v230, a14
    v_mfma_f32_32x32x16_bf16 v[176:191], v[60:63], v[44:47], v[176:191]
    s_add_u32 m0, s46, 35840
    s_add_u32 s3, s60, 24576
    buffer_load_dwordx4 v12, s[20:23], s3 offen lds
    s_add_u32 s59, s59, 128
    s_add_u32 s60, s60, 131072
    s_add_u32 s99, s99, 1
    s_cmp_eq_u32 s99, 20
    s_cselect_b32 s59, s100, s59
    s_cselect_b32 s60, s101, s60
    s_add_u32 s62, s62, 1
    s_cmp_eq_u32 s62, 20
    s_cselect_b32 s60, s61, s60
    s_cselect_b32 s59, s57, s59
    s_cselect_b32 s20, s24, s20
    s_cselect_b32 s21, s25, s21
    s_cselect_b32 s22, s26, s22
    s_waitcnt lgkmcnt(0)
    v_mfma_f32_32x32x16_bf16 v[128:143], v[48:51], v[32:35], v[128:143]
    ds_read_b128 v[40:43], v19 offset:32768
    ds_read_b128 v[44:47], v19 offset:36864
    ds_read_b64_tr_b16 v[56:57], v28 offset:36864
    v_accvgpr_read_b32 v231, a15
    v_add_f32 v196, 0x358637bd, v196
    v_rcp_f32 v196, v196
    s_nop 0
    v_mul_f32 v216, v216, v196
    v_mul_f32 v217, v217, v196
    v_mfma_f32_32x32x16_bf16 v[144:159], v[48:51], v[36:39], v[144:159]
    ds_read_b64_tr_b16 v[58:59], v28 offset:37888
    ds_read_b64_tr_b16 v[60:61], v29 offset:36864
    ds_read_b64_tr_b16 v[62:63], v29 offset:37888
    v_mul_f32 v218, v218, v196
    v_mul_f32 v219, v219, v196
    v_mul_f32 v220, v220, v196
    v_mul_f32 v221, v221, v196
    v_mul_f32 v222, v222, v196
    v_mul_f32 v223, v223, v196
    v_mfma_f32_32x32x16_bf16 v[160:175], v[52:55], v[32:35], v[160:175]
    s_add_u32 m0, s45, 65536
    s_add_u32 s3, s59, 0
    buffer_load_dwordx4 v10, s[4:7], s3 offen lds
    v_mul_f32 v224, v224, v196
    v_mul_f32 v225, v225, v196
    v_mul_f32 v226, v226, v196
    v_mul_f32 v227, v227, v196
    v_mul_f32 v228, v228, v196
    v_mul_f32 v229, v229, v196
    v_mfma_f32_32x32x16_bf16 v[176:191], v[52:55], v[36:39], v[176:191]
    s_add_u32 m0, s46, 65536
    s_add_u32 s3, s60, 0
    buffer_load_dwordx4 v12, s[20:23], s3 offen lds
    v_mul_f32 v230, v230, v196
    v_mul_f32 v231, v231, v196
    v_cvt_pk_bf16_f32 v232, v216, v217
    v_cvt_pk_bf16_f32 v233, v218, v219
    v_cvt_pk_bf16_f32 v234, v220, v221
    v_cvt_pk_bf16_f32 v235, v222, v223
    s_waitcnt lgkmcnt(0)
    v_mfma_f32_32x32x16_bf16 v[128:143], v[56:59], v[40:43], v[128:143]
    ds_read_b128 v[32:35], v20 offset:32768
    ds_read_b128 v[36:39], v20 offset:36864
    ds_read_b64_tr_b16 v[48:49], v28 offset:40960
    v_cvt_pk_bf16_f32 v236, v224, v225
    v_cvt_pk_bf16_f32 v237, v226, v227
    v_cvt_pk_bf16_f32 v238, v228, v229
    v_cvt_pk_bf16_f32 v239, v230, v231
    s_nop 1
    v_permlane32_swap_b32 v232, v234
    v_mfma_f32_32x32x16_bf16 v[144:159], v[56:59], v[44:47], v[144:159]
    ds_read_b64_tr_b16 v[50:51], v28 offset:41984
    ds_read_b64_tr_b16 v[52:53], v29 offset:40960
    ds_read_b64_tr_b16 v[54:55], v29 offset:41984
    v_permlane32_swap_b32 v233, v235
    v_permlane32_swap_b32 v236, v238
    v_permlane32_swap_b32 v237, v239
    buffer_store_dwordx4 v[232:235], v194, s[28:31], s48 offen sc1
    buffer_store_dwordx4 v[236:239], v194, s[28:31], s48 offen offset:1024 sc1
    v_accvgpr_read_b32 v196, a48
    v_mfma_f32_32x32x16_bf16 v[160:175], v[60:63], v[40:43], v[160:175]
    s_add_u32 m0, s45, 66560
    s_add_u32 s3, s59, 73728
    buffer_load_dwordx4 v11, s[4:7], s3 offen lds
    v_accvgpr_read_b32 v216, a16
    v_accvgpr_read_b32 v217, a17
    v_accvgpr_read_b32 v218, a18
    v_accvgpr_read_b32 v219, a19
    v_accvgpr_read_b32 v220, a20
    v_accvgpr_read_b32 v221, a21
    v_mfma_f32_32x32x16_bf16 v[176:191], v[60:63], v[44:47], v[176:191]
    s_add_u32 m0, s46, 66560
    s_add_u32 s3, s60, 8192
    buffer_load_dwordx4 v12, s[20:23], s3 offen lds
    v_accvgpr_read_b32 v222, a22
    v_accvgpr_read_b32 v223, a23
    v_accvgpr_read_b32 v224, a24
    v_accvgpr_read_b32 v225, a25
    v_accvgpr_read_b32 v226, a26
    v_accvgpr_read_b32 v227, a27
    s_waitcnt lgkmcnt(0)
    v_mfma_f32_32x32x16_bf16 v[128:143], v[48:51], v[32:35], v[128:143]
    ds_read_b128 v[40:43], v21 offset:32768
    ds_read_b128 v[44:47], v21 offset:36864
    ds_read_b64_tr_b16 v[56:57], v28 offset:45056
    v_accvgpr_read_b32 v228, a28
    v_accvgpr_read_b32 v229, a29
    v_accvgpr_read_b32 v230, a30
    v_accvgpr_read_b32 v231, a31
    v_add_f32 v196, 0x358637bd, v196
    v_rcp_f32 v196, v196
    v_mfma_f32_32x32x16_bf16 v[144:159], v[48:51], v[36:39], v[144:159]
    ds_read_b64_tr_b16 v[58:59], v28 offset:46080
    ds_read_b64_tr_b16 v[60:61], v29 offset:45056
    ds_read_b64_tr_b16 v[62:63], v29 offset:46080
    s_nop 0
    v_mul_f32 v216, v216, v196
    v_mul_f32 v217, v217, v196
    v_mul_f32 v218, v218, v196
    v_mul_f32 v219, v219, v196
    v_mul_f32 v220, v220, v196
    v_mfma_f32_32x32x16_bf16 v[160:175], v[52:55], v[32:35], v[160:175]
    s_add_u32 m0, s45, 67584
    s_add_u32 s3, s59, 147456
    buffer_load_dwordx4 v10, s[4:7], s3 offen lds
    v_mul_f32 v221, v221, v196
    v_mul_f32 v222, v222, v196
    v_mul_f32 v223, v223, v196
    v_mul_f32 v224, v224, v196
    v_mul_f32 v225, v225, v196
    v_mul_f32 v226, v226, v196
    v_mfma_f32_32x32x16_bf16 v[176:191], v[52:55], v[36:39], v[176:191]
    s_add_u32 m0, s46, 67584
    s_add_u32 s3, s60, 16384
    buffer_load_dwordx4 v12, s[20:23], s3 offen lds
    v_mul_f32 v227, v227, v196
    v_mul_f32 v228, v228, v196
    v_mul_f32 v229, v229, v196
    v_mul_f32 v230, v230, v196
    v_mul_f32 v231, v231, v196
    v_cvt_pk_bf16_f32 v240, v216, v217
    s_waitcnt vmcnt(17) lgkmcnt(0)
    s_barrier
    s_waitcnt lgkmcnt(0)
    v_mfma_f32_32x32x16_bf16 v[128:143], v[56:59], v[40:43], v[128:143]
    ds_read_b128 v[32:35], v14 offset:0
    ds_read_b128 v[36:39], v14 offset:4096
    ds_read_b64_tr_b16 v[48:49], v22 offset:0
    v_cvt_pk_bf16_f32 v241, v218, v219
    v_cvt_pk_bf16_f32 v242, v220, v221
    v_cvt_pk_bf16_f32 v243, v222, v223
    v_cvt_pk_bf16_f32 v244, v224, v225
    v_cvt_pk_bf16_f32 v245, v226, v227
    v_cvt_pk_bf16_f32 v246, v228, v229
    v_mfma_f32_32x32x16_bf16 v[144:159], v[56:59], v[44:47], v[144:159]
    ds_read_b64_tr_b16 v[50:51], v22 offset:1024
    ds_read_b64_tr_b16 v[52:53], v23 offset:0
    ds_read_b64_tr_b16 v[54:55], v23 offset:1024
    v_cvt_pk_bf16_f32 v247, v230, v231
    s_nop 1
    v_permlane32_swap_b32 v240, v242
    v_permlane32_swap_b32 v241, v243
    v_permlane32_swap_b32 v244, v246
    v_permlane32_swap_b32 v245, v247
    v_mfma_f32_32x32x16_bf16 v[160:175], v[60:63], v[40:43], v[160:175]
    s_add_u32 m0, s45, 68608
    s_add_u32 s3, s59, 221184
    buffer_load_dwordx4 v11, s[4:7], s3 offen lds
    buffer_store_dwordx4 v[240:243], v194, s[28:31], s49 offen sc1
    buffer_store_dwordx4 v[244:247], v194, s[28:31], s49 offen offset:1024 sc1
    v_mfma_f32_32x32x16_bf16 v[176:191], v[60:63], v[44:47], v[176:191]
    s_add_u32 m0, s46, 68608
    s_add_u32 s3, s60, 24576
    buffer_load_dwordx4 v12, s[20:23], s3 offen lds
    s_add_u32 s59, s59, 128
    s_add_u32 s60, s60, 131072
    s_add_u32 s99, s99, 1
    s_cmp_eq_u32 s99, 20
    s_cselect_b32 s59, s100, s59
    s_cselect_b32 s60, s101, s60
    s_add_u32 s62, s62, 1
    s_cmp_eq_u32 s62, 20
    s_cselect_b32 s60, s61, s60
    s_cselect_b32 s59, s57, s59
    s_cselect_b32 s20, s24, s20
    s_cselect_b32 s21, s25, s21
    s_cselect_b32 s22, s26, s22
    s_waitcnt lgkmcnt(0)
    v_mfma_f32_32x32x16_bf16 v[128:143], v[48:51], v[32:35], v[128:143]
    ds_read_b128 v[40:43], v15 offset:0
    ds_read_b128 v[44:47], v15 offset:4096
    ds_read_b64_tr_b16 v[56:57], v22 offset:4096
    v_mfma_f32_32x32x16_bf16 v[144:159], v[48:51], v[36:39], v[144:159]
    ds_read_b64_tr_b16 v[58:59], v22 offset:5120
    ds_read_b64_tr_b16 v[60:61], v23 offset:4096
    ds_read_b64_tr_b16 v[62:63], v23 offset:5120
    v_mfma_f32_32x32x16_bf16 v[160:175], v[52:55], v[32:35], v[160:175]
    s_add_u32 m0, s45, 98304
    s_add_u32 s3, s59, 0
    buffer_load_dwordx4 v10, s[4:7], s3 offen lds
    v_mfma_f32_32x32x16_bf16 v[176:191], v[52:55], v[36:39], v[176:191]
    s_add_u32 m0, s46, 98304
    s_add_u32 s3, s60, 0
    buffer_load_dwordx4 v12, s[20:23], s3 offen lds
    s_waitcnt lgkmcnt(0)
    v_mfma_f32_32x32x16_bf16 v[128:143], v[56:59], v[40:43], v[128:143]
    ds_read_b128 v[32:35], v16 offset:0
    ds_read_b128 v[36:39], v16 offset:4096
    ds_read_b64_tr_b16 v[48:49], v22 offset:8192
    v_mfma_f32_32x32x16_bf16 v[144:159], v[56:59], v[44:47], v[144:159]
    ds_read_b64_tr_b16 v[50:51], v22 offset:9216
    ds_read_b64_tr_b16 v[52:53], v23 offset:8192
    ds_read_b64_tr_b16 v[54:55], v23 offset:9216
    v_mfma_f32_32x32x16_bf16 v[160:175], v[60:63], v[40:43], v[160:175]
    s_add_u32 m0, s45, 99328
    s_add_u32 s3, s59, 73728
    buffer_load_dwordx4 v11, s[4:7], s3 offen lds
    v_mfma_f32_32x32x16_bf16 v[176:191], v[60:63], v[44:47], v[176:191]
    s_add_u32 m0, s46, 99328
    s_add_u32 s3, s60, 8192
    buffer_load_dwordx4 v12, s[20:23], s3 offen lds
    s_waitcnt lgkmcnt(0)
    v_mfma_f32_32x32x16_bf16 v[128:143], v[48:51], v[32:35], v[128:143]
    ds_read_b128 v[40:43], v17 offset:0
    ds_read_b128 v[44:47], v17 offset:4096
    ds_read_b64_tr_b16 v[56:57], v22 offset:12288
    v_mfma_f32_32x32x16_bf16 v[144:159], v[48:51], v[36:39], v[144:159]
    ds_read_b64_tr_b16 v[58:59], v22 offset:13312
    ds_read_b64_tr_b16 v[60:61], v23 offset:12288
    ds_read_b64_tr_b16 v[62:63], v23 offset:13312
    v_mfma_f32_32x32x16_bf16 v[160:175], v[52:55], v[32:35], v[160:175]
    s_add_u32 m0, s45, 100352
    s_add_u32 s3, s59, 147456
    buffer_load_dwordx4 v10, s[4:7], s3 offen lds
    v_mfma_f32_32x32x16_bf16 v[176:191], v[52:55], v[36:39], v[176:191]
    s_add_u32 m0, s46, 100352
    s_add_u32 s3, s60, 16384
    buffer_load_dwordx4 v12, s[20:23], s3 offen lds
    s_waitcnt vmcnt(18) lgkmcnt(0)
    s_barrier
    s_waitcnt lgkmcnt(0)
    v_mfma_f32_32x32x16_bf16 v[128:143], v[56:59], v[40:43], v[128:143]
    ds_read_b128 v[32:35], v14 offset:32768
    ds_read_b128 v[36:39], v14 offset:36864
    ds_read_b64_tr_b16 v[48:49], v22 offset:32768
    v_mfma_f32_32x32x16_bf16 v[144:159], v[56:59], v[44:47], v[144:159]
    ds_read_b64_tr_b16 v[50:51], v22 offset:33792
    ds_read_b64_tr_b16 v[52:53], v23 offset:32768
    ds_read_b64_tr_b16 v[54:55], v23 offset:33792
    v_mfma_f32_32x32x16_bf16 v[160:175], v[60:63], v[40:43], v[160:175]
    s_add_u32 m0, s45, 101376
    s_add_u32 s3, s59, 221184
    buffer_load_dwordx4 v11, s[4:7], s3 offen lds
    v_mfma_f32_32x32x16_bf16 v[176:191], v[60:63], v[44:47], v[176:191]
    s_add_u32 m0, s46, 101376
    s_add_u32 s3, s60, 24576
    buffer_load_dwordx4 v12, s[20:23], s3 offen lds
    s_add_u32 s59, s59, 128
    s_add_u32 s60, s60, 131072
    s_add_u32 s99, s99, 1
    s_cmp_eq_u32 s99, 20
    s_cselect_b32 s59, s100, s59
    s_cselect_b32 s60, s101, s60
    s_add_u32 s62, s62, 1
    s_cmp_eq_u32 s62, 20
    s_cselect_b32 s60, s61, s60
    s_cselect_b32 s59, s57, s59
    s_cselect_b32 s20, s24, s20
    s_cselect_b32 s21, s25, s21
    s_cselect_b32 s22, s26, s22
    s_waitcnt lgkmcnt(0)
    v_mfma_f32_32x32x16_bf16 v[128:143], v[48:51], v[32:35], v[128:143]
    ds_read_b128 v[40:43], v15 offset:32768
    ds_read_b128 v[44:47], v15 offset:36864
    ds_read_b64_tr_b16 v[56:57], v22 offset:36864
    v_mfma_f32_32x32x16_bf16 v[144:159], v[48:51], v[36:39], v[144:159]
    ds_read_b64_tr_b16 v[58:59], v22 offset:37888
    ds_read_b64_tr_b16 v[60:61], v23 offset:36864
    ds_read_b64_tr_b16 v[62:63], v23 offset:37888
    v_mfma_f32_32x32x16_bf16 v[160:175], v[52:55], v[32:35], v[160:175]
    s_add_u32 m0, s45, 0
    s_add_u32 s3, s59, 0
    buffer_load_dwordx4 v10, s[4:7], s3 offen lds
    v_mfma_f32_32x32x16_bf16 v[176:191], v[52:55], v[36:39], v[176:191]
    s_add_u32 m0, s46, 0
    s_add_u32 s3, s60, 0
    buffer_load_dwordx4 v12, s[20:23], s3 offen lds
    s_waitcnt lgkmcnt(0)
    v_mfma_f32_32x32x16_bf16 v[128:143], v[56:59], v[40:43], v[128:143]
    ds_read_b128 v[32:35], v16 offset:32768
    ds_read_b128 v[36:39], v16 offset:36864
    ds_read_b64_tr_b16 v[48:49], v22 offset:40960
    v_mfma_f32_32x32x16_bf16 v[144:159], v[56:59], v[44:47], v[144:159]
    ds_read_b64_tr_b16 v[50:51], v22 offset:41984
    ds_read_b64_tr_b16 v[52:53], v23 offset:40960
    ds_read_b64_tr_b16 v[54:55], v23 offset:41984
    v_mfma_f32_32x32x16_bf16 v[160:175], v[60:63], v[40:43], v[160:175]
    s_add_u32 m0, s45, 1024
    s_add_u32 s3, s59, 73728
    buffer_load_dwordx4 v11, s[4:7], s3 offen lds
    v_mfma_f32_32x32x16_bf16 v[176:191], v[60:63], v[44:47], v[176:191]
    s_add_u32 m0, s46, 1024
    s_add_u32 s3, s60, 8192
    buffer_load_dwordx4 v12, s[20:23], s3 offen lds
    s_waitcnt lgkmcnt(0)
    v_mfma_f32_32x32x16_bf16 v[128:143], v[48:51], v[32:35], v[128:143]
    ds_read_b128 v[40:43], v17 offset:32768
    ds_read_b128 v[44:47], v17 offset:36864
    ds_read_b64_tr_b16 v[56:57], v22 offset:45056
    v_mfma_f32_32x32x16_bf16 v[144:159], v[48:51], v[36:39], v[144:159]
    ds_read_b64_tr_b16 v[58:59], v22 offset:46080
    ds_read_b64_tr_b16 v[60:61], v23 offset:45056
    ds_read_b64_tr_b16 v[62:63], v23 offset:46080
    v_mfma_f32_32x32x16_bf16 v[160:175], v[52:55], v[32:35], v[160:175]
    s_add_u32 m0, s45, 2048
    s_add_u32 s3, s59, 147456
    buffer_load_dwordx4 v10, s[4:7], s3 offen lds
    v_mfma_f32_32x32x16_bf16 v[176:191], v[52:55], v[36:39], v[176:191]
    s_add_u32 m0, s46, 2048
    s_add_u32 s3, s60, 16384
    buffer_load_dwordx4 v12, s[20:23], s3 offen lds
    s_waitcnt vmcnt(14) lgkmcnt(0)
    s_barrier
    s_cmp_eq_u32 s35, 0
    s_cbranch_scc0 K3_NOSIG
    v_mov_b32 v30, 1
    v_mov_b32 v31, 0
    s_lshl_b32 s3, s51, 2
    v_cmp_eq_u32 vcc, 0, v2
    s_and_saveexec_b64 s[78:79], vcc
    buffer_atomic_add v30, v31, s[16:19], s3 offen sc1
    s_mov_b64 exec, s[78:79]
K3_NOSIG:
    s_waitcnt lgkmcnt(0)
    v_mfma_f32_32x32x16_bf16 v[128:143], v[56:59], v[40:43], v[128:143]
    ds_read_b128 v[32:35], v18 offset:0
    ds_read_b128 v[36:39], v18 offset:4096
    ds_read_b64_tr_b16 v[48:49], v28 offset:0
    v_mfma_f32_32x32x16_bf16 v[144:159], v[56:59], v[44:47], v[144:159]
    ds_read_b64_tr_b16 v[50:51], v28 offset:1024
    ds_read_b64_tr_b16 v[52:53], v29 offset:0
    ds_read_b64_tr_b16 v[54:55], v29 offset:1024
    v_mfma_f32_32x32x16_bf16 v[160:175], v[60:63], v[40:43], v[160:175]
    s_add_u32 m0, s45, 3072
    s_add_u32 s3, s59, 221184
    buffer_load_dwordx4 v11, s[4:7], s3 offen lds
    v_mfma_f32_32x32x16_bf16 v[176:191], v[60:63], v[44:47], v[176:191]
    s_add_u32 m0, s46, 3072
    s_add_u32 s3, s60, 24576
    buffer_load_dwordx4 v12, s[20:23], s3 offen lds
    s_add_u32 s59, s59, 128
    s_add_u32 s60, s60, 131072
    s_add_u32 s99, s99, 1
    s_cmp_eq_u32 s99, 20
    s_cselect_b32 s59, s100, s59
    s_cselect_b32 s60, s101, s60
    s_add_u32 s62, s62, 1
    s_cmp_eq_u32 s62, 20
    s_cselect_b32 s60, s61, s60
    s_cselect_b32 s59, s57, s59
    s_cselect_b32 s20, s24, s20
    s_cselect_b32 s21, s25, s21
    s_cselect_b32 s22, s26, s22
    s_waitcnt lgkmcnt(0)
    v_mfma_f32_32x32x16_bf16 v[128:143], v[48:51], v[32:35], v[128:143]
    ds_read_b128 v[40:43], v19 offset:0
    ds_read_b128 v[44:47], v19 offset:4096
    ds_read_b64_tr_b16 v[56:57], v28 offset:4096
    v_mfma_f32_32x32x16_bf16 v[144:159], v[48:51], v[36:39], v[144:159]
    ds_read_b64_tr_b16 v[58:59], v28 offset:5120
    ds_read_b64_tr_b16 v[60:61], v29 offset:4096
    ds_read_b64_tr_b16 v[62:63], v29 offset:5120
    v_mfma_f32_32x32x16_bf16 v[160:175], v[52:55], v[32:35], v[160:175]
    s_add_u32 m0, s45, 32768
    s_add_u32 s3, s59, 0
    buffer_load_dwordx4 v10, s[4:7], s3 offen lds
    v_mfma_f32_32x32x16_bf16 v[176:191], v[52:55], v[36:39], v[176:191]
    s_add_u32 m0, s46, 32768
    s_add_u32 s3, s60, 0
    buffer_load_dwordx4 v12, s[20:23], s3 offen lds
    s_waitcnt lgkmcnt(0)
    v_mfma_f32_32x32x16_bf16 v[128:143], v[56:59], v[40:43], v[128:143]
    ds_read_b128 v[32:35], v20 offset:0
    ds_read_b128 v[36:39], v20 offset:4096
    ds_read_b64_tr_b16 v[48:49], v28 offset:8192
    v_mfma_f32_32x32x16_bf16 v[144:159], v[56:59], v[44:47], v[144:159]
    ds_read_b64_tr_b16 v[50:51], v28 offset:9216
    ds_read_b64_tr_b16 v[52:53], v29 offset:8192
    ds_read_b64_tr_b16 v[54:55], v29 offset:9216
    v_mfma_f32_32x32x16_bf16 v[160:175], v[60:63], v[40:43], v[160:175]
    s_add_u32 m0, s45, 33792
    s_add_u32 s3, s59, 73728
    buffer_load_dwordx4 v11, s[4:7], s3 offen lds
    v_mfma_f32_32x32x16_bf16 v[176:191], v[60:63], v[44:47], v[176:191]
    s_add_u32 m0, s46, 33792
    s_add_u32 s3, s60, 8192
    buffer_load_dwordx4 v12, s[20:23], s3 offen lds
    s_waitcnt lgkmcnt(0)
    v_mfma_f32_32x32x16_bf16 v[128:143], v[48:51], v[32:35], v[128:143]
    ds_read_b128 v[40:43], v21 offset:0
    ds_read_b128 v[44:47], v21 offset:4096
    ds_read_b64_tr_b16 v[56:57], v28 offset:12288
    v_mfma_f32_32x32x16_bf16 v[144:159], v[48:51], v[36:39], v[144:159]
    ds_read_b64_tr_b16 v[58:59], v28 offset:13312
    ds_read_b64_tr_b16 v[60:61], v29 offset:12288
    ds_read_b64_tr_b16 v[62:63], v29 offset:13312
    v_mfma_f32_32x32x16_bf16 v[160:175], v[52:55], v[32:35], v[160:175]
    s_add_u32 m0, s45, 34816
    s_add_u32 s3, s59, 147456
    buffer_load_dwordx4 v10, s[4:7], s3 offen lds
    v_mfma_f32_32x32x16_bf16 v[176:191], v[52:55], v[36:39], v[176:191]
    s_add_u32 m0, s46, 34816
    s_add_u32 s3, s60, 16384
    buffer_load_dwordx4 v12, s[20:23], s3 offen lds
    s_waitcnt vmcnt(15) lgkmcnt(0)
    s_barrier
    s_waitcnt lgkmcnt(0)
    v_mfma_f32_32x32x16_bf16 v[128:143], v[56:59], v[40:43], v[128:143]
    ds_read_b128 v[32:35], v18 offset:32768
    ds_read_b128 v[36:39], v18 offset:36864
    ds_read_b64_tr_b16 v[48:49], v28 offset:32768
    v_mfma_f32_32x32x16_bf16 v[144:159], v[56:59], v[44:47], v[144:159]
    ds_read_b64_tr_b16 v[50:51], v28 offset:33792
    ds_read_b64_tr_b16 v[52:53], v29 offset:32768
    ds_read_b64_tr_b16 v[54:55], v29 offset:33792
    v_mfma_f32_32x32x16_bf16 v[160:175], v[60:63], v[40:43], v[160:175]
    s_add_u32 m0, s45, 35840
    s_add_u32 s3, s59, 221184
    buffer_load_dwordx4 v11, s[4:7], s3 offen lds
    v_mfma_f32_32x32x16_bf16 v[176:191], v[60:63], v[44:47], v[176:191]
    s_add_u32 m0, s46, 35840
    s_add_u32 s3, s60, 24576
    buffer_load_dwordx4 v12, s[20:23], s3 offen lds
    s_add_u32 s59, s59, 128
    s_add_u32 s60, s60, 131072
    s_add_u32 s99, s99, 1
    s_cmp_eq_u32 s99, 20
    s_cselect_b32 s59, s100, s59
    s_cselect_b32 s60, s101, s60
    s_add_u32 s62, s62, 1
    s_cmp_eq_u32 s62, 20
    s_cselect_b32 s60, s61, s60
    s_cselect_b32 s59, s57, s59
    s_cselect_b32 s20, s24, s20
    s_cselect_b32 s21, s25, s21
    s_cselect_b32 s22, s26, s22
    s_waitcnt lgkmcnt(0)
    v_mfma_f32_32x32x16_bf16 v[128:143], v[48:51], v[32:35], v[128:143]
    ds_read_b128 v[40:43], v19 offset:32768
    ds_read_b128 v[44:47], v19 offset:36864
    ds_read_b64_tr_b16 v[56:57], v28 offset:36864
    v_mfma_f32_32x32x16_bf16 v[144:159], v[48:51], v[36:39], v[144:159]
    ds_read_b64_tr_b16 v[58:59], v28 offset:37888
    ds_read_b64_tr_b16 v[60:61], v29 offset:36864
    ds_read_b64_tr_b16 v[62:63], v29 offset:37888
    v_mfma_f32_32x32x16_bf16 v[160:175], v[52:55], v[32:35], v[160:175]
    s_add_u32 m0, s45, 65536
    s_add_u32 s3, s59, 0
    buffer_load_dwordx4 v10, s[4:7], s3 offen lds
    v_mfma_f32_32x32x16_bf16 v[176:191], v[52:55], v[36:39], v[176:191]
    s_add_u32 m0, s46, 65536
    s_add_u32 s3, s60, 0
    buffer_load_dwordx4 v12, s[20:23], s3 offen lds
    s_waitcnt lgkmcnt(0)
    v_mfma_f32_32x32x16_bf16 v[128:143], v[56:59], v[40:43], v[128:143]
    ds_read_b128 v[32:35], v20 offset:32768
    ds_read_b128 v[36:39], v20 offset:36864
    ds_read_b64_tr_b16 v[48:49], v28 offset:40960
    v_mfma_f32_32x32x16_bf16 v[144:159], v[56:59], v[44:47], v[144:159]
    ds_read_b64_tr_b16 v[50:51], v28 offset:41984
    ds_read_b64_tr_b16 v[52:53], v29 offset:40960
    ds_read_b64_tr_b16 v[54:55], v29 offset:41984
    v_mfma_f32_32x32x16_bf16 v[160:175], v[60:63], v[40:43], v[160:175]
    s_add_u32 m0, s45, 66560
    s_add_u32 s3, s59, 73728
    buffer_load_dwordx4 v11, s[4:7], s3 offen lds
    v_mfma_f32_32x32x16_bf16 v[176:191], v[60:63], v[44:47], v[176:191]
    s_add_u32 m0, s46, 66560
    s_add_u32 s3, s60, 8192
    buffer_load_dwordx4 v12, s[20:23], s3 offen lds
    s_waitcnt lgkmcnt(0)
    v_mfma_f32_32x32x16_bf16 v[128:143], v[48:51], v[32:35], v[128:143]
    ds_read_b128 v[40:43], v21 offset:32768
    ds_read_b128 v[44:47], v21 offset:36864
    ds_read_b64_tr_b16 v[56:57], v28 offset:45056
    v_mfma_f32_32x32x16_bf16 v[144:159], v[48:51], v[36:39], v[144:159]
    ds_read_b64_tr_b16 v[58:59], v28 offset:46080
    ds_read_b64_tr_b16 v[60:61], v29 offset:45056
    ds_read_b64_tr_b16 v[62:63], v29 offset:46080
    v_mfma_f32_32x32x16_bf16 v[160:175], v[52:55], v[32:35], v[160:175]
    s_add_u32 m0, s45, 67584
    s_add_u32 s3, s59, 147456
    buffer_load_dwordx4 v10, s[4:7], s3 offen lds
    v_mfma_f32_32x32x16_bf16 v[176:191], v[52:55], v[36:39], v[176:191]
    s_add_u32 m0, s46, 67584
    s_add_u32 s3, s60, 16384
    buffer_load_dwordx4 v12, s[20:23], s3 offen lds
    s_waitcnt vmcnt(14) lgkmcnt(0)
    s_barrier
    s_waitcnt lgkmcnt(0)
    v_mfma_f32_32x32x16_bf16 v[128:143], v[56:59], v[40:43], v[128:143]
    ds_read_b128 v[32:35], v14 offset:0
    ds_read_b128 v[36:39], v14 offset:4096
    ds_read_b64_tr_b16 v[48:49], v22 offset:0
    v_mfma_f32_32x32x16_bf16 v[144:159], v[56:59], v[44:47], v[144:159]
    ds_read_b64_tr_b16 v[50:51], v22 offset:1024
    ds_read_b64_tr_b16 v[52:53], v23 offset:0
    ds_read_b64_tr_b16 v[54:55], v23 offset:1024
    v_mfma_f32_32x32x16_bf16 v[160:175], v[60:63], v[40:43], v[160:175]
    s_add_u32 m0, s45, 68608
    s_add_u32 s3, s59, 221184
    buffer_load_dwordx4 v11, s[4:7], s3 offen lds
    v_mfma_f32_32x32x16_bf16 v[176:191], v[60:63], v[44:47], v[176:191]
    s_add_u32 m0, s46, 68608
    s_add_u32 s3, s60, 24576
    buffer_load_dwordx4 v12, s[20:23], s3 offen lds
    s_add_u32 s59, s59, 128
    s_add_u32 s60, s60, 131072
    s_add_u32 s99, s99, 1
    s_cmp_eq_u32 s99, 20
    s_cselect_b32 s59, s100, s59
    s_cselect_b32 s60, s101, s60
    s_add_u32 s62, s62, 1
    s_cmp_eq_u32 s62, 20
    s_cselect_b32 s60, s61, s60
    s_cselect_b32 s59, s57, s59
    s_cselect_b32 s20, s24, s20
    s_cselect_b32 s21, s25, s21
    s_cselect_b32 s22, s26, s22
    s_waitcnt lgkmcnt(0)
    v_mfma_f32_32x32x16_bf16 v[128:143], v[48:51], v[32:35], v[128:143]
    ds_read_b128 v[40:43], v15 offset:0
    ds_read_b128 v[44:47], v15 offset:4096
    ds_read_b64_tr_b16 v[56:57], v22 offset:4096
    v_mfma_f32_32x32x16_bf16 v[144:159], v[48:51], v[36:39], v[144:159]
    ds_read_b64_tr_b16 v[58:59], v22 offset:5120
    ds_read_b64_tr_b16 v[60:61], v23 offset:4096
    ds_read_b64_tr_b16 v[62:63], v23 offset:5120
    v_mfma_f32_32x32x16_bf16 v[160:175], v[52:55], v[32:35], v[160:175]
    s_add_u32 m0, s45, 98304
    s_add_u32 s3, s59, 0
    buffer_load_dwordx4 v10, s[4:7], s3 offen lds
    v_mfma_f32_32x32x16_bf16 v[176:191], v[52:55], v[36:39], v[176:191]
    s_add_u32 m0, s46, 98304
    s_add_u32 s3, s60, 0
    buffer_load_dwordx4 v12, s[20:23], s3 offen lds
    s_waitcnt lgkmcnt(0)
    v_mfma_f32_32x32x16_bf16 v[128:143], v[56:59], v[40:43], v[128:143]
    ds_read_b128 v[32:35], v16 offset:0
    ds_read_b128 v[36:39], v16 offset:4096
    ds_read_b64_tr_b16 v[48:49], v22 offset:8192
    v_mfma_f32_32x32x16_bf16 v[144:159], v[56:59], v[44:47], v[144:159]
    ds_read_b64_tr_b16 v[50:51], v22 offset:9216
    ds_read_b64_tr_b16 v[52:53], v23 offset:8192
    ds_read_b64_tr_b16 v[54:55], v23 offset:9216
    v_mfma_f32_32x32x16_bf16 v[160:175], v[60:63], v[40:43], v[160:175]
    s_add_u32 m0, s45, 99328
    s_add_u32 s3, s59, 73728
    buffer_load_dwordx4 v11, s[4:7], s3 offen lds
    v_mfma_f32_32x32x16_bf16 v[176:191], v[60:63], v[44:47], v[176:191]
    s_add_u32 m0, s46, 99328
    s_add_u32 s3, s60, 8192
    buffer_load_dwordx4 v12, s[20:23], s3 offen lds
    s_waitcnt lgkmcnt(0)
    v_mfma_f32_32x32x16_bf16 v[128:143], v[48:51], v[32:35], v[128:143]
    ds_read_b128 v[40:43], v17 offset:0
    ds_read_b128 v[44:47], v17 offset:4096
    ds_read_b64_tr_b16 v[56:57], v22 offset:12288
    v_mfma_f32_32x32x16_bf16 v[144:159], v[48:51], v[36:39], v[144:159]
    ds_read_b64_tr_b16 v[58:59], v22 offset:13312
    ds_read_b64_tr_b16 v[60:61], v23 offset:12288
    ds_read_b64_tr_b16 v[62:63], v23 offset:13312
    v_mfma_f32_32x32x16_bf16 v[160:175], v[52:55], v[32:35], v[160:175]
    s_add_u32 m0, s45, 100352
    s_add_u32 s3, s59, 147456
    buffer_load_dwordx4 v10, s[4:7], s3 offen lds
    v_mfma_f32_32x32x16_bf16 v[176:191], v[52:55], v[36:39], v[176:191]
    s_add_u32 m0, s46, 100352
    s_add_u32 s3, s60, 16384
    buffer_load_dwordx4 v12, s[20:23], s3 offen lds
    s_waitcnt vmcnt(14) lgkmcnt(0)
    s_barrier
    s_waitcnt lgkmcnt(0)
    v_mfma_f32_32x32x16_bf16 v[128:143], v[56:59], v[40:43], v[128:143]
    ds_read_b128 v[32:35], v14 offset:32768
    ds_read_b128 v[36:39], v14 offset:36864
    ds_read_b64_tr_b16 v[48:49], v22 offset:32768
    v_mfma_f32_32x32x16_bf16 v[144:159], v[56:59], v[44:47], v[144:159]
    ds_read_b64_tr_b16 v[50:51], v22 offset:33792
    ds_read_b64_tr_b16 v[52:53], v23 offset:32768
    ds_read_b64_tr_b16 v[54:55], v23 offset:33792
    v_mfma_f32_32x32x16_bf16 v[160:175], v[60:63], v[40:43], v[160:175]
    s_add_u32 m0, s45, 101376
    s_add_u32 s3, s59, 221184
    buffer_load_dwordx4 v11, s[4:7], s3 offen lds
    v_mfma_f32_32x32x16_bf16 v[176:191], v[60:63], v[44:47], v[176:191]
    s_add_u32 m0, s46, 101376
    s_add_u32 s3, s60, 24576
    buffer_load_dwordx4 v12, s[20:23], s3 offen lds
    s_add_u32 s59, s59, 128
    s_add_u32 s60, s60, 131072
    s_add_u32 s99, s99, 1
    s_cmp_eq_u32 s99, 20
    s_cselect_b32 s59, s100, s59
    s_cselect_b32 s60, s101, s60
    s_add_u32 s62, s62, 1
    s_cmp_eq_u32 s62, 20
    s_cselect_b32 s60, s61, s60
    s_cselect_b32 s59, s57, s59
    s_cselect_b32 s20, s24, s20
    s_cselect_b32 s21, s25, s21
    s_cselect_b32 s22, s26, s22
    s_waitcnt lgkmcnt(0)
    v_mfma_f32_32x32x16_bf16 v[128:143], v[48:51], v[32:35], v[128:143]
    ds_read_b128 v[40:43], v15 offset:32768
    ds_read_b128 v[44:47], v15 offset:36864
    ds_read_b64_tr_b16 v[56:57], v22 offset:36864
    v_mfma_f32_32x32x16_bf16 v[144:159], v[48:51], v[36:39], v[144:159]
    ds_read_b64_tr_b16 v[58:59], v22 offset:37888
    ds_read_b64_tr_b16 v[60:61], v23 offset:36864
    ds_read_b64_tr_b16 v[62:63], v23 offset:37888
    v_mfma_f32_32x32x16_bf16 v[160:175], v[52:55], v[32:35], v[160:175]
    s_add_u32 m0, s45, 0
    s_add_u32 s3, s59, 0
    buffer_load_dwordx4 v10, s[4:7], s3 offen lds
    v_mfma_f32_32x32x16_bf16 v[176:191], v[52:55], v[36:39], v[176:191]
    s_add_u32 m0, s46, 0
    s_add_u32 s3, s60, 0
    buffer_load_dwordx4 v12, s[20:23], s3 offen lds
    s_waitcnt lgkmcnt(0)
    v_mfma_f32_32x32x16_bf16 v[128:143], v[56:59], v[40:43], v[128:143]
    ds_read_b128 v[32:35], v16 offset:32768
    ds_read_b128 v[36:39], v16 offset:36864
    ds_read_b64_tr_b16 v[48:49], v22 offset:40960
    v_mfma_f32_32x32x16_bf16 v[144:159], v[56:59], v[44:47], v[144:159]
    ds_read_b64_tr_b16 v[50:51], v22 offset:41984
    ds_read_b64_tr_b16 v[52:53], v23 offset:40960
    ds_read_b64_tr_b16 v[54:55], v23 offset:41984
    v_mfma_f32_32x32x16_bf16 v[160:175], v[60:63], v[40:43], v[160:175]
    s_add_u32 m0, s45, 1024
    s_add_u32 s3, s59, 73728
    buffer_load_dwordx4 v11, s[4:7], s3 offen lds
    v_mfma_f32_32x32x16_bf16 v[176:191], v[60:63], v[44:47], v[176:191]
    s_add_u32 m0, s46, 1024
    s_add_u32 s3, s60, 8192
    buffer_load_dwordx4 v12, s[20:23], s3 offen lds
    s_waitcnt lgkmcnt(0)
    v_mfma_f32_32x32x16_bf16 v[128:143], v[48:51], v[32:35], v[128:143]
    ds_read_b128 v[40:43], v17 offset:32768
    ds_read_b128 v[44:47], v17 offset:36864
    ds_read_b64_tr_b16 v[56:57], v22 offset:45056
    v_mfma_f32_32x32x16_bf16 v[144:159], v[48:51], v[36:39], v[144:159]
    ds_read_b64_tr_b16 v[58:59], v22 offset:46080
    ds_read_b64_tr_b16 v[60:61], v23 offset:45056
    ds_read_b64_tr_b16 v[62:63], v23 offset:46080
    v_mfma_f32_32x32x16_bf16 v[160:175], v[52:55], v[32:35], v[160:175]
    s_add_u32 m0, s45, 2048
    s_add_u32 s3, s59, 147456
    buffer_load_dwordx4 v10, s[4:7], s3 offen lds
    v_mfma_f32_32x32x16_bf16 v[176:191], v[52:55], v[36:39], v[176:191]
    s_add_u32 m0, s46, 2048
    s_add_u32 s3, s60, 16384
    buffer_load_dwordx4 v12, s[20:23], s3 offen lds
    s_waitcnt vmcnt(14) lgkmcnt(0)
    s_barrier
    s_waitcnt lgkmcnt(0)
    v_mfma_f32_32x32x16_bf16 v[128:143], v[56:59], v[40:43], v[128:143]
    ds_read_b128 v[32:35], v18 offset:0
    ds_read_b128 v[36:39], v18 offset:4096
    ds_read_b64_tr_b16 v[48:49], v28 offset:0
    v_mfma_f32_32x32x16_bf16 v[144:159], v[56:59], v[44:47], v[144:159]
    ds_read_b64_tr_b16 v[50:51], v28 offset:1024
    ds_read_b64_tr_b16 v[52:53], v29 offset:0
    ds_read_b64_tr_b16 v[54:55], v29 offset:1024
    v_mfma_f32_32x32x16_bf16 v[160:175], v[60:63], v[40:43], v[160:175]
    s_add_u32 m0, s45, 3072
    s_add_u32 s3, s59, 221184
    buffer_load_dwordx4 v11, s[4:7], s3 offen lds
    v_mfma_f32_32x32x16_bf16 v[176:191], v[60:63], v[44:47], v[176:191]
    s_add_u32 m0, s46, 3072
    s_add_u32 s3, s60, 24576
    buffer_load_dwordx4 v12, s[20:23], s3 offen lds
    s_add_u32 s59, s59, 128
    s_add_u32 s60, s60, 131072
    s_add_u32 s99, s99, 1
    s_cmp_eq_u32 s99, 20
    s_cselect_b32 s59, s100, s59
    s_cselect_b32 s60, s101, s60
    s_add_u32 s62, s62, 1
    s_cmp_eq_u32 s62, 20
    s_cselect_b32 s60, s61, s60
    s_cselect_b32 s59, s57, s59
    s_cselect_b32 s20, s24, s20
    s_cselect_b32 s21, s25, s21
    s_cselect_b32 s22, s26, s22
    s_waitcnt lgkmcnt(0)
    v_mfma_f32_32x32x16_bf16 v[128:143], v[48:51], v[32:35], v[128:143]
    ds_read_b128 v[40:43], v19 offset:0
    ds_read_b128 v[44:47], v19 offset:4096
    ds_read_b64_tr_b16 v[56:57], v28 offset:4096
    v_mfma_f32_32x32x16_bf16 v[144:159], v[48:51], v[36:39], v[144:159]
    ds_read_b64_tr_b16 v[58:59], v28 offset:5120
    ds_read_b64_tr_b16 v[60:61], v29 offset:4096
    ds_read_b64_tr_b16 v[62:63], v29 offset:5120
    v_mfma_f32_32x32x16_bf16 v[160:175], v[52:55], v[32:35], v[160:175]
    s_add_u32 m0, s45, 32768
    s_add_u32 s3, s59, 0
    buffer_load_dwordx4 v10, s[4:7], s3 offen lds
    v_mfma_f32_32x32x16_bf16 v[176:191], v[52:55], v[36:39], v[176:191]
    s_add_u32 m0, s46, 32768
    s_add_u32 s3, s60, 0
    buffer_load_dwordx4 v12, s[20:23], s3 offen lds
    s_waitcnt lgkmcnt(0)
    v_mfma_f32_32x32x16_bf16 v[128:143], v[56:59], v[40:43], v[128:143]
    ds_read_b128 v[32:35], v20 offset:0
    ds_read_b128 v[36:39], v20 offset:4096
    ds_read_b64_tr_b16 v[48:49], v28 offset:8192
    v_mfma_f32_32x32x16_bf16 v[144:159], v[56:59], v[44:47], v[144:159]
    ds_read_b64_tr_b16 v[50:51], v28 offset:9216
    ds_read_b64_tr_b16 v[52:53], v29 offset:8192
    ds_read_b64_tr_b16 v[54:55], v29 offset:9216
    v_mfma_f32_32x32x16_bf16 v[160:175], v[60:63], v[40:43], v[160:175]
    s_add_u32 m0, s45, 33792
    s_add_u32 s3, s59, 73728
    buffer_load_dwordx4 v11, s[4:7], s3 offen lds
    v_mfma_f32_32x32x16_bf16 v[176:191], v[60:63], v[44:47], v[176:191]
    s_add_u32 m0, s46, 33792
    s_add_u32 s3, s60, 8192
    buffer_load_dwordx4 v12, s[20:23], s3 offen lds
    s_waitcnt lgkmcnt(0)
    v_mfma_f32_32x32x16_bf16 v[128:143], v[48:51], v[32:35], v[128:143]
    ds_read_b128 v[40:43], v21 offset:0
    ds_read_b128 v[44:47], v21 offset:4096
    ds_read_b64_tr_b16 v[56:57], v28 offset:12288
    v_mfma_f32_32x32x16_bf16 v[144:159], v[48:51], v[36:39], v[144:159]
    ds_read_b64_tr_b16 v[58:59], v28 offset:13312
    ds_read_b64_tr_b16 v[60:61], v29 offset:12288
    ds_read_b64_tr_b16 v[62:63], v29 offset:13312
    v_mfma_f32_32x32x16_bf16 v[160:175], v[52:55], v[32:35], v[160:175]
    s_add_u32 m0, s45, 34816
    s_add_u32 s3, s59, 147456
    buffer_load_dwordx4 v10, s[4:7], s3 offen lds
    v_mfma_f32_32x32x16_bf16 v[176:191], v[52:55], v[36:39], v[176:191]
    s_add_u32 m0, s46, 34816
    s_add_u32 s3, s60, 16384
    buffer_load_dwordx4 v12, s[20:23], s3 offen lds
    s_waitcnt vmcnt(14) lgkmcnt(0)
    s_barrier
    s_waitcnt lgkmcnt(0)
    v_mfma_f32_32x32x16_bf16 v[128:143], v[56:59], v[40:43], v[128:143]
    ds_read_b128 v[32:35], v18 offset:32768
    ds_read_b128 v[36:39], v18 offset:36864
    ds_read_b64_tr_b16 v[48:49], v28 offset:32768
    v_mfma_f32_32x32x16_bf16 v[144:159], v[56:59], v[44:47], v[144:159]
    ds_read_b64_tr_b16 v[50:51], v28 offset:33792
    ds_read_b64_tr_b16 v[52:53], v29 offset:32768
    ds_read_b64_tr_b16 v[54:55], v29 offset:33792
    v_mfma_f32_32x32x16_bf16 v[160:175], v[60:63], v[40:43], v[160:175]
    s_add_u32 m0, s45, 35840
    s_add_u32 s3, s59, 221184
    buffer_load_dwordx4 v11, s[4:7], s3 offen lds
    v_mfma_f32_32x32x16_bf16 v[176:191], v[60:63], v[44:47], v[176:191]
    s_add_u32 m0, s46, 35840
    s_add_u32 s3, s60, 24576
    buffer_load_dwordx4 v12, s[20:23], s3 offen lds
    s_add_u32 s59, s59, 128
    s_add_u32 s60, s60, 131072
    s_add_u32 s99, s99, 1
    s_cmp_eq_u32 s99, 20
    s_cselect_b32 s59, s100, s59
    s_cselect_b32 s60, s101, s60
    s_add_u32 s62, s62, 1
    s_cmp_eq_u32 s62, 20
    s_cselect_b32 s60, s61, s60
    s_cselect_b32 s59, s57, s59
    s_cselect_b32 s20, s24, s20
    s_cselect_b32 s21, s25, s21
    s_cselect_b32 s22, s26, s22
    v_mov_b32 v31, 0
    buffer_load_dword v30, v31, s[16:19], s44 offen sc1
    s_waitcnt lgkmcnt(0)
    v_mfma_f32_32x32x16_bf16 v[128:143], v[48:51], v[32:35], v[128:143]
    ds_read_b128 v[40:43], v19 offset:32768
    ds_read_b128 v[44:47], v19 offset:36864
    ds_read_b64_tr_b16 v[56:57], v28 offset:36864
    v_mfma_f32_32x32x16_bf16 v[144:159], v[48:51], v[36:39], v[144:159]
    ds_read_b64_tr_b16 v[58:59], v28 offset:37888
    ds_read_b64_tr_b16 v[60:61], v29 offset:36864
    ds_read_b64_tr_b16 v[62:63], v29 offset:37888
    v_mfma_f32_32x32x16_bf16 v[160:175], v[52:55], v[32:35], v[160:175]
    s_add_u32 m0, s45, 65536
    s_add_u32 s3, s59, 0
    buffer_load_dwordx4 v10, s[4:7], s3 offen lds
    v_mfma_f32_32x32x16_bf16 v[176:191], v[52:55], v[36:39], v[176:191]
    s_add_u32 m0, s46, 65536
    s_add_u32 s3, s60, 0
    buffer_load_dwordx4 v12, s[20:23], s3 offen lds
    s_waitcnt lgkmcnt(0)
    v_mfma_f32_32x32x16_bf16 v[128:143], v[56:59], v[40:43], v[128:143]
    ds_read_b128 v[32:35], v20 offset:32768
    ds_read_b128 v[36:39], v20 offset:36864
    ds_read_b64_tr_b16 v[48:49], v28 offset:40960
    v_mfma_f32_32x32x16_bf16 v[144:159], v[56:59], v[44:47], v[144:159]
    ds_read_b64_tr_b16 v[50:51], v28 offset:41984
    ds_read_b64_tr_b16 v[52:53], v29 offset:40960
    ds_read_b64_tr_b16 v[54:55], v29 offset:41984
    v_mfma_f32_32x32x16_bf16 v[160:175], v[60:63], v[40:43], v[160:175]
    s_add_u32 m0, s45, 66560
    s_add_u32 s3, s59, 73728
    buffer_load_dwordx4 v11, s[4:7], s3 offen lds
    v_mfma_f32_32x32x16_bf16 v[176:191], v[60:63], v[44:47], v[176:191]
    s_add_u32 m0, s46, 66560
    s_add_u32 s3, s60, 8192
    buffer_load_dwordx4 v12, s[20:23], s3 offen lds
    s_waitcnt lgkmcnt(0)
    v_mfma_f32_32x32x16_bf16 v[128:143], v[48:51], v[32:35], v[128:143]
    ds_read_b128 v[40:43], v21 offset:32768
    ds_read_b128 v[44:47], v21 offset:36864
    ds_read_b64_tr_b16 v[56:57], v28 offset:45056
    v_mfma_f32_32x32x16_bf16 v[144:159], v[48:51], v[36:39], v[144:159]
    ds_read_b64_tr_b16 v[58:59], v28 offset:46080
    ds_read_b64_tr_b16 v[60:61], v29 offset:45056
    ds_read_b64_tr_b16 v[62:63], v29 offset:46080
    v_mfma_f32_32x32x16_bf16 v[160:175], v[52:55], v[32:35], v[160:175]
    s_add_u32 m0, s45, 67584
    s_add_u32 s3, s59, 147456
    buffer_load_dwordx4 v10, s[4:7], s3 offen lds
    v_mfma_f32_32x32x16_bf16 v[176:191], v[52:55], v[36:39], v[176:191]
    s_add_u32 m0, s46, 67584
    s_add_u32 s3, s60, 16384
    buffer_load_dwordx4 v12, s[20:23], s3 offen lds
    s_waitcnt vmcnt(14) lgkmcnt(0)
    s_barrier
    s_waitcnt lgkmcnt(0)
    v_mfma_f32_32x32x16_bf16 v[128:143], v[56:59], v[40:43], v[128:143]
    ds_read_b128 v[32:35], v14 offset:0
    ds_read_b128 v[36:39], v14 offset:4096
    ds_read_b64_tr_b16 v[48:49], v22 offset:0
    v_mfma_f32_32x32x16_bf16 v[144:159], v[56:59], v[44:47], v[144:159]
    ds_read_b64_tr_b16 v[50:51], v22 offset:1024
    ds_read_b64_tr_b16 v[52:53], v23 offset:0
    ds_read_b64_tr_b16 v[54:55], v23 offset:1024
    v_mfma_f32_32x32x16_bf16 v[160:175], v[60:63], v[40:43], v[160:175]
    s_add_u32 m0, s45, 68608
    s_add_u32 s3, s59, 221184
    buffer_load_dwordx4 v11, s[4:7], s3 offen lds
    v_mfma_f32_32x32x16_bf16 v[176:191], v[60:63], v[44:47], v[176:191]
    s_add_u32 m0, s46, 68608
    s_add_u32 s3, s60, 24576
    buffer_load_dwordx4 v12, s[20:23], s3 offen lds
    s_add_u32 s59, s59, 128
    s_add_u32 s60, s60, 131072
    s_add_u32 s99, s99, 1
    s_cmp_eq_u32 s99, 20
    s_cselect_b32 s59, s100, s59
    s_cselect_b32 s60, s101, s60
    s_add_u32 s62, s62, 1
    s_cmp_eq_u32 s62, 20
    s_cselect_b32 s60, s61, s60
    s_cselect_b32 s59, s57, s59
    s_cselect_b32 s20, s24, s20
    s_cselect_b32 s21, s25, s21
    s_cselect_b32 s22, s26, s22
    s_waitcnt lgkmcnt(0)
    v_mfma_f32_32x32x16_bf16 v[128:143], v[48:51], v[32:35], v[128:143]
    ds_read_b128 v[40:43], v15 offset:0
    ds_read_b128 v[44:47], v15 offset:4096
    ds_read_b64_tr_b16 v[56:57], v22 offset:4096
    v_mfma_f32_32x32x16_bf16 v[144:159], v[48:51], v[36:39], v[144:159]
    ds_read_b64_tr_b16 v[58:59], v22 offset:5120
    ds_read_b64_tr_b16 v[60:61], v23 offset:4096
    ds_read_b64_tr_b16 v[62:63], v23 offset:5120
    v_mfma_f32_32x32x16_bf16 v[160:175], v[52:55], v[32:35], v[160:175]
    s_add_u32 m0, s45, 98304
    s_add_u32 s3, s59, 0
    buffer_load_dwordx4 v10, s[4:7], s3 offen lds
    v_mfma_f32_32x32x16_bf16 v[176:191], v[52:55], v[36:39], v[176:191]
    s_add_u32 m0, s46, 98304
    s_add_u32 s3, s60, 0
    buffer_load_dwordx4 v12, s[20:23], s3 offen lds
    s_waitcnt lgkmcnt(0)
    v_mfma_f32_32x32x16_bf16 v[128:143], v[56:59], v[40:43], v[128:143]
    ds_read_b128 v[32:35], v16 offset:0
    ds_read_b128 v[36:39], v16 offset:4096
    ds_read_b64_tr_b16 v[48:49], v22 offset:8192
    v_mfma_f32_32x32x16_bf16 v[144:159], v[56:59], v[44:47], v[144:159]
    ds_read_b64_tr_b16 v[50:51], v22 offset:9216
    ds_read_b64_tr_b16 v[52:53], v23 offset:8192
    ds_read_b64_tr_b16 v[54:55], v23 offset:9216
    v_mfma_f32_32x32x16_bf16 v[160:175], v[60:63], v[40:43], v[160:175]
    s_add_u32 m0, s45, 99328
    s_add_u32 s3, s59, 73728
    buffer_load_dwordx4 v11, s[4:7], s3 offen lds
    v_mfma_f32_32x32x16_bf16 v[176:191], v[60:63], v[44:47], v[176:191]
    s_add_u32 m0, s46, 99328
    s_add_u32 s3, s60, 8192
    buffer_load_dwordx4 v12, s[20:23], s3 offen lds
    s_waitcnt lgkmcnt(0)
    v_mfma_f32_32x32x16_bf16 v[128:143], v[48:51], v[32:35], v[128:143]
    ds_read_b128 v[40:43], v17 offset:0
    ds_read_b128 v[44:47], v17 offset:4096
    ds_read_b64_tr_b16 v[56:57], v22 offset:12288
    v_mfma_f32_32x32x16_bf16 v[144:159], v[48:51], v[36:39], v[144:159]
    ds_read_b64_tr_b16 v[58:59], v22 offset:13312
    ds_read_b64_tr_b16 v[60:61], v23 offset:12288
    ds_read_b64_tr_b16 v[62:63], v23 offset:13312
    v_mfma_f32_32x32x16_bf16 v[160:175], v[52:55], v[32:35], v[160:175]
    s_add_u32 m0, s45, 100352
    s_add_u32 s3, s59, 147456
    buffer_load_dwordx4 v10, s[4:7], s3 offen lds
    v_mfma_f32_32x32x16_bf16 v[176:191], v[52:55], v[36:39], v[176:191]
    s_add_u32 m0, s46, 100352
    s_add_u32 s3, s60, 16384
    buffer_load_dwordx4 v12, s[20:23], s3 offen lds
    s_waitcnt vmcnt(14) lgkmcnt(0)
    s_barrier
    s_waitcnt lgkmcnt(0)
    v_mfma_f32_32x32x16_bf16 v[128:143], v[56:59], v[40:43], v[128:143]
    ds_read_b128 v[32:35], v14 offset:32768
    ds_read_b128 v[36:39], v14 offset:36864
    ds_read_b64_tr_b16 v[48:49], v22 offset:32768
    v_mfma_f32_32x32x16_bf16 v[144:159], v[56:59], v[44:47], v[144:159]
    ds_read_b64_tr_b16 v[50:51], v22 offset:33792
    ds_read_b64_tr_b16 v[52:53], v23 offset:32768
    ds_read_b64_tr_b16 v[54:55], v23 offset:33792
    v_mfma_f32_32x32x16_bf16 v[160:175], v[60:63], v[40:43], v[160:175]
    s_add_u32 m0, s45, 101376
    s_add_u32 s3, s59, 221184
    buffer_load_dwordx4 v11, s[4:7], s3 offen lds
    v_mfma_f32_32x32x16_bf16 v[176:191], v[60:63], v[44:47], v[176:191]
    s_add_u32 m0, s46, 101376
    s_add_u32 s3, s60, 24576
    buffer_load_dwordx4 v12, s[20:23], s3 offen lds
    s_add_u32 s59, s59, 128
    s_add_u32 s60, s60, 131072
    s_add_u32 s99, s99, 1
    s_cmp_eq_u32 s99, 20
    s_cselect_b32 s59, s100, s59
    s_cselect_b32 s60, s101, s60
    s_add_u32 s62, s62, 1
    s_cmp_eq_u32 s62, 20
    s_cselect_b32 s60, s61, s60
    s_cselect_b32 s59, s57, s59
    s_cselect_b32 s20, s24, s20
    s_cselect_b32 s21, s25, s21
    s_cselect_b32 s22, s26, s22
    v_readfirstlane_b32 s3, v30
    s_cmp_ge_u32 s3, 32
    s_cbranch_scc1 K3_READY
    s_mov_b32 s47, 0
K3_SPIN:
    s_sleep 8
    buffer_load_dword v30, v31, s[16:19], s44 offen sc1
    s_waitcnt vmcnt(0)
    v_readfirstlane_b32 s3, v30
    s_add_u32 s47, s47, 1
    s_cmp_ge_u32 s47, 0x20000
    s_cbranch_scc1 K3_READY
    s_cmp_ge_u32 s3, 32
    s_cbranch_scc0 K3_SPIN
K3_READY:
    s_mov_b32 s52, 0
    s_mov_b32 s53, 73728
    s_mov_b32 s54, 147456
    s_mov_b32 s55, 221184
    s_movk_i32 s27, 128
    s_cmp_eq_u32 s36, 0
    s_cbranch_scc0 K3_NOSW
    s_movk_i32 s52, 0
    s_movk_i32 s53, 256
    s_movk_i32 s54, 512
    s_movk_i32 s55, 768
    s_movk_i32 s27, 4096
    s_lshl_b32 s3, s33, 18
    s_add_u32 s3, s3, 41943040
    s_add_u32 s4, s74, s3
    s_addc_u32 s5, s75, 0
    s_and_b32 s5, s5, 0xffff
    s_mov_b32 s6, 0x40000
    v_lshrrev_b32 v3, 3, v2
    v_lshlrev_b32 v3, 5, v3
    v_lshlrev_b32 v4, 16, v1
    v_add_u32 v3, v3, v4
    v_lshrrev_b32 v5, 4, v2
    v_and_b32 v6, 7, v2
    v_xor_b32 v7, v6, v5
    v_lshrrev_b32 v8, 1, v7
    v_lshl_add_u32 v8, v8, 10, v3
    v_and_b32 v9, 1, v7
    v_lshl_add_u32 v10, v9, 4, v8
    v_xor_b32 v7, 4, v7
    v_lshrrev_b32 v8, 1, v7
    v_lshl_add_u32 v8, v8, 10, v3
    v_and_b32 v9, 1, v7
    v_lshl_add_u32 v11, v9, 4, v8
K3_NOSW:
    v_and_b32 v3, 31, v2
    v_lshrrev_b32 v4, 1, v1
    v_lshlrev_b32 v4, 6, v4
    v_add_u32 v3, v3, v4
    v_lshlrev_b32 v4, 2, v3
    s_lshl_b32 s3, s33, 9
    s_add_u32 s3, s3, 28311552
    buffer_load_dword v24, v4, s[28:31], s3 offen sc1
    buffer_load_dword v25, v4, s[28:31], s3 offen offset:128 sc1
    s_waitcnt lgkmcnt(0)
    v_mfma_f32_32x32x16_bf16 v[128:143], v[48:51], v[32:35], v[128:143]
    ds_read_b128 v[40:43], v15 offset:32768
    ds_read_b128 v[44:47], v15 offset:36864
    ds_read_b64_tr_b16 v[56:57], v22 offset:36864
    v_mfma_f32_32x32x16_bf16 v[144:159], v[48:51], v[36:39], v[144:159]
    ds_read_b64_tr_b16 v[58:59], v22 offset:37888
    ds_read_b64_tr_b16 v[60:61], v23 offset:36864
    ds_read_b64_tr_b16 v[62:63], v23 offset:37888
    v_mfma_f32_32x32x16_bf16 v[160:175], v[52:55], v[32:35], v[160:175]
    s_add_u32 m0, s45, 0
    s_add_u32 s3, s59, s52
    buffer_load_dwordx4 v10, s[4:7], s3 offen lds
    v_mfma_f32_32x32x16_bf16 v[176:191], v[52:55], v[36:39], v[176:191]
    s_add_u32 m0, s46, 0
    s_add_u32 s3, s60, 0
    buffer_load_dwordx4 v12, s[20:23], s3 offen lds
    s_waitcnt lgkmcnt(0)
    v_mfma_f32_32x32x16_bf16 v[128:143], v[56:59], v[40:43], v[128:143]
    ds_read_b128 v[32:35], v16 offset:32768
    ds_read_b128 v[36:39], v16 offset:36864
    ds_read_b64_tr_b16 v[48:49], v22 offset:40960
    v_mfma_f32_32x32x16_bf16 v[144:159], v[56:59], v[44:47], v[144:159]
    ds_read_b64_tr_b16 v[50:51], v22 offset:41984
    ds_read_b64_tr_b16 v[52:53], v23 offset:40960
    ds_read_b64_tr_b16 v[54:55], v23 offset:41984
    v_mfma_f32_32x32x16_bf16 v[160:175], v[60:63], v[40:43], v[160:175]
    s_add_u32 m0, s45, 1024
    s_add_u32 s3, s59, s53
    buffer_load_dwordx4 v11, s[4:7], s3 offen lds
    v_mfma_f32_32x32x16_bf16 v[176:191], v[60:63], v[44:47], v[176:191]
    s_add_u32 m0, s46, 1024
    s_add_u32 s3, s60, 8192
    buffer_load_dwordx4 v12, s[20:23], s3 offen lds
    s_waitcnt lgkmcnt(0)
    v_mfma_f32_32x32x16_bf16 v[128:143], v[48:51], v[32:35], v[128:143]
    ds_read_b128 v[40:43], v17 offset:32768
    ds_read_b128 v[44:47], v17 offset:36864
    ds_read_b64_tr_b16 v[56:57], v22 offset:45056
    v_mfma_f32_32x32x16_bf16 v[144:159], v[48:51], v[36:39], v[144:159]
    ds_read_b64_tr_b16 v[58:59], v22 offset:46080
    ds_read_b64_tr_b16 v[60:61], v23 offset:45056
    ds_read_b64_tr_b16 v[62:63], v23 offset:46080
    v_mfma_f32_32x32x16_bf16 v[160:175], v[52:55], v[32:35], v[160:175]
    s_add_u32 m0, s45, 2048
    s_add_u32 s3, s59, s54
    buffer_load_dwordx4 v10, s[4:7], s3 offen lds
    v_mfma_f32_32x32x16_bf16 v[176:191], v[52:55], v[36:39], v[176:191]
    s_add_u32 m0, s46, 2048
    s_add_u32 s3, s60, 16384
    buffer_load_dwordx4 v12, s[20:23], s3 offen lds
    s_waitcnt vmcnt(14) lgkmcnt(0)
    s_barrier
    s_waitcnt lgkmcnt(0)
    v_mfma_f32_32x32x16_bf16 v[128:143], v[56:59], v[40:43], v[128:143]
    ds_read_b128 v[32:35], v18 offset:0
    ds_read_b128 v[36:39], v18 offset:4096
    ds_read_b64_tr_b16 v[48:49], v28 offset:0
    v_mfma_f32_32x32x16_bf16 v[144:159], v[56:59], v[44:47], v[144:159]
    ds_read_b64_tr_b16 v[50:51], v28 offset:1024
    ds_read_b64_tr_b16 v[52:53], v29 offset:0
    ds_read_b64_tr_b16 v[54:55], v29 offset:1024
    v_mfma_f32_32x32x16_bf16 v[160:175], v[60:63], v[40:43], v[160:175]
    s_add_u32 m0, s45, 3072
    s_add_u32 s3, s59, s55
    buffer_load_dwordx4 v11, s[4:7], s3 offen lds
    v_mfma_f32_32x32x16_bf16 v[176:191], v[60:63], v[44:47], v[176:191]
    s_add_u32 m0, s46, 3072
    s_add_u32 s3, s60, 24576
    buffer_load_dwordx4 v12, s[20:23], s3 offen lds
    s_add_u32 s59, s59, s27
    s_add_u32 s60, s60, 131072
    s_waitcnt lgkmcnt(0)
    v_mfma_f32_32x32x16_bf16 v[128:143], v[48:51], v[32:35], v[128:143]
    ds_read_b128 v[40:43], v19 offset:0
    ds_read_b128 v[44:47], v19 offset:4096
    ds_read_b64_tr_b16 v[56:57], v28 offset:4096
    v_mfma_f32_32x32x16_bf16 v[144:159], v[48:51], v[36:39], v[144:159]
    ds_read_b64_tr_b16 v[58:59], v28 offset:5120
    ds_read_b64_tr_b16 v[60:61], v29 offset:4096
    ds_read_b64_tr_b16 v[62:63], v29 offset:5120
    v_mfma_f32_32x32x16_bf16 v[160:175], v[52:55], v[32:35], v[160:175]
    s_add_u32 m0, s45, 32768
    s_add_u32 s3, s59, s52
    buffer_load_dwordx4 v10, s[4:7], s3 offen lds
    v_mfma_f32_32x32x16_bf16 v[176:191], v[52:55], v[36:39], v[176:191]
    s_add_u32 m0, s46, 32768
    s_add_u32 s3, s60, 0
    buffer_load_dwordx4 v12, s[20:23], s3 offen lds
    s_waitcnt lgkmcnt(0)
    v_mfma_f32_32x32x16_bf16 v[128:143], v[56:59], v[40:43], v[128:143]
    ds_read_b128 v[32:35], v20 offset:0
    ds_read_b128 v[36:39], v20 offset:4096
    ds_read_b64_tr_b16 v[48:49], v28 offset:8192
    v_mfma_f32_32x32x16_bf16 v[144:159], v[56:59], v[44:47], v[144:159]
    ds_read_b64_tr_b16 v[50:51], v28 offset:9216
    ds_read_b64_tr_b16 v[52:53], v29 offset:8192
    ds_read_b64_tr_b16 v[54:55], v29 offset:9216
    v_mfma_f32_32x32x16_bf16 v[160:175], v[60:63], v[40:43], v[160:175]
    s_add_u32 m0, s45, 33792
    s_add_u32 s3, s59, s53
    buffer_load_dwordx4 v11, s[4:7], s3 offen lds
    v_mfma_f32_32x32x16_bf16 v[176:191], v[60:63], v[44:47], v[176:191]
    s_add_u32 m0, s46, 33792
    s_add_u32 s3, s60, 8192
    buffer_load_dwordx4 v12, s[20:23], s3 offen lds
    s_waitcnt lgkmcnt(0)
    v_mfma_f32_32x32x16_bf16 v[128:143], v[48:51], v[32:35], v[128:143]
    ds_read_b128 v[40:43], v21 offset:0
    ds_read_b128 v[44:47], v21 offset:4096
    ds_read_b64_tr_b16 v[56:57], v28 offset:12288
    v_mfma_f32_32x32x16_bf16 v[144:159], v[48:51], v[36:39], v[144:159]
    ds_read_b64_tr_b16 v[58:59], v28 offset:13312
    ds_read_b64_tr_b16 v[60:61], v29 offset:12288
    ds_read_b64_tr_b16 v[62:63], v29 offset:13312
    v_mfma_f32_32x32x16_bf16 v[160:175], v[52:55], v[32:35], v[160:175]
    s_add_u32 m0, s45, 34816
    s_add_u32 s3, s59, s54
    buffer_load_dwordx4 v10, s[4:7], s3 offen lds
    v_mfma_f32_32x32x16_bf16 v[176:191], v[52:55], v[36:39], v[176:191]
    s_add_u32 m0, s46, 34816
    s_add_u32 s3, s60, 16384
    buffer_load_dwordx4 v12, s[20:23], s3 offen lds
    s_waitcnt vmcnt(14) lgkmcnt(0)
    s_barrier
    s_waitcnt lgkmcnt(0)
    v_mfma_f32_32x32x16_bf16 v[128:143], v[56:59], v[40:43], v[128:143]
    ds_read_b128 v[32:35], v18 offset:32768
    ds_read_b128 v[36:39], v18 offset:36864
    ds_read_b64_tr_b16 v[48:49], v28 offset:32768
    v_mfma_f32_32x32x16_bf16 v[144:159], v[56:59], v[44:47], v[144:159]
    ds_read_b64_tr_b16 v[50:51], v28 offset:33792
    ds_read_b64_tr_b16 v[52:53], v29 offset:32768
    ds_read_b64_tr_b16 v[54:55], v29 offset:33792
    v_mfma_f32_32x32x16_bf16 v[160:175], v[60:63], v[40:43], v[160:175]
    s_add_u32 m0, s45, 35840
    s_add_u32 s3, s59, s55
    buffer_load_dwordx4 v11, s[4:7], s3 offen lds
    v_mfma_f32_32x32x16_bf16 v[176:191], v[60:63], v[44:47], v[176:191]
    s_add_u32 m0, s46, 35840
    s_add_u32 s3, s60, 24576
    buffer_load_dwordx4 v12, s[20:23], s3 offen lds
    s_add_u32 s59, s59, s27
    s_add_u32 s60, s60, 131072
    s_waitcnt lgkmcnt(0)
    v_mfma_f32_32x32x16_bf16 v[128:143], v[48:51], v[32:35], v[128:143]
    ds_read_b128 v[40:43], v19 offset:32768
    ds_read_b128 v[44:47], v19 offset:36864
    ds_read_b64_tr_b16 v[56:57], v28 offset:36864
    v_mfma_f32_32x32x16_bf16 v[144:159], v[48:51], v[36:39], v[144:159]
    ds_read_b64_tr_b16 v[58:59], v28 offset:37888
    ds_read_b64_tr_b16 v[60:61], v29 offset:36864
    ds_read_b64_tr_b16 v[62:63], v29 offset:37888
    v_mfma_f32_32x32x16_bf16 v[160:175], v[52:55], v[32:35], v[160:175]
    s_add_u32 m0, s45, 65536
    s_add_u32 s3, s59, s52
    buffer_load_dwordx4 v10, s[4:7], s3 offen lds
    v_mfma_f32_32x32x16_bf16 v[176:191], v[52:55], v[36:39], v[176:191]
    s_add_u32 m0, s46, 65536
    s_add_u32 s3, s60, 0
    buffer_load_dwordx4 v12, s[20:23], s3 offen lds
    s_waitcnt lgkmcnt(0)
    v_mfma_f32_32x32x16_bf16 v[128:143], v[56:59], v[40:43], v[128:143]
    ds_read_b128 v[32:35], v20 offset:32768
    ds_read_b128 v[36:39], v20 offset:36864
    ds_read_b64_tr_b16 v[48:49], v28 offset:40960
    v_mfma_f32_32x32x16_bf16 v[144:159], v[56:59], v[44:47], v[144:159]
    ds_read_b64_tr_b16 v[50:51], v28 offset:41984
    ds_read_b64_tr_b16 v[52:53], v29 offset:40960
    ds_read_b64_tr_b16 v[54:55], v29 offset:41984
    v_mfma_f32_32x32x16_bf16 v[160:175], v[60:63], v[40:43], v[160:175]
    s_add_u32 m0, s45, 66560
    s_add_u32 s3, s59, s53
    buffer_load_dwordx4 v11, s[4:7], s3 offen lds
    v_mfma_f32_32x32x16_bf16 v[176:191], v[60:63], v[44:47], v[176:191]
    s_add_u32 m0, s46, 66560
    s_add_u32 s3, s60, 8192
    buffer_load_dwordx4 v12, s[20:23], s3 offen lds
    s_waitcnt lgkmcnt(0)
    v_mfma_f32_32x32x16_bf16 v[128:143], v[48:51], v[32:35], v[128:143]
    ds_read_b128 v[40:43], v21 offset:32768
    ds_read_b128 v[44:47], v21 offset:36864
    ds_read_b64_tr_b16 v[56:57], v28 offset:45056
    v_mfma_f32_32x32x16_bf16 v[144:159], v[48:51], v[36:39], v[144:159]
    ds_read_b64_tr_b16 v[58:59], v28 offset:46080
    ds_read_b64_tr_b16 v[60:61], v29 offset:45056
    ds_read_b64_tr_b16 v[62:63], v29 offset:46080
    v_mfma_f32_32x32x16_bf16 v[160:175], v[52:55], v[32:35], v[160:175]
    s_add_u32 m0, s45, 67584
    s_add_u32 s3, s59, s54
    buffer_load_dwordx4 v10, s[4:7], s3 offen lds
    v_mfma_f32_32x32x16_bf16 v[176:191], v[52:55], v[36:39], v[176:191]
    s_add_u32 m0, s46, 67584
    s_add_u32 s3, s60, 16384
    buffer_load_dwordx4 v12, s[20:23], s3 offen lds
    s_waitcnt vmcnt(14) lgkmcnt(0)
    s_barrier
    s_waitcnt lgkmcnt(0)
    v_mfma_f32_32x32x16_bf16 v[128:143], v[56:59], v[40:43], v[128:143]
    ds_read_b128 v[32:35], v14 offset:0
    ds_read_b128 v[36:39], v14 offset:4096
    ds_read_b64_tr_b16 v[48:49], v22 offset:0
    v_mfma_f32_32x32x16_bf16 v[144:159], v[56:59], v[44:47], v[144:159]
    ds_read_b64_tr_b16 v[50:51], v22 offset:1024
    ds_read_b64_tr_b16 v[52:53], v23 offset:0
    ds_read_b64_tr_b16 v[54:55], v23 offset:1024
    v_mfma_f32_32x32x16_bf16 v[160:175], v[60:63], v[40:43], v[160:175]
    s_add_u32 m0, s45, 68608
    s_add_u32 s3, s59, s55
    buffer_load_dwordx4 v11, s[4:7], s3 offen lds
    v_mfma_f32_32x32x16_bf16 v[176:191], v[60:63], v[44:47], v[176:191]
    s_add_u32 m0, s46, 68608
    s_add_u32 s3, s60, 24576
    buffer_load_dwordx4 v12, s[20:23], s3 offen lds
    s_add_u32 s59, s59, s27
    s_add_u32 s60, s60, 131072
    s_mov_b32 s63, 0
K3_LOOP2:
    s_waitcnt lgkmcnt(0)
    v_mfma_f32_32x32x16_bf16 v[64:79], v[48:51], v[32:35], v[64:79]
    ds_read_b128 v[40:43], v15 offset:0
    ds_read_b128 v[44:47], v15 offset:4096
    ds_read_b64_tr_b16 v[56:57], v22 offset:4096
    v_mfma_f32_32x32x16_bf16 v[80:95], v[48:51], v[36:39], v[80:95]
    ds_read_b64_tr_b16 v[58:59], v22 offset:5120
    ds_read_b64_tr_b16 v[60:61], v23 offset:4096
    ds_read_b64_tr_b16 v[62:63], v23 offset:5120
    v_mfma_f32_32x32x16_bf16 v[96:111], v[52:55], v[32:35], v[96:111]
    s_add_u32 m0, s45, 98304
    s_add_u32 s3, s59, s52
    buffer_load_dwordx4 v10, s[4:7], s3 offen lds
    v_mfma_f32_32x32x16_bf16 v[112:127], v[52:55], v[36:39], v[112:127]
    s_add_u32 m0, s46, 98304
    s_add_u32 s3, s60, 0
    buffer_load_dwordx4 v12, s[20:23], s3 offen lds
    s_waitcnt lgkmcnt(0)
    v_mfma_f32_32x32x16_bf16 v[64:79], v[56:59], v[40:43], v[64:79]
    ds_read_b128 v[32:35], v16 offset:0
    ds_read_b128 v[36:39], v16 offset:4096
    ds_read_b64_tr_b16 v[48:49], v22 offset:8192
    v_mfma_f32_32x32x16_bf16 v[80:95], v[56:59], v[44:47], v[80:95]
    ds_read_b64_tr_b16 v[50:51], v22 offset:9216
    ds_read_b64_tr_b16 v[52:53], v23 offset:8192
    ds_read_b64_tr_b16 v[54:55], v23 offset:9216
    v_mfma_f32_32x32x16_bf16 v[96:111], v[60:63], v[40:43], v[96:111]
    s_add_u32 m0, s45, 99328
    s_add_u32 s3, s59, s53
    buffer_load_dwordx4 v11, s[4:7], s3 offen lds
    v_mfma_f32_32x32x16_bf16 v[112:127], v[60:63], v[44:47], v[112:127]
    s_add_u32 m0, s46, 99328
    s_add_u32 s3, s60, 8192
    buffer_load_dwordx4 v12, s[20:23], s3 offen lds
    s_waitcnt lgkmcnt(0)
    v_mfma_f32_32x32x16_bf16 v[64:79], v[48:51], v[32:35], v[64:79]
    ds_read_b128 v[40:43], v17 offset:0
    ds_read_b128 v[44:47], v17 offset:4096
    ds_read_b64_tr_b16 v[56:57], v22 offset:12288
    v_mfma_f32_32x32x16_bf16 v[80:95], v[48:51], v[36:39], v[80:95]
    ds_read_b64_tr_b16 v[58:59], v22 offset:13312
    ds_read_b64_tr_b16 v[60:61], v23 offset:12288
    ds_read_b64_tr_b16 v[62:63], v23 offset:13312
    v_mfma_f32_32x32x16_bf16 v[96:111], v[52:55], v[32:35], v[96:111]
    s_add_u32 m0, s45, 100352
    s_add_u32 s3, s59, s54
    buffer_load_dwordx4 v10, s[4:7], s3 offen lds
    v_mfma_f32_32x32x16_bf16 v[112:127], v[52:55], v[36:39], v[112:127]
    s_add_u32 m0, s46, 100352
    s_add_u32 s3, s60, 16384
    buffer_load_dwordx4 v12, s[20:23], s3 offen lds
    s_waitcnt vmcnt(14) lgkmcnt(0)
    s_barrier
    s_waitcnt lgkmcnt(0)
    v_mfma_f32_32x32x16_bf16 v[64:79], v[56:59], v[40:43], v[64:79]
    ds_read_b128 v[32:35], v14 offset:32768
    ds_read_b128 v[36:39], v14 offset:36864
    ds_read_b64_tr_b16 v[48:49], v22 offset:32768
    v_mfma_f32_32x32x16_bf16 v[80:95], v[56:59], v[44:47], v[80:95]
    ds_read_b64_tr_b16 v[50:51], v22 offset:33792
    ds_read_b64_tr_b16 v[52:53], v23 offset:32768
    ds_read_b64_tr_b16 v[54:55], v23 offset:33792
    v_mfma_f32_32x32x16_bf16 v[96:111], v[60:63], v[40:43], v[96:111]
    s_add_u32 m0, s45, 101376
    s_add_u32 s3, s59, s55
    buffer_load_dwordx4 v11, s[4:7], s3 offen lds
    v_mfma_f32_32x32x16_bf16 v[112:127], v[60:63], v[44:47], v[112:127]
    s_add_u32 m0, s46, 101376
    s_add_u32 s3, s60, 24576
    buffer_load_dwordx4 v12, s[20:23], s3 offen lds
    s_add_u32 s59, s59, s27
    s_add_u32 s60, s60, 131072
    s_waitcnt lgkmcnt(0)
    v_mfma_f32_32x32x16_bf16 v[64:79], v[48:51], v[32:35], v[64:79]
    ds_read_b128 v[40:43], v15 offset:32768
    ds_read_b128 v[44:47], v15 offset:36864
    ds_read_b64_tr_b16 v[56:57], v22 offset:36864
    v_mfma_f32_32x32x16_bf16 v[80:95], v[48:51], v[36:39], v[80:95]
    ds_read_b64_tr_b16 v[58:59], v22 offset:37888
    ds_read_b64_tr_b16 v[60:61], v23 offset:36864
    ds_read_b64_tr_b16 v[62:63], v23 offset:37888
    v_mfma_f32_32x32x16_bf16 v[96:111], v[52:55], v[32:35], v[96:111]
    s_add_u32 m0, s45, 0
    s_add_u32 s3, s59, s52
    buffer_load_dwordx4 v10, s[4:7], s3 offen lds
    v_mfma_f32_32x32x16_bf16 v[112:127], v[52:55], v[36:39], v[112:127]
    s_add_u32 m0, s46, 0
    s_add_u32 s3, s60, 0
    buffer_load_dwordx4 v12, s[20:23], s3 offen lds
    s_waitcnt lgkmcnt(0)
    v_mfma_f32_32x32x16_bf16 v[64:79], v[56:59], v[40:43], v[64:79]
    ds_read_b128 v[32:35], v16 offset:32768
    ds_read_b128 v[36:39], v16 offset:36864
    ds_read_b64_tr_b16 v[48:49], v22 offset:40960
    v_mfma_f32_32x32x16_bf16 v[80:95], v[56:59], v[44:47], v[80:95]
    ds_read_b64_tr_b16 v[50:51], v22 offset:41984
    ds_read_b64_tr_b16 v[52:53], v23 offset:40960
    ds_read_b64_tr_b16 v[54:55], v23 offset:41984
    v_mfma_f32_32x32x16_bf16 v[96:111], v[60:63], v[40:43], v[96:111]
    s_add_u32 m0, s45, 1024
    s_add_u32 s3, s59, s53
    buffer_load_dwordx4 v11, s[4:7], s3 offen lds
    v_mfma_f32_32x32x16_bf16 v[112:127], v[60:63], v[44:47], v[112:127]
    s_add_u32 m0, s46, 1024
    s_add_u32 s3, s60, 8192
    buffer_load_dwordx4 v12, s[20:23], s3 offen lds
    s_waitcnt lgkmcnt(0)
    v_mfma_f32_32x32x16_bf16 v[64:79], v[48:51], v[32:35], v[64:79]
    ds_read_b128 v[40:43], v17 offset:32768
    ds_read_b128 v[44:47], v17 offset:36864
    ds_read_b64_tr_b16 v[56:57], v22 offset:45056
    v_mfma_f32_32x32x16_bf16 v[80:95], v[48:51], v[36:39], v[80:95]
    ds_read_b64_tr_b16 v[58:59], v22 offset:46080
    ds_read_b64_tr_b16 v[60:61], v23 offset:45056
    ds_read_b64_tr_b16 v[62:63], v23 offset:46080
    v_mfma_f32_32x32x16_bf16 v[96:111], v[52:55], v[32:35], v[96:111]
    s_add_u32 m0, s45, 2048
    s_add_u32 s3, s59, s54
    buffer_load_dwordx4 v10, s[4:7], s3 offen lds
    v_mfma_f32_32x32x16_bf16 v[112:127], v[52:55], v[36:39], v[112:127]
    s_add_u32 m0, s46, 2048
    s_add_u32 s3, s60, 16384
    buffer_load_dwordx4 v12, s[20:23], s3 offen lds
    s_waitcnt vmcnt(14) lgkmcnt(0)
    s_barrier
    s_waitcnt lgkmcnt(0)
    v_mfma_f32_32x32x16_bf16 v[64:79], v[56:59], v[40:43], v[64:79]
    ds_read_b128 v[32:35], v18 offset:0
    ds_read_b128 v[36:39], v18 offset:4096
    ds_read_b64_tr_b16 v[48:49], v28 offset:0
    v_mfma_f32_32x32x16_bf16 v[80:95], v[56:59], v[44:47], v[80:95]
    ds_read_b64_tr_b16 v[50:51], v28 offset:1024
    ds_read_b64_tr_b16 v[52:53], v29 offset:0
    ds_read_b64_tr_b16 v[54:55], v29 offset:1024
    v_mfma_f32_32x32x16_bf16 v[96:111], v[60:63], v[40:43], v[96:111]
    s_add_u32 m0, s45, 3072
    s_add_u32 s3, s59, s55
    buffer_load_dwordx4 v11, s[4:7], s3 offen lds
    v_mfma_f32_32x32x16_bf16 v[112:127], v[60:63], v[44:47], v[112:127]
    s_add_u32 m0, s46, 3072
    s_add_u32 s3, s60, 24576
    buffer_load_dwordx4 v12, s[20:23], s3 offen lds
    s_add_u32 s59, s59, s27
    s_add_u32 s60, s60, 131072
    s_waitcnt lgkmcnt(0)
    v_mfma_f32_32x32x16_bf16 v[64:79], v[48:51], v[32:35], v[64:79]
    ds_read_b128 v[40:43], v19 offset:0
    ds_read_b128 v[44:47], v19 offset:4096
    ds_read_b64_tr_b16 v[56:57], v28 offset:4096
    v_mfma_f32_32x32x16_bf16 v[80:95], v[48:51], v[36:39], v[80:95]
    ds_read_b64_tr_b16 v[58:59], v28 offset:5120
    ds_read_b64_tr_b16 v[60:61], v29 offset:4096
    ds_read_b64_tr_b16 v[62:63], v29 offset:5120
    v_mfma_f32_32x32x16_bf16 v[96:111], v[52:55], v[32:35], v[96:111]
    s_add_u32 m0, s45, 32768
    s_add_u32 s3, s59, s52
    buffer_load_dwordx4 v10, s[4:7], s3 offen lds
    v_mfma_f32_32x32x16_bf16 v[112:127], v[52:55], v[36:39], v[112:127]
    s_add_u32 m0, s46, 32768
    s_add_u32 s3, s60, 0
    buffer_load_dwordx4 v12, s[20:23], s3 offen lds
    s_waitcnt lgkmcnt(0)
    v_mfma_f32_32x32x16_bf16 v[64:79], v[56:59], v[40:43], v[64:79]
    ds_read_b128 v[32:35], v20 offset:0
    ds_read_b128 v[36:39], v20 offset:4096
    ds_read_b64_tr_b16 v[48:49], v28 offset:8192
    v_mfma_f32_32x32x16_bf16 v[80:95], v[56:59], v[44:47], v[80:95]
    ds_read_b64_tr_b16 v[50:51], v28 offset:9216
    ds_read_b64_tr_b16 v[52:53], v29 offset:8192
    ds_read_b64_tr_b16 v[54:55], v29 offset:9216
    v_mfma_f32_32x32x16_bf16 v[96:111], v[60:63], v[40:43], v[96:111]
    s_add_u32 m0, s45, 33792
    s_add_u32 s3, s59, s53
    buffer_load_dwordx4 v11, s[4:7], s3 offen lds
    v_mfma_f32_32x32x16_bf16 v[112:127], v[60:63], v[44:47], v[112:127]
    s_add_u32 m0, s46, 33792
    s_add_u32 s3, s60, 8192
    buffer_load_dwordx4 v12, s[20:23], s3 offen lds
    s_waitcnt lgkmcnt(0)
    v_mfma_f32_32x32x16_bf16 v[64:79], v[48:51], v[32:35], v[64:79]
    ds_read_b128 v[40:43], v21 offset:0
    ds_read_b128 v[44:47], v21 offset:4096
    ds_read_b64_tr_b16 v[56:57], v28 offset:12288
    v_mfma_f32_32x32x16_bf16 v[80:95], v[48:51], v[36:39], v[80:95]
    ds_read_b64_tr_b16 v[58:59], v28 offset:13312
    ds_read_b64_tr_b16 v[60:61], v29 offset:12288
    ds_read_b64_tr_b16 v[62:63], v29 offset:13312
    v_mfma_f32_32x32x16_bf16 v[96:111], v[52:55], v[32:35], v[96:111]
    s_add_u32 m0, s45, 34816
    s_add_u32 s3, s59, s54
    buffer_load_dwordx4 v10, s[4:7], s3 offen lds
    v_mfma_f32_32x32x16_bf16 v[112:127], v[52:55], v[36:39], v[112:127]
    s_add_u32 m0, s46, 34816
    s_add_u32 s3, s60, 16384
    buffer_load_dwordx4 v12, s[20:23], s3 offen lds
    s_waitcnt vmcnt(14) lgkmcnt(0)
    s_barrier
    s_waitcnt lgkmcnt(0)
    v_mfma_f32_32x32x16_bf16 v[64:79], v[56:59], v[40:43], v[64:79]
    ds_read_b128 v[32:35], v18 offset:32768
    ds_read_b128 v[36:39], v18 offset:36864
    ds_read_b64_tr_b16 v[48:49], v28 offset:32768
    v_mfma_f32_32x32x16_bf16 v[80:95], v[56:59], v[44:47], v[80:95]
    ds_read_b64_tr_b16 v[50:51], v28 offset:33792
    ds_read_b64_tr_b16 v[52:53], v29 offset:32768
    ds_read_b64_tr_b16 v[54:55], v29 offset:33792
    v_mfma_f32_32x32x16_bf16 v[96:111], v[60:63], v[40:43], v[96:111]
    s_add_u32 m0, s45, 35840
    s_add_u32 s3, s59, s55
    buffer_load_dwordx4 v11, s[4:7], s3 offen lds
    v_mfma_f32_32x32x16_bf16 v[112:127], v[60:63], v[44:47], v[112:127]
    s_add_u32 m0, s46, 35840
    s_add_u32 s3, s60, 24576
    buffer_load_dwordx4 v12, s[20:23], s3 offen lds
    s_add_u32 s59, s59, s27
    s_add_u32 s60, s60, 131072
    s_waitcnt lgkmcnt(0)
    v_mfma_f32_32x32x16_bf16 v[64:79], v[48:51], v[32:35], v[64:79]
    ds_read_b128 v[40:43], v19 offset:32768
    ds_read_b128 v[44:47], v19 offset:36864
    ds_read_b64_tr_b16 v[56:57], v28 offset:36864
    v_mfma_f32_32x32x16_bf16 v[80:95], v[48:51], v[36:39], v[80:95]
    ds_read_b64_tr_b16 v[58:59], v28 offset:37888
    ds_read_b64_tr_b16 v[60:61], v29 offset:36864
    ds_read_b64_tr_b16 v[62:63], v29 offset:37888
    v_mfma_f32_32x32x16_bf16 v[96:111], v[52:55], v[32:35], v[96:111]
    s_add_u32 m0, s45, 65536
    s_add_u32 s3, s59, s52
    buffer_load_dwordx4 v10, s[4:7], s3 offen lds
    v_mfma_f32_32x32x16_bf16 v[112:127], v[52:55], v[36:39], v[112:127]
    s_add_u32 m0, s46, 65536
    s_add_u32 s3, s60, 0
    buffer_load_dwordx4 v12, s[20:23], s3 offen lds
    s_waitcnt lgkmcnt(0)
    v_mfma_f32_32x32x16_bf16 v[64:79], v[56:59], v[40:43], v[64:79]
    ds_read_b128 v[32:35], v20 offset:32768
    ds_read_b128 v[36:39], v20 offset:36864
    ds_read_b64_tr_b16 v[48:49], v28 offset:40960
    v_mfma_f32_32x32x16_bf16 v[80:95], v[56:59], v[44:47], v[80:95]
    ds_read_b64_tr_b16 v[50:51], v28 offset:41984
    ds_read_b64_tr_b16 v[52:53], v29 offset:40960
    ds_read_b64_tr_b16 v[54:55], v29 offset:41984
    v_mfma_f32_32x32x16_bf16 v[96:111], v[60:63], v[40:43], v[96:111]
    s_add_u32 m0, s45, 66560
    s_add_u32 s3, s59, s53
    buffer_load_dwordx4 v11, s[4:7], s3 offen lds
    v_mfma_f32_32x32x16_bf16 v[112:127], v[60:63], v[44:47], v[112:127]
    s_add_u32 m0, s46, 66560
    s_add_u32 s3, s60, 8192
    buffer_load_dwordx4 v12, s[20:23], s3 offen lds
    s_waitcnt lgkmcnt(0)
    v_mfma_f32_32x32x16_bf16 v[64:79], v[48:51], v[32:35], v[64:79]
    ds_read_b128 v[40:43], v21 offset:32768
    ds_read_b128 v[44:47], v21 offset:36864
    ds_read_b64_tr_b16 v[56:57], v28 offset:45056
    v_mfma_f32_32x32x16_bf16 v[80:95], v[48:51], v[36:39], v[80:95]
    ds_read_b64_tr_b16 v[58:59], v28 offset:46080
    ds_read_b64_tr_b16 v[60:61], v29 offset:45056
    ds_read_b64_tr_b16 v[62:63], v29 offset:46080
    v_mfma_f32_32x32x16_bf16 v[96:111], v[52:55], v[32:35], v[96:111]
    s_add_u32 m0, s45, 67584
    s_add_u32 s3, s59, s54
    buffer_load_dwordx4 v10, s[4:7], s3 offen lds
    v_mfma_f32_32x32x16_bf16 v[112:127], v[52:55], v[36:39], v[112:127]
    s_add_u32 m0, s46, 67584
    s_add_u32 s3, s60, 16384
    buffer_load_dwordx4 v12, s[20:23], s3 offen lds
    s_waitcnt vmcnt(14) lgkmcnt(0)
    s_barrier
    s_waitcnt lgkmcnt(0)
    v_mfma_f32_32x32x16_bf16 v[64:79], v[56:59], v[40:43], v[64:79]
    ds_read_b128 v[32:35], v14 offset:0
    ds_read_b128 v[36:39], v14 offset:4096
    ds_read_b64_tr_b16 v[48:49], v22 offset:0
    v_mfma_f32_32x32x16_bf16 v[80:95], v[56:59], v[44:47], v[80:95]
    ds_read_b64_tr_b16 v[50:51], v22 offset:1024
    ds_read_b64_tr_b16 v[52:53], v23 offset:0
    ds_read_b64_tr_b16 v[54:55], v23 offset:1024
    v_mfma_f32_32x32x16_bf16 v[96:111], v[60:63], v[40:43], v[96:111]
    s_add_u32 m0, s45, 68608
    s_add_u32 s3, s59, s55
    buffer_load_dwordx4 v11, s[4:7], s3 offen lds
    v_mfma_f32_32x32x16_bf16 v[112:127], v[60:63], v[44:47], v[112:127]
    s_add_u32 m0, s46, 68608
    s_add_u32 s3, s60, 24576
    buffer_load_dwordx4 v12, s[20:23], s3 offen lds
    s_add_u32 s59, s59, s27
    s_add_u32 s60, s60, 131072
    s_add_u32 s63, s63, 1
    s_cmp_lt_u32 s63, 3
    s_cbranch_scc1 K3_LOOP2
    s_waitcnt lgkmcnt(0)
    v_mfma_f32_32x32x16_bf16 v[64:79], v[48:51], v[32:35], v[64:79]
    ds_read_b128 v[40:43], v15 offset:0
    ds_read_b128 v[44:47], v15 offset:4096
    ds_read_b64_tr_b16 v[56:57], v22 offset:4096
    v_mfma_f32_32x32x16_bf16 v[80:95], v[48:51], v[36:39], v[80:95]
    ds_read_b64_tr_b16 v[58:59], v22 offset:5120
    ds_read_b64_tr_b16 v[60:61], v23 offset:4096
    ds_read_b64_tr_b16 v[62:63], v23 offset:5120
    v_mfma_f32_32x32x16_bf16 v[96:111], v[52:55], v[32:35], v[96:111]
    s_add_u32 m0, s45, 98304
    s_add_u32 s3, s59, s52
    buffer_load_dwordx4 v10, s[4:7], s3 offen lds
    v_mfma_f32_32x32x16_bf16 v[112:127], v[52:55], v[36:39], v[112:127]
    s_add_u32 m0, s46, 98304
    s_add_u32 s3, s60, 0
    buffer_load_dwordx4 v12, s[20:23], s3 offen lds
    s_waitcnt lgkmcnt(0)
    v_mfma_f32_32x32x16_bf16 v[64:79], v[56:59], v[40:43], v[64:79]
    ds_read_b128 v[32:35], v16 offset:0
    ds_read_b128 v[36:39], v16 offset:4096
    ds_read_b64_tr_b16 v[48:49], v22 offset:8192
    v_mfma_f32_32x32x16_bf16 v[80:95], v[56:59], v[44:47], v[80:95]
    ds_read_b64_tr_b16 v[50:51], v22 offset:9216
    ds_read_b64_tr_b16 v[52:53], v23 offset:8192
    ds_read_b64_tr_b16 v[54:55], v23 offset:9216
    v_mfma_f32_32x32x16_bf16 v[96:111], v[60:63], v[40:43], v[96:111]
    s_add_u32 m0, s45, 99328
    s_add_u32 s3, s59, s53
    buffer_load_dwordx4 v11, s[4:7], s3 offen lds
    v_mfma_f32_32x32x16_bf16 v[112:127], v[60:63], v[44:47], v[112:127]
    s_add_u32 m0, s46, 99328
    s_add_u32 s3, s60, 8192
    buffer_load_dwordx4 v12, s[20:23], s3 offen lds
    s_waitcnt lgkmcnt(0)
    v_mfma_f32_32x32x16_bf16 v[64:79], v[48:51], v[32:35], v[64:79]
    ds_read_b128 v[40:43], v17 offset:0
    ds_read_b128 v[44:47], v17 offset:4096
    ds_read_b64_tr_b16 v[56:57], v22 offset:12288
    v_mfma_f32_32x32x16_bf16 v[80:95], v[48:51], v[36:39], v[80:95]
    ds_read_b64_tr_b16 v[58:59], v22 offset:13312
    ds_read_b64_tr_b16 v[60:61], v23 offset:12288
    ds_read_b64_tr_b16 v[62:63], v23 offset:13312
    v_mfma_f32_32x32x16_bf16 v[96:111], v[52:55], v[32:35], v[96:111]
    s_add_u32 m0, s45, 100352
    s_add_u32 s3, s59, s54
    buffer_load_dwordx4 v10, s[4:7], s3 offen lds
    v_mfma_f32_32x32x16_bf16 v[112:127], v[52:55], v[36:39], v[112:127]
    s_add_u32 m0, s46, 100352
    s_add_u32 s3, s60, 16384
    buffer_load_dwordx4 v12, s[20:23], s3 offen lds
    s_waitcnt vmcnt(14) lgkmcnt(0)
    s_barrier
    s_waitcnt lgkmcnt(0)
    v_mfma_f32_32x32x16_bf16 v[64:79], v[56:59], v[40:43], v[64:79]
    ds_read_b128 v[32:35], v14 offset:32768
    ds_read_b128 v[36:39], v14 offset:36864
    ds_read_b64_tr_b16 v[48:49], v22 offset:32768
    v_mfma_f32_32x32x16_bf16 v[80:95], v[56:59], v[44:47], v[80:95]
    ds_read_b64_tr_b16 v[50:51], v22 offset:33792
    ds_read_b64_tr_b16 v[52:53], v23 offset:32768
    ds_read_b64_tr_b16 v[54:55], v23 offset:33792
    v_mfma_f32_32x32x16_bf16 v[96:111], v[60:63], v[40:43], v[96:111]
    s_add_u32 m0, s45, 101376
    s_add_u32 s3, s59, s55
    buffer_load_dwordx4 v11, s[4:7], s3 offen lds
    v_mfma_f32_32x32x16_bf16 v[112:127], v[60:63], v[44:47], v[112:127]
    s_add_u32 m0, s46, 101376
    s_add_u32 s3, s60, 24576
    buffer_load_dwordx4 v12, s[20:23], s3 offen lds
    s_add_u32 s59, s59, s27
    s_add_u32 s60, s60, 131072
    s_waitcnt lgkmcnt(0)
    v_mfma_f32_32x32x16_bf16 v[64:79], v[48:51], v[32:35], v[64:79]
    ds_read_b128 v[40:43], v15 offset:32768
    ds_read_b128 v[44:47], v15 offset:36864
    ds_read_b64_tr_b16 v[56:57], v22 offset:36864
    v_mfma_f32_32x32x16_bf16 v[80:95], v[48:51], v[36:39], v[80:95]
    ds_read_b64_tr_b16 v[58:59], v22 offset:37888
    ds_read_b64_tr_b16 v[60:61], v23 offset:36864
    ds_read_b64_tr_b16 v[62:63], v23 offset:37888
    v_mfma_f32_32x32x16_bf16 v[96:111], v[52:55], v[32:35], v[96:111]
    v_mfma_f32_32x32x16_bf16 v[112:127], v[52:55], v[36:39], v[112:127]
    s_waitcnt lgkmcnt(0)
    v_mfma_f32_32x32x16_bf16 v[64:79], v[56:59], v[40:43], v[64:79]
    ds_read_b128 v[32:35], v16 offset:32768
    ds_read_b128 v[36:39], v16 offset:36864
    ds_read_b64_tr_b16 v[48:49], v22 offset:40960
    v_mfma_f32_32x32x16_bf16 v[80:95], v[56:59], v[44:47], v[80:95]
    ds_read_b64_tr_b16 v[50:51], v22 offset:41984
    ds_read_b64_tr_b16 v[52:53], v23 offset:40960
    ds_read_b64_tr_b16 v[54:55], v23 offset:41984
    v_mfma_f32_32x32x16_bf16 v[96:111], v[60:63], v[40:43], v[96:111]
    v_mfma_f32_32x32x16_bf16 v[112:127], v[60:63], v[44:47], v[112:127]
    s_waitcnt lgkmcnt(0)
    v_mfma_f32_32x32x16_bf16 v[64:79], v[48:51], v[32:35], v[64:79]
    ds_read_b128 v[40:43], v17 offset:32768
    ds_read_b128 v[44:47], v17 offset:36864
    ds_read_b64_tr_b16 v[56:57], v22 offset:45056
    v_mfma_f32_32x32x16_bf16 v[80:95], v[48:51], v[36:39], v[80:95]
    ds_read_b64_tr_b16 v[58:59], v22 offset:46080
    ds_read_b64_tr_b16 v[60:61], v23 offset:45056
    ds_read_b64_tr_b16 v[62:63], v23 offset:46080
    v_mfma_f32_32x32x16_bf16 v[96:111], v[52:55], v[32:35], v[96:111]
    v_mfma_f32_32x32x16_bf16 v[112:127], v[52:55], v[36:39], v[112:127]
    s_waitcnt vmcnt(8) lgkmcnt(0)
    s_barrier
    s_waitcnt lgkmcnt(0)
    v_mfma_f32_32x32x16_bf16 v[64:79], v[56:59], v[40:43], v[64:79]
    ds_read_b128 v[32:35], v18 offset:0
    ds_read_b128 v[36:39], v18 offset:4096
    ds_read_b64_tr_b16 v[48:49], v28 offset:0
    v_mfma_f32_32x32x16_bf16 v[80:95], v[56:59], v[44:47], v[80:95]
    ds_read_b64_tr_b16 v[50:51], v28 offset:1024
    ds_read_b64_tr_b16 v[52:53], v29 offset:0
    ds_read_b64_tr_b16 v[54:55], v29 offset:1024
    v_mfma_f32_32x32x16_bf16 v[96:111], v[60:63], v[40:43], v[96:111]
    v_mfma_f32_32x32x16_bf16 v[112:127], v[60:63], v[44:47], v[112:127]
    s_waitcnt lgkmcnt(0)
    v_mfma_f32_32x32x16_bf16 v[64:79], v[48:51], v[32:35], v[64:79]
    ds_read_b128 v[40:43], v19 offset:0
    ds_read_b128 v[44:47], v19 offset:4096
    ds_read_b64_tr_b16 v[56:57], v28 offset:4096
    v_mfma_f32_32x32x16_bf16 v[80:95], v[48:51], v[36:39], v[80:95]
    ds_read_b64_tr_b16 v[58:59], v28 offset:5120
    ds_read_b64_tr_b16 v[60:61], v29 offset:4096
    ds_read_b64_tr_b16 v[62:63], v29 offset:5120
    v_mfma_f32_32x32x16_bf16 v[96:111], v[52:55], v[32:35], v[96:111]
    v_mfma_f32_32x32x16_bf16 v[112:127], v[52:55], v[36:39], v[112:127]
    s_waitcnt lgkmcnt(0)
    v_mfma_f32_32x32x16_bf16 v[64:79], v[56:59], v[40:43], v[64:79]
    ds_read_b128 v[32:35], v20 offset:0
    ds_read_b128 v[36:39], v20 offset:4096
    ds_read_b64_tr_b16 v[48:49], v28 offset:8192
    v_mfma_f32_32x32x16_bf16 v[80:95], v[56:59], v[44:47], v[80:95]
    ds_read_b64_tr_b16 v[50:51], v28 offset:9216
    ds_read_b64_tr_b16 v[52:53], v29 offset:8192
    ds_read_b64_tr_b16 v[54:55], v29 offset:9216
    v_mfma_f32_32x32x16_bf16 v[96:111], v[60:63], v[40:43], v[96:111]
    v_mfma_f32_32x32x16_bf16 v[112:127], v[60:63], v[44:47], v[112:127]
    s_waitcnt lgkmcnt(0)
    v_mfma_f32_32x32x16_bf16 v[64:79], v[48:51], v[32:35], v[64:79]
    ds_read_b128 v[40:43], v21 offset:0
    ds_read_b128 v[44:47], v21 offset:4096
    ds_read_b64_tr_b16 v[56:57], v28 offset:12288
    v_mfma_f32_32x32x16_bf16 v[80:95], v[48:51], v[36:39], v[80:95]
    ds_read_b64_tr_b16 v[58:59], v28 offset:13312
    ds_read_b64_tr_b16 v[60:61], v29 offset:12288
    ds_read_b64_tr_b16 v[62:63], v29 offset:13312
    v_mfma_f32_32x32x16_bf16 v[96:111], v[52:55], v[32:35], v[96:111]
    v_mfma_f32_32x32x16_bf16 v[112:127], v[52:55], v[36:39], v[112:127]
    s_waitcnt vmcnt(0) lgkmcnt(0)
    s_barrier
    s_waitcnt lgkmcnt(0)
    v_mfma_f32_32x32x16_bf16 v[64:79], v[56:59], v[40:43], v[64:79]
    ds_read_b128 v[32:35], v18 offset:32768
    ds_read_b128 v[36:39], v18 offset:36864
    ds_read_b64_tr_b16 v[48:49], v28 offset:32768
    v_mfma_f32_32x32x16_bf16 v[80:95], v[56:59], v[44:47], v[80:95]
    ds_read_b64_tr_b16 v[50:51], v28 offset:33792
    ds_read_b64_tr_b16 v[52:53], v29 offset:32768
    ds_read_b64_tr_b16 v[54:55], v29 offset:33792
    v_mfma_f32_32x32x16_bf16 v[96:111], v[60:63], v[40:43], v[96:111]
    v_mfma_f32_32x32x16_bf16 v[112:127], v[60:63], v[44:47], v[112:127]
    s_waitcnt lgkmcnt(0)
    v_mfma_f32_32x32x16_bf16 v[64:79], v[48:51], v[32:35], v[64:79]
    ds_read_b128 v[40:43], v19 offset:32768
    ds_read_b128 v[44:47], v19 offset:36864
    ds_read_b64_tr_b16 v[56:57], v28 offset:36864
    v_mfma_f32_32x32x16_bf16 v[80:95], v[48:51], v[36:39], v[80:95]
    ds_read_b64_tr_b16 v[58:59], v28 offset:37888
    ds_read_b64_tr_b16 v[60:61], v29 offset:36864
    ds_read_b64_tr_b16 v[62:63], v29 offset:37888
    v_mfma_f32_32x32x16_bf16 v[96:111], v[52:55], v[32:35], v[96:111]
    v_mfma_f32_32x32x16_bf16 v[112:127], v[52:55], v[36:39], v[112:127]
    s_waitcnt lgkmcnt(0)
    v_mfma_f32_32x32x16_bf16 v[64:79], v[56:59], v[40:43], v[64:79]
    ds_read_b128 v[32:35], v20 offset:32768
    ds_read_b128 v[36:39], v20 offset:36864
    ds_read_b64_tr_b16 v[48:49], v28 offset:40960
    v_mfma_f32_32x32x16_bf16 v[80:95], v[56:59], v[44:47], v[80:95]
    ds_read_b64_tr_b16 v[50:51], v28 offset:41984
    ds_read_b64_tr_b16 v[52:53], v29 offset:40960
    ds_read_b64_tr_b16 v[54:55], v29 offset:41984
    v_mfma_f32_32x32x16_bf16 v[96:111], v[60:63], v[40:43], v[96:111]
    v_mfma_f32_32x32x16_bf16 v[112:127], v[60:63], v[44:47], v[112:127]
    s_waitcnt lgkmcnt(0)
    v_mfma_f32_32x32x16_bf16 v[64:79], v[48:51], v[32:35], v[64:79]
    ds_read_b128 v[40:43], v21 offset:32768
    ds_read_b128 v[44:47], v21 offset:36864
    ds_read_b64_tr_b16 v[56:57], v28 offset:45056
    v_mfma_f32_32x32x16_bf16 v[80:95], v[48:51], v[36:39], v[80:95]
    ds_read_b64_tr_b16 v[58:59], v28 offset:46080
    ds_read_b64_tr_b16 v[60:61], v29 offset:45056
    ds_read_b64_tr_b16 v[62:63], v29 offset:46080
    v_mfma_f32_32x32x16_bf16 v[96:111], v[52:55], v[32:35], v[96:111]
    v_mfma_f32_32x32x16_bf16 v[112:127], v[52:55], v[36:39], v[112:127]
    s_waitcnt lgkmcnt(0)
    v_mfma_f32_32x32x16_bf16 v[64:79], v[56:59], v[40:43], v[64:79]
    v_mfma_f32_32x32x16_bf16 v[80:95], v[56:59], v[44:47], v[80:95]
    v_mfma_f32_32x32x16_bf16 v[96:111], v[60:63], v[40:43], v[96:111]
    v_mfma_f32_32x32x16_bf16 v[112:127], v[60:63], v[44:47], v[112:127]
    v_and_b32 v3, 31, v2
    v_lshrrev_b32 v4, 1, v1
    v_lshlrev_b32 v4, 6, v4
    v_add_u32 v3, v3, v4
    v_sub_f32 v26, 1.0, v24
    v_sub_f32 v27, 1.0, v25
    s_cmp_eq_u32 s36, 0
    s_cselect_b64 vcc, -1, 0
    s_nop 1
    v_cndmask_b32 v24, v26, v24, vcc
    v_cndmask_b32 v25, v27, v25, vcc
    s_nop 3
    v_mul_f32 v64, v64, v24
    v_mul_f32 v65, v65, v24
    v_mul_f32 v66, v66, v24
    v_mul_f32 v67, v67, v24
    v_mul_f32 v68, v68, v24
    v_mul_f32 v69, v69, v24
    v_mul_f32 v70, v70, v24
    v_mul_f32 v71, v71, v24
    v_mul_f32 v72, v72, v24
    v_mul_f32 v73, v73, v24
    v_mul_f32 v74, v74, v24
    v_mul_f32 v75, v75, v24
    v_mul_f32 v76, v76, v24
    v_mul_f32 v77, v77, v24
    v_mul_f32 v78, v78, v24
    v_mul_f32 v79, v79, v24
    v_fmac_f32 v64, v128, v26
    v_fmac_f32 v65, v129, v26
    v_fmac_f32 v66, v130, v26
    v_fmac_f32 v67, v131, v26
    v_fmac_f32 v68, v132, v26
    v_fmac_f32 v69, v133, v26
    v_fmac_f32 v70, v134, v26
    v_fmac_f32 v71, v135, v26
    v_fmac_f32 v72, v136, v26
    v_fmac_f32 v73, v137, v26
    v_fmac_f32 v74, v138, v26
    v_fmac_f32 v75, v139, v26
    v_fmac_f32 v76, v140, v26
    v_fmac_f32 v77, v141, v26
    v_fmac_f32 v78, v142, v26
    v_fmac_f32 v79, v143, v26
    v_mul_f32 v80, v80, v25
    v_mul_f32 v81, v81, v25
    v_mul_f32 v82, v82, v25
    v_mul_f32 v83, v83, v25
    v_mul_f32 v84, v84, v25
    v_mul_f32 v85, v85, v25
    v_mul_f32 v86, v86, v25
    v_mul_f32 v87, v87, v25
    v_mul_f32 v88, v88, v25
    v_mul_f32 v89, v89, v25
    v_mul_f32 v90, v90, v25
    v_mul_f32 v91, v91, v25
    v_mul_f32 v92, v92, v25
    v_mul_f32 v93, v93, v25
    v_mul_f32 v94, v94, v25
    v_mul_f32 v95, v95, v25
    v_fmac_f32 v80, v144, v27
    v_fmac_f32 v81, v145, v27
    v_fmac_f32 v82, v146, v27
    v_fmac_f32 v83, v147, v27
    v_fmac_f32 v84, v148, v27
    v_fmac_f32 v85, v149, v27
    v_fmac_f32 v86, v150, v27
    v_fmac_f32 v87, v151, v27
    v_fmac_f32 v88, v152, v27
    v_fmac_f32 v89, v153, v27
    v_fmac_f32 v90, v154, v27
    v_fmac_f32 v91, v155, v27
    v_fmac_f32 v92, v156, v27
    v_fmac_f32 v93, v157, v27
    v_fmac_f32 v94, v158, v27
    v_fmac_f32 v95, v159, v27
    v_mul_f32 v96, v96, v24
    v_mul_f32 v97, v97, v24
    v_mul_f32 v98, v98, v24
    v_mul_f32 v99, v99, v24
    v_mul_f32 v100, v100, v24
    v_mul_f32 v101, v101, v24
    v_mul_f32 v102, v102, v24
    v_mul_f32 v103, v103, v24
    v_mul_f32 v104, v104, v24
    v_mul_f32 v105, v105, v24
    v_mul_f32 v106, v106, v24
    v_mul_f32 v107, v107, v24
    v_mul_f32 v108, v108, v24
    v_mul_f32 v109, v109, v24
    v_mul_f32 v110, v110, v24
    v_mul_f32 v111, v111, v24
    v_fmac_f32 v96, v160, v26
    v_fmac_f32 v97, v161, v26
    v_fmac_f32 v98, v162, v26
    v_fmac_f32 v99, v163, v26
    v_fmac_f32 v100, v164, v26
    v_fmac_f32 v101, v165, v26
    v_fmac_f32 v102, v166, v26
    v_fmac_f32 v103, v167, v26
    v_fmac_f32 v104, v168, v26
    v_fmac_f32 v105, v169, v26
    v_fmac_f32 v106, v170, v26
    v_fmac_f32 v107, v171, v26
    v_fmac_f32 v108, v172, v26
    v_fmac_f32 v109, v173, v26
    v_fmac_f32 v110, v174, v26
    v_fmac_f32 v111, v175, v26
    v_mul_f32 v112, v112, v25
    v_mul_f32 v113, v113, v25
    v_mul_f32 v114, v114, v25
    v_mul_f32 v115, v115, v25
    v_mul_f32 v116, v116, v25
    v_mul_f32 v117, v117, v25
    v_mul_f32 v118, v118, v25
    v_mul_f32 v119, v119, v25
    v_mul_f32 v120, v120, v25
    v_mul_f32 v121, v121, v25
    v_mul_f32 v122, v122, v25
    v_mul_f32 v123, v123, v25
    v_mul_f32 v124, v124, v25
    v_mul_f32 v125, v125, v25
    v_mul_f32 v126, v126, v25
    v_mul_f32 v127, v127, v25
    v_fmac_f32 v112, v176, v27
    v_fmac_f32 v113, v177, v27
    v_fmac_f32 v114, v178, v27
    v_fmac_f32 v115, v179, v27
    v_fmac_f32 v116, v180, v27
    v_fmac_f32 v117, v181, v27
    v_fmac_f32 v118, v182, v27
    v_fmac_f32 v119, v183, v27
    v_fmac_f32 v120, v184, v27
    v_fmac_f32 v121, v185, v27
    v_fmac_f32 v122, v186, v27
    v_fmac_f32 v123, v187, v27
    v_fmac_f32 v124, v188, v27
    v_fmac_f32 v125, v189, v27
    v_fmac_f32 v126, v190, v27
    v_fmac_f32 v127, v191, v27
    s_lshl_b32 s3, s33, 3
    s_add_u32 s3, s3, s34
    s_lshl_b32 s3, s3, 1
    s_add_u32 s38, s3, s36
    s_xor_b32 s39, s38, 1
    s_lshl_b32 s38, s38, 2
    s_add_u32 s38, s38, s35
    s_lshl_b32 s38, s38, 13
    s_add_u32 s38, s38, 29360128
    s_lshl_b32 s39, s39, 2
    s_add_u32 s39, s39, s35
    s_lshl_b32 s39, s39, 13
    s_add_u32 s39, s39, 29360128
    v_lshlrev_b32 v5, 4, v2
    v_lshlrev_b32 v6, 11, v3
    v_lshrrev_b32 v7, 5, v2
    v_lshl_add_u32 v6, v7, 4, v6
    s_lshl_b32 s47, s33, 18
    s_lshl_b32 s3, s36, 16
    s_add_u32 s47, s47, s3
    s_lshl_b32 s3, s34, 8
    s_add_u32 s47, s47, s3
    s_and_b32 s3, s35, 1
    s_lshl_b32 s3, s3, 7
    s_add_u32 s47, s47, s3
    s_cmp_eq_u32 s36, 0
    s_cbranch_scc0 K3_S1
    buffer_store_dwordx4 v[80:83], v5, s[28:31], s39 offen offset:0 sc1
    buffer_store_dwordx4 v[84:87], v5, s[28:31], s39 offen offset:1024 sc1
    buffer_store_dwordx4 v[88:91], v5, s[28:31], s39 offen offset:2048 sc1
    buffer_store_dwordx4 v[92:95], v5, s[28:31], s39 offen offset:3072 sc1
    s_add_u32 s39, s39, 4096
    buffer_store_dwordx4 v[112:115], v5, s[28:31], s39 offen offset:0 sc1
    buffer_store_dwordx4 v[116:119], v5, s[28:31], s39 offen offset:1024 sc1
    buffer_store_dwordx4 v[120:123], v5, s[28:31], s39 offen offset:2048 sc1
    buffer_store_dwordx4 v[124:127], v5, s[28:31], s39 offen offset:3072 sc1
    s_waitcnt vmcnt(0)
    s_barrier
    s_cmp_eq_u32 s35, 0
    s_cbranch_scc0 K3_NOFLAG0
    v_mov_b32 v30, 1
    v_mov_b32 v31, 0
    s_lshl_b32 s3, s2, 7
    s_add_u32 s3, s3, 28377088
    v_cmp_eq_u32 vcc, 0, v2
    s_and_saveexec_b64 s[78:79], vcc
    buffer_store_dword v30, v31, s[28:31], s3 offen sc1
    s_mov_b64 exec, s[78:79]
K3_NOFLAG0:
    s_xor_b32 s49, s2, 1
    s_lshl_b32 s49, s49, 7
    s_add_u32 s49, s49, 28377088
    v_mov_b32 v31, 0
    s_mov_b32 s56, 0
K3_XSPIN0:
    buffer_load_dword v30, v31, s[28:31], s49 offen sc1
    s_waitcnt vmcnt(0)
    v_readfirstlane_b32 s3, v30
    s_add_u32 s56, s56, 1
    s_cmp_ge_u32 s56, 0x20000
    s_cbranch_scc1 K3_XGO0
    s_cmp_eq_u32 s3, 1
    s_cbranch_scc1 K3_XGO0
    s_sleep 2
    s_branch K3_XSPIN0
K3_XGO0:
    buffer_load_dwordx4 v[128:131], v5, s[28:31], s38 offen offset:0 sc1
    buffer_load_dwordx4 v[132:135], v5, s[28:31], s38 offen offset:1024 sc1
    buffer_load_dwordx4 v[136:139], v5, s[28:31], s38 offen offset:2048 sc1
    buffer_load_dwordx4 v[140:143], v5, s[28:31], s38 offen offset:3072 sc1
    s_add_u32 s38, s38, 4096
    buffer_load_dwordx4 v[144:147], v5, s[28:31], s38 offen offset:0 sc1
    buffer_load_dwordx4 v[148:151], v5, s[28:31], s38 offen offset:1024 sc1
    buffer_load_dwordx4 v[152:155], v5, s[28:31], s38 offen offset:2048 sc1
    buffer_load_dwordx4 v[156:159], v5, s[28:31], s38 offen offset:3072 sc1
    s_waitcnt vmcnt(4)
    v_add_f32 v64, v64, v128
    v_add_f32 v65, v65, v129
    v_add_f32 v66, v66, v130
    v_add_f32 v67, v67, v131
    v_add_f32 v68, v68, v132
    v_add_f32 v69, v69, v133
    v_add_f32 v70, v70, v134
    v_add_f32 v71, v71, v135
    v_add_f32 v72, v72, v136
    v_add_f32 v73, v73, v137
    v_add_f32 v74, v74, v138
    v_add_f32 v75, v75, v139
    v_add_f32 v76, v76, v140
    v_add_f32 v77, v77, v141
    v_add_f32 v78, v78, v142
    v_add_f32 v79, v79, v143
    v_cvt_pk_bf16_f32 v32, v64, v65
    v_cvt_pk_bf16_f32 v33, v66, v67
    v_cvt_pk_bf16_f32 v34, v68, v69
    v_cvt_pk_bf16_f32 v35, v70, v71
    v_cvt_pk_bf16_f32 v36, v72, v73
    v_cvt_pk_bf16_f32 v37, v74, v75
    v_cvt_pk_bf16_f32 v38, v76, v77
    v_cvt_pk_bf16_f32 v39, v78, v79
    s_nop 1
    v_permlane32_swap_b32 v32, v34
    v_permlane32_swap_b32 v33, v35
    v_permlane32_swap_b32 v36, v38
    v_permlane32_swap_b32 v37, v39
    buffer_store_dwordx4 v[32:35], v6, s[68:71], s47 offen offset:0
    buffer_store_dwordx4 v[36:39], v6, s[68:71], s47 offen offset:32
    s_waitcnt vmcnt(0)
    v_add_f32 v96, v96, v144
    v_add_f32 v97, v97, v145
    v_add_f32 v98, v98, v146
    v_add_f32 v99, v99, v147
    v_add_f32 v100, v100, v148
    v_add_f32 v101, v101, v149
    v_add_f32 v102, v102, v150
    v_add_f32 v103, v103, v151
    v_add_f32 v104, v104, v152
    v_add_f32 v105, v105, v153
    v_add_f32 v106, v106, v154
    v_add_f32 v107, v107, v155
    v_add_f32 v108, v108, v156
    v_add_f32 v109, v109, v157
    v_add_f32 v110, v110, v158
    v_add_f32 v111, v111, v159
    v_cvt_pk_bf16_f32 v40, v96, v97
    v_cvt_pk_bf16_f32 v41, v98, v99
    v_cvt_pk_bf16_f32 v42, v100, v101
    v_cvt_pk_bf16_f32 v43, v102, v103
    v_cvt_pk_bf16_f32 v44, v104, v105
    v_cvt_pk_bf16_f32 v45, v106, v107
    v_cvt_pk_bf16_f32 v46, v108, v109
    v_cvt_pk_bf16_f32 v47, v110, v111
    s_nop 1
    v_permlane32_swap_b32 v40, v42
    v_permlane32_swap_b32 v41, v43
    v_permlane32_swap_b32 v44, v46
    v_permlane32_swap_b32 v45, v47
    buffer_store_dwordx4 v[40:43], v6, s[68:71], s47 offen offset:64
    buffer_store_dwordx4 v[44:47], v6, s[68:71], s47 offen offset:96
    s_branch K3_FIN
K3_S1:
    buffer_store_dwordx4 v[64:67], v5, s[28:31], s39 offen offset:0 sc1
    buffer_store_dwordx4 v[68:71], v5, s[28:31], s39 offen offset:1024 sc1
    buffer_store_dwordx4 v[72:75], v5, s[28:31], s39 offen offset:2048 sc1
    buffer_store_dwordx4 v[76:79], v5, s[28:31], s39 offen offset:3072 sc1
    s_add_u32 s39, s39, 4096
    buffer_store_dwordx4 v[96:99], v5, s[28:31], s39 offen offset:0 sc1
    buffer_store_dwordx4 v[100:103], v5, s[28:31], s39 offen offset:1024 sc1
    buffer_store_dwordx4 v[104:107], v5, s[28:31], s39 offen offset:2048 sc1
    buffer_store_dwordx4 v[108:111], v5, s[28:31], s39 offen offset:3072 sc1
    s_waitcnt vmcnt(0)
    s_barrier
    s_cmp_eq_u32 s35, 0
    s_cbranch_scc0 K3_NOFLAG1
    v_mov_b32 v30, 1
    v_mov_b32 v31, 0
    s_lshl_b32 s3, s2, 7
    s_add_u32 s3, s3, 28377088
    v_cmp_eq_u32 vcc, 0, v2
    s_and_saveexec_b64 s[78:79], vcc
    buffer_store_dword v30, v31, s[28:31], s3 offen sc1
    s_mov_b64 exec, s[78:79]
K3_NOFLAG1:
    s_xor_b32 s49, s2, 1
    s_lshl_b32 s49, s49, 7
    s_add_u32 s49, s49, 28377088
    v_mov_b32 v31, 0
    s_mov_b32 s56, 0
K3_XSPIN1:
    buffer_load_dword v30, v31, s[28:31], s49 offen sc1
    s_waitcnt vmcnt(0)
    v_readfirstlane_b32 s3, v30
    s_add_u32 s56, s56, 1
    s_cmp_ge_u32 s56, 0x20000
    s_cbranch_scc1 K3_XGO1
    s_cmp_eq_u32 s3, 1
    s_cbranch_scc1 K3_XGO1
    s_sleep 2
    s_branch K3_XSPIN1
K3_XGO1:
    buffer_load_dwordx4 v[128:131], v5, s[28:31], s38 offen offset:0 sc1
    buffer_load_dwordx4 v[132:135], v5, s[28:31], s38 offen offset:1024 sc1
    buffer_load_dwordx4 v[136:139], v5, s[28:31], s38 offen offset:2048 sc1
    buffer_load_dwordx4 v[140:143], v5, s[28:31], s38 offen offset:3072 sc1
    s_add_u32 s38, s38, 4096
    buffer_load_dwordx4 v[144:147], v5, s[28:31], s38 offen offset:0 sc1
    buffer_load_dwordx4 v[148:151], v5, s[28:31], s38 offen offset:1024 sc1
    buffer_load_dwordx4 v[152:155], v5, s[28:31], s38 offen offset:2048 sc1
    buffer_load_dwordx4 v[156:159], v5, s[28:31], s38 offen offset:3072 sc1
    s_waitcnt vmcnt(4)
    v_add_f32 v80, v80, v128
    v_add_f32 v81, v81, v129
    v_add_f32 v82, v82, v130
    v_add_f32 v83, v83, v131
    v_add_f32 v84, v84, v132
    v_add_f32 v85, v85, v133
    v_add_f32 v86, v86, v134
    v_add_f32 v87, v87, v135
    v_add_f32 v88, v88, v136
    v_add_f32 v89, v89, v137
    v_add_f32 v90, v90, v138
    v_add_f32 v91, v91, v139
    v_add_f32 v92, v92, v140
    v_add_f32 v93, v93, v141
    v_add_f32 v94, v94, v142
    v_add_f32 v95, v95, v143
    v_cvt_pk_bf16_f32 v32, v80, v81
    v_cvt_pk_bf16_f32 v33, v82, v83
    v_cvt_pk_bf16_f32 v34, v84, v85
    v_cvt_pk_bf16_f32 v35, v86, v87
    v_cvt_pk_bf16_f32 v36, v88, v89
    v_cvt_pk_bf16_f32 v37, v90, v91
    v_cvt_pk_bf16_f32 v38, v92, v93
    v_cvt_pk_bf16_f32 v39, v94, v95
    s_nop 1
    v_permlane32_swap_b32 v32, v34
    v_permlane32_swap_b32 v33, v35
    v_permlane32_swap_b32 v36, v38
    v_permlane32_swap_b32 v37, v39
    buffer_store_dwordx4 v[32:35], v6, s[68:71], s47 offen offset:0
    buffer_store_dwordx4 v[36:39], v6, s[68:71], s47 offen offset:32
    s_waitcnt vmcnt(0)
    v_add_f32 v112, v112, v144
    v_add_f32 v113, v113, v145
    v_add_f32 v114, v114, v146
    v_add_f32 v115, v115, v147
    v_add_f32 v116, v116, v148
    v_add_f32 v117, v117, v149
    v_add_f32 v118, v118, v150
    v_add_f32 v119, v119, v151
    v_add_f32 v120, v120, v152
    v_add_f32 v121, v121, v153
    v_add_f32 v122, v122, v154
    v_add_f32 v123, v123, v155
    v_add_f32 v124, v124, v156
    v_add_f32 v125, v125, v157
    v_add_f32 v126, v126, v158
    v_add_f32 v127, v127, v159
    v_cvt_pk_bf16_f32 v40, v112, v113
    v_cvt_pk_bf16_f32 v41, v114, v115
    v_cvt_pk_bf16_f32 v42, v116, v117
    v_cvt_pk_bf16_f32 v43, v118, v119
    v_cvt_pk_bf16_f32 v44, v120, v121
    v_cvt_pk_bf16_f32 v45, v122, v123
    v_cvt_pk_bf16_f32 v46, v124, v125
    v_cvt_pk_bf16_f32 v47, v126, v127
    s_nop 1
    v_permlane32_swap_b32 v40, v42
    v_permlane32_swap_b32 v41, v43
    v_permlane32_swap_b32 v44, v46
    v_permlane32_swap_b32 v45, v47
    buffer_store_dwordx4 v[40:43], v6, s[68:71], s47 offen offset:64
    buffer_store_dwordx4 v[44:47], v6, s[68:71], s47 offen offset:96
K3_FIN:
K3_END:
    s_endpgm

.section .rodata,"a"
.p2align 6
.amdhsa_kernel k3_gemm2_kernel
  .amdhsa_next_free_vgpr 360
  .amdhsa_next_free_sgpr 102
  .amdhsa_accum_offset 256
  .amdhsa_group_segment_fixed_size 0
  .amdhsa_kernarg_size 88
  .amdhsa_user_sgpr_count 2
  .amdhsa_user_sgpr_kernarg_segment_ptr 1
  .amdhsa_system_sgpr_workgroup_id_x 1
.end_amdhsa_kernel
.text
```
